```python
import torch

def _softmax(x, axis=-1):
    return torch.softmax(x, dim=axis)
def _gelu(x):
    return torch.nn.functional.gelu(x, approximate="tanh")
def _silu(x):
    return torch.nn.functional.silu(x)
def _sigmoid(x):
    return torch.sigmoid(x)
def _layernorm(x, axis=-1, eps=1e-5):
    m = x.mean(dim=axis, keepdim=True)
    v = x.var(dim=axis, keepdim=True, unbiased=False)
    return (x - m) / torch.sqrt(v + eps)
def _scatter_add(tgt, idx, src, axis=0):
    return tgt.clone().index_add_(axis, idx, src)
def _segment_sum(src, seg, n):
    out = torch.zeros((n,) + src.shape[1:], dtype=src.dtype)
    return out.index_add_(0, seg, src)
def _pad(x, pw):
    flat = tuple(v for pair in reversed(pw) for v in pair)
    return torch.nn.functional.pad(x, flat)

kernel_name = 'recurrent_scan__linear_kernel_hedgehog__swiglu_ffn__prompt'

def setup_inputs():

    _w = (lambda a: (lambda t: t.to(torch.bfloat16) if t.is_floating_point() else t)(torch.as_tensor(a)))
    def _A_setup():
        B, S, D, H = 1, 2048, 576, 32
        Dh = D // H
        return {
            "x": _w((lambda *s: torch.randn(*s, dtype=torch.bfloat16) * 0.05)(B, S, D)),
            "wqkv": _w((lambda *s: torch.randn(*s, dtype=torch.bfloat16) * 0.2)(D, 3 * D)),
            "w_phi": _w((lambda *s: torch.randn(*s, dtype=torch.bfloat16) * 0.2)(H, Dh, Dh) * (Dh ** -0.5)),
            "wo": _w((lambda *s: torch.randn(*s, dtype=torch.bfloat16) * 0.05)(D, D)),
        }
    _A_in = _A_setup()

    def _B_setup():
        B, S, D, F = 1, 2048, 576, 4608
        return {
            "x": _w((lambda *s: torch.randn(*s, dtype=torch.bfloat16) * 0.05)(B, S, D)),
            "w_gate": _w((lambda *s: torch.randn(*s, dtype=torch.bfloat16) * 0.05)(D, F)),
            "w_up": _w((lambda *s: torch.randn(*s, dtype=torch.bfloat16) * 0.05)(D, F)),
            "w_down": _w((lambda *s: torch.randn(*s, dtype=torch.bfloat16) * 0.05)(F, D)),
        }
    _B_in = _B_setup()

    return {
        "A_x": _A_in["x"],
        "A_wqkv": _A_in["wqkv"],
        "A_w_phi": _A_in["w_phi"],
        "A_wo": _A_in["wo"],
        "B_x": _B_in["x"],
        "B_w_gate": _B_in["w_gate"],
        "B_w_up": _B_in["w_up"],
        "B_w_down": _B_in["w_down"],
    }

def reference(A_x, A_wqkv, A_w_phi, A_wo, B_x, B_w_gate, B_w_up, B_w_down):
    def _A_ref(x, wqkv, w_phi, wo):
        B, S, D = x.shape
        H = 32; Dh = D // H
        qkv = (lambda x, *d: x.permute(*d))((x @ wqkv).reshape(B, S, 3, H, Dh), 2, 0, 3, 1, 4)
        q, k, v = qkv[0], qkv[1], qkv[2]
        pq = torch.einsum("bhsd,hdf->bhsf", q, w_phi)
        pk = torch.einsum("bhsd,hdf->bhsf", k, w_phi)
        phi_q = torch.concatenate([_softmax(pq, axis=-1), _softmax(-pq, axis=-1)], axis=-1)
        phi_k = torch.concatenate([_softmax(pk, axis=-1), _softmax(-pk, axis=-1)], axis=-1)
        kv = torch.einsum("bhsf,bhsd->bhfd", phi_k, v)
        z  = torch.einsum("bhsf->bhf", phi_k)
        num = torch.einsum("bhqf,bhfd->bhqd", phi_q, kv)
        den = torch.einsum("bhqf,bhf->bhq", phi_q, z)[..., None] + 1e-6
        o = num / den
        return (lambda x, *d: x.permute(*d))(o, 0, 2, 1, 3).reshape(B, S, D) @ wo

    def _B_ref(x, w_gate, w_up, w_down):
        g = _silu(x @ w_gate)
        u = x @ w_up
        return (g * u) @ w_down

    x = A_x
    xn = _layernorm(x, axis=-1)
    s = _A_ref(xn, A_wqkv, A_w_phi, A_wo)
    g = _silu(_B_ref(xn, B_w_gate, B_w_up, B_w_down))
    return x + s * g
```

```asm
; @launch grid=(256,1,1) block=(256,1,1) lds=163552
.amdgcn_target "amdgcn-amd-amdhsa--gfx950"
.text
.globl recurrent_scan__linear_kernel_hedgehog__swiglu_ffn__prompt_kernel
.p2align 8
.type recurrent_scan__linear_kernel_hedgehog__swiglu_ffn__prompt_kernel,@function
recurrent_scan__linear_kernel_hedgehog__swiglu_ffn__prompt_kernel:
    s_cmp_ge_u32 s2, 256
    s_cbranch_scc1 LK_end
    s_load_dwordx8 s[64:71], s[0:1], 0
    s_load_dwordx8 s[72:79], s[0:1], 40
    s_load_dwordx4 s[80:83], s[0:1], 72
    v_lshrrev_b32 v14, 6, v0
    v_and_b32 v1, 63, v0
    v_readfirstlane_b32 s36, v14
    s_and_b32 s40, s2, 7
    s_lshr_b32 s41, s2, 3
    s_and_b32 s42, s40, 1
    s_lshl_b32 s42, s42, 2
    s_and_b32 s43, s41, 3
    s_add_u32 s37, s42, s43
    s_lshr_b32 s42, s40, 1
    s_lshl_b32 s42, s42, 3
    s_lshr_b32 s43, s41, 2
    s_add_u32 s38, s42, s43
    s_lshl_b32 s44, s36, 10
    s_lshl_b32 s56, s36, 11
    s_lshl_b32 s3, s36, 13
    s_lshl_b32 s63, s36, 3
    s_add_u32 s63, s63, s37
    s_mul_i32 s40, s38, 144
    s_and_b32 s41, s38, 1
    s_lshl_b32 s42, s41, 4
    s_add_u32 s42, s42, s40
    s_cmp_eq_u32 s41, 0
    s_cselect_b32 s43, 128, 0
    s_add_u32 s43, s43, s40
    s_add_u32 s40, s38, 1
    s_and_b32 s40, s40, 2
    s_lshl_b32 s40, s40, 4
    s_add_u32 s45, s42, s40
    s_lshl_b32 s45, s45, 1
    v_lshrrev_b32 v17, 5, v1
    v_and_b32 v19, 31, v1
    s_lshl_b32 s39, s37, 5
    s_add_u32 s39, s39, s38
    s_lshl_b32 s39, s39, 3
    s_lshl_b32 s61, s36, 1
    s_add_u32 s61, s61, s39
    v_add_u32 v16, s61, v17
    v_mul_u32_u24 v15, 1152, v16
    v_lshl_add_u32 v15, v19, 2, v15
    s_add_u32 s100, s37, s38
    s_mul_i32 s62, s100, 7282
    s_lshr_b32 s62, s62, 16
    s_mul_i32 s62, s62, 9
    s_sub_u32 s100, s100, s62
    v_lshrrev_b32 v12, 3, v1
    s_lshl_b32 s61, s37, 2
    s_add_u32 s61, s61, s36
    s_lshl_b32 s61, s61, 6
    v_add_u32 v13, s61, v12
    v_mul_u32_u24 v13, 1152, v13
    v_lshrrev_b32 v12, 1, v12
    v_and_b32 v14, 7, v1
    v_xor_b32 v12, v12, v14
    v_lshl_add_u32 v212, v12, 4, v13
    v_xor_b32 v213, 64, v212
    v_bfe_u32 v12, v1, 2, 3
    s_lshl_b32 s61, s36, 4
    v_add_u32 v12, s61, v12
    v_mul_u32_u24 v12, 9216, v12
    v_lshl_add_u32 v12, v17, 6, v12
    v_and_b32 v13, 3, v1
    v_lshl_add_u32 v214, v13, 4, v12
    v_cmp_eq_u32 vcc, 0, v1
    v_mov_b32 v18, 2146435072
    s_nop 0
    v_cndmask_b32 v0, v18, v1, vcc
    v_lshlrev_b32 v6, 4, v1
    s_waitcnt lgkmcnt(0)
    s_mov_b32 s4, s64
    s_mov_b32 s5, s65
    s_mov_b32 s6, 2359296
    s_mov_b32 s7, 0x20000
    s_getpc_b64 s[46:47]
LT_pc:
    s_lshr_b32 s48, s2, 3
    s_lshl_b32 s48, s48, 2
    s_add_u32 s48, s48, s36
    s_cmp_gt_u32 s48, 7
    s_cbranch_scc1 LT_nocode
    s_lshl_b32 s48, s48, 13
    v_lshlrev_b32 v21, 7, v1
    v_add_u32 v21, s48, v21
    v_min_u32 v21, LK_end-LT_pc-4, v21
    global_load_dword v255, v21, s[46:47]
LT_nocode:
    buffer_load_dword v224, v15, s[4:7], 0 offen offset:0
    buffer_load_dword v225, v15, s[4:7], 0 offen offset:128
    buffer_load_dword v226, v15, s[4:7], 0 offen offset:256
    buffer_load_dword v227, v15, s[4:7], 0 offen offset:384
    buffer_load_dword v228, v15, s[4:7], 0 offen offset:512
    buffer_load_dword v229, v15, s[4:7], 0 offen offset:640
    buffer_load_dword v230, v15, s[4:7], 0 offen offset:768
    buffer_load_dword v231, v15, s[4:7], 0 offen offset:896
    buffer_load_dword v232, v15, s[4:7], 0 offen offset:1024
    s_mov_b32 s12, s72
    s_mov_b32 s13, s73
    s_mov_b32 s14, 5308416
    s_mov_b32 s15, 0x20000
    s_mov_b32 s16, s74
    s_mov_b32 s17, s75
    s_mov_b32 s18, 5308416
    s_mov_b32 s19, 0x20000
    s_mov_b32 s24, s66
    s_mov_b32 s25, s67
    s_mov_b32 s26, 1990656
    s_mov_b32 s27, 0x20000
    v_min_u32 v20, 15, v1
    v_lshlrev_b32 v20, 7, v20
    s_lshl_b32 s46, s2, 2
    s_add_u32 s46, s46, s36
    s_lshl_b32 s46, s46, 11
    buffer_load_dword v248, v20, s[24:27], s46 offen
    s_mul_i32 s60, s100, 589824
    s_add_u32 s60, s60, s45
    s_add_u32 m0, s56, 0
    s_nop 0
    buffer_load_dwordx4 v214, s[12:15], s60 offen lds
    s_add_u32 m0, s56, 8224
    s_nop 0
    buffer_load_dwordx4 v214, s[16:19], s60 offen lds
    s_add_u32 m0, s56, 1024
    s_add_u32 s60, s60, 73728
    buffer_load_dwordx4 v214, s[12:15], s60 offen lds
    s_add_u32 m0, s56, 9248
    s_nop 0
    buffer_load_dwordx4 v214, s[16:19], s60 offen lds
    s_add_u32 m0, s3, 16416
    s_lshl_b32 s60, s100, 7
    buffer_load_dwordx4 v212, s[4:7], s60 offen lds
    s_mov_b32 s20, s80
    s_mov_b32 s21, s81
    s_mov_b32 s22, 256
    s_mov_b32 s23, 0x20000
    s_or_b32 s46, s2, s36
    s_cmp_lg_u32 s46, 0
    s_cbranch_scc1 LT_skip
    s_memrealtime s[46:47]
    v_mov_b32 v34, 0
    v_mov_b32 v35, 0
    s_waitcnt lgkmcnt(0)
    s_or_b32 s46, s46, 1
    v_mov_b32 v32, s46
    v_mov_b32 v33, s47
    buffer_atomic_cmpswap_x2 v[32:35], v0, s[20:23], 0 offen sc1
LT_skip:
    s_add_u32 s46, s45, 64
    s_lshl_b32 s40, s40, 1
    s_sub_u32 s40, 64, s40
    s_add_u32 s40, s40, s42
    s_lshl_b32 s47, s40, 1
    s_add_u32 s42, s42, 96
    s_lshl_b32 s48, s42, 1
    s_lshl_b32 s49, s43, 1
    s_lshl_b32 s50, s45, 4
    s_lshl_b32 s51, s46, 4
    s_lshl_b32 s52, s47, 4
    s_lshl_b32 s53, s48, 4
    s_lshl_b32 s54, s49, 4
    s_mul_i32 s62, s38, 4608
    s_add_u32 s8, s82, 2359296
    s_addc_u32 s9, s83, 0
    s_mov_b32 s10, 2359296
    s_mov_b32 s11, 0x20000
    s_mov_b32 s28, s68
    s_mov_b32 s29, s69
    s_mov_b32 s30, 20736
    s_mov_b32 s31, 0x20000
    s_add_u32 s32, s82, 4882432
    s_addc_u32 s33, s83, 0
    s_mov_b32 s34, 65536
    s_mov_b32 s35, 0x20000
    s_xor_b32 s66, s36, 0
    s_lshl_b32 s66, s66, 10
    s_xor_b32 s67, s36, 1
    s_lshl_b32 s67, s67, 10
    s_xor_b32 s68, s36, 2
    s_lshl_b32 s68, s68, 10
    s_xor_b32 s69, s36, 3
    s_lshl_b32 s69, s69, 10
    s_mul_i32 s80, s38, 73728
    s_add_u32 s80, s80, s44
    s_cmp_eq_u32 s36, 0
    s_cselect_b32 s81, 0, 2146435072
    v_bfe_u32 v12, v1, 2, 2
    v_and_b32 v13, 3, v1
    v_lshlrev_b32 v13, 3, v13
    v_lshl_add_u32 v12, v12, 6, v13
    v_bfe_u32 v13, v1, 4, 1
    v_mul_u32_u24 v14, 36896, v13
    v_add_u32 v14, v14, v12
    v_lshl_add_u32 v7, v17, 9, v14
    v_mul_u32_u24 v14, 8224, v13
    v_add_u32 v14, v14, v12
    v_lshl_add_u32 v14, v17, 10, v14
    s_lshl_b32 s40, s66, 1
    v_add_u32 v8, s40, v14
    s_lshl_b32 s40, s67, 1
    v_add_u32 v9, s40, v14
    s_lshl_b32 s40, s68, 1
    v_add_u32 v10, s40, v14
    s_lshl_b32 s40, s69, 1
    v_add_u32 v11, s40, v14
    v_bfe_u32 v12, v1, 1, 3
    v_xor_b32 v12, v12, v17
    s_add_u32 s41, s3, 16416
    v_lshl_add_u32 v14, v19, 7, s41
    s_lshr_b32 s40, s66, 9
    v_xor_b32 v15, s40, v12
    v_lshl_add_u32 v208, v15, 4, v14
    s_lshr_b32 s40, s67, 9
    v_xor_b32 v15, s40, v12
    v_lshl_add_u32 v209, v15, 4, v14
    s_lshr_b32 s40, s68, 9
    v_xor_b32 v15, s40, v12
    v_lshl_add_u32 v210, v15, 4, v14
    s_lshr_b32 s40, s69, 9
    v_xor_b32 v15, s40, v12
    v_lshl_add_u32 v211, v15, 4, v14
    v_lshrrev_b32 v12, 2, v1
    s_lshl_b32 s40, s36, 4
    v_add_u32 v12, s40, v12
    v_mul_u32_u24 v12, 9216, v12
    v_and_b32 v14, 3, v1
    v_lshl_add_u32 v2, v14, 4, v12
    s_lshl_b32 s40, s37, 4
    s_lshl_b32 s41, s36, 2
    s_add_u32 s40, s40, s41
    v_add_u32 v12, s40, v13
    v_mul_u32_u24 v12, 147456, v12
    v_and_b32 v14, 15, v1
    v_lshl_add_u32 v12, v14, 4, v12
    v_lshl_add_u32 v3, v17, 8, v12
    s_mul_i32 s40, s36, 3600
    s_add_u32 s40, s40, 147552
    v_mul_u32_u24 v12, 112, v19
    v_lshl_add_u32 v12, v17, 3, v12
    v_add_u32 v4, s40, v12
    v_lshrrev_b32 v12, 4, v1
    v_bfe_u32 v15, v1, 2, 2
    v_lshl_add_u32 v12, v12, 3, v15
    v_mul_u32_u24 v12, 112, v12
    v_and_b32 v15, 3, v1
    v_lshl_add_u32 v12, v15, 3, v12
    v_add_u32 v5, s40, v12
    s_lshl_b32 s41, s36, 7
    s_add_u32 s41, s41, 147552
    v_lshl_add_u32 v244, v1, 3, s41
    v_lshlrev_b32 v12, 3, v14
    v_lshl_add_u32 v12, v13, 2, v12
    v_add_u32 v245, 147552, v12
    s_mov_b32 s55, 0xbfb8aa3b
    v_lshlrev_b32 v16, 4, v16
    v_add_u32 v16, 32768, v16
    v_cmp_eq_u32 vcc, 0, v19
    s_nop 1
    v_cndmask_b32 v220, v18, v16, vcc
    v_mov_b32 v243, 0
    v_mov_b32 v241, v17
    v_bfe_u32 v22, v19, 2, 1
    v_lshrrev_b32 v23, 3, v19
    v_and_b32 v24, 3, v19
    v_lshl_or_b32 v240, v23, 2, v24
    v_mul_u32_u24 v24, 9, v22
    v_cmp_gt_u32 vcc, 9, v240
    v_subrev_u32 v25, 9, v240
    s_nop 0
    v_cndmask_b32 v25, v25, v240, vcc
    v_add_u32 v25, v25, v24
    v_cmp_gt_u32 vcc, 2, v240
    v_add3_u32 v26, v240, v24, 7
    s_nop 0
    v_cndmask_b32 v26, v243, v26, vcc
    s_add_u32 s41, s44, 158352
    v_lshl_add_u32 v238, v25, 1, s41
    v_lshl_add_u32 v239, v26, 1, s41
    v_and_b32 v20, 0x13, v19
    v_and_b32 v21, 4, v19
    v_lshl_or_b32 v20, v21, 1, v20
    v_and_b32 v21, 8, v19
    v_lshrrev_b32 v21, 1, v21
    v_or_b32 v20, v20, v21
    v_mul_u32_u24 v20, 36, v20
    v_add_u32 v246, s40, v20
    v_lshl_add_u32 v247, v17, 4, v246
    v_mul_u32_u24 v27, 288, v17
    v_add_u32 v236, v238, v27
    v_add_u32 v237, v239, v27
    v_subrev_u32 v25, 2, v240
    v_lshl_add_u32 v26, v22, 3, v25
    v_cmp_gt_u32 vcc, 8, v25
    v_add_u32 v31, 8, v25
    v_lshl_add_u32 v31, v22, 6, v31
    v_cndmask_b32 v26, v31, v26, vcc
    v_cmp_gt_u32 vcc, 10, v25
    v_mov_b32 v31, 255
    s_nop 0
    v_cndmask_b32 v26, v31, v26, vcc
    v_lshlrev_b32 v27, 3, v17
    v_sub_u32 v242, v26, v27
    v_accvgpr_write_b32 a125, 0
    v_accvgpr_write_b32 a126, 0
    v_accvgpr_write_b32 a127, 0
    v_accvgpr_write_b32 a129, 0
    v_accvgpr_write_b32 a130, 0
    v_accvgpr_write_b32 a131, 0
    v_accvgpr_write_b32 a133, 0
    v_accvgpr_write_b32 a134, 0
    v_accvgpr_write_b32 a135, 0
    s_add_u32 m0, s3, 17440
    s_add_u32 s60, s60, 9216
    buffer_load_dwordx4 v213, s[4:7], s60 offen lds
    s_add_u32 m0, s3, 18464
    s_add_u32 s60, s60, 9216
    buffer_load_dwordx4 v212, s[4:7], s60 offen lds
    s_add_u32 m0, s3, 19488
    s_add_u32 s60, s60, 9216
    buffer_load_dwordx4 v213, s[4:7], s60 offen lds
    s_add_u32 m0, s3, 20512
    s_add_u32 s60, s60, 9216
    buffer_load_dwordx4 v212, s[4:7], s60 offen lds
    s_add_u32 m0, s3, 21536
    s_add_u32 s60, s60, 9216
    buffer_load_dwordx4 v213, s[4:7], s60 offen lds
    s_add_u32 m0, s3, 22560
    s_add_u32 s60, s60, 9216
    buffer_load_dwordx4 v212, s[4:7], s60 offen lds
    s_add_u32 m0, s3, 23584
    s_add_u32 s60, s60, 9216
    buffer_load_dwordx4 v213, s[4:7], s60 offen lds
    s_add_u32 s100, s100, 1
    s_cmp_eq_u32 s100, 9
    s_cselect_b32 s100, 0, s100
    s_waitcnt vmcnt(21)
    v_lshlrev_b32 v96, 16, v224
    v_and_b32 v97, 0xffff0000, v224
    s_waitcnt vmcnt(20)
    v_lshlrev_b32 v98, 16, v225
    v_and_b32 v99, 0xffff0000, v225
    s_waitcnt vmcnt(19)
    v_lshlrev_b32 v100, 16, v226
    v_and_b32 v101, 0xffff0000, v226
    s_waitcnt vmcnt(18)
    v_lshlrev_b32 v102, 16, v227
    v_and_b32 v103, 0xffff0000, v227
    s_waitcnt vmcnt(17)
    v_lshlrev_b32 v104, 16, v228
    v_and_b32 v105, 0xffff0000, v228
    s_waitcnt vmcnt(16)
    v_lshlrev_b32 v106, 16, v229
    v_and_b32 v107, 0xffff0000, v229
    s_waitcnt vmcnt(15)
    v_lshlrev_b32 v108, 16, v230
    v_and_b32 v109, 0xffff0000, v230
    s_waitcnt vmcnt(14)
    v_lshlrev_b32 v110, 16, v231
    v_and_b32 v111, 0xffff0000, v231
    s_waitcnt vmcnt(13)
    v_lshlrev_b32 v112, 16, v232
    v_and_b32 v113, 0xffff0000, v232
    v_cmp_eq_u32 vcc, v14, v13
    v_mov_b32 v12, 0x3f803f80
    s_nop 0
    v_cndmask_b32 v232, v243, v12, vcc
    v_cndmask_b32 v233, v243, v12, vcc
    v_cndmask_b32 v234, v243, v12, vcc
    v_cndmask_b32 v235, v243, v12, vcc
    v_mov_b32 v225, 0
    v_mov_b32 v227, 0
    v_mov_b32 v229, 0
    v_add_f32 v216, v96, v98
    v_add_f32 v217, v97, v99
    v_add_f32 v216, v216, v100
    v_add_f32 v217, v217, v101
    v_add_f32 v216, v216, v102
    v_add_f32 v217, v217, v103
    v_add_f32 v216, v216, v104
    v_add_f32 v217, v217, v105
    v_add_f32 v216, v216, v106
    v_add_f32 v217, v217, v107
    v_add_f32 v216, v216, v108
    v_add_f32 v217, v217, v109
    v_add_f32 v216, v216, v110
    v_add_f32 v217, v217, v111
    v_add_f32 v216, v216, v112
    v_add_f32 v217, v217, v113
    v_add_f32 v216, v216, v217
    s_nop 1
    v_add_f32_dpp v216, v216, v216 row_ror:8 row_mask:0xf bank_mask:0xf
    s_nop 1
    v_add_f32_dpp v216, v216, v216 row_ror:4 row_mask:0xf bank_mask:0xf
    s_nop 1
    v_add_f32_dpp v216, v216, v216 row_ror:2 row_mask:0xf bank_mask:0xf
    s_nop 1
    v_add_f32_dpp v216, v216, v216 row_ror:1 row_mask:0xf bank_mask:0xf
    v_mov_b32 v217, v216
    s_nop 1
    v_permlane16_swap_b32 v216, v217
    v_add_f32 v216, v216, v217
    v_mul_f32 v216, 0x3ae38e39, v216
    v_sub_f32 v96, v96, v216
    v_sub_f32 v97, v97, v216
    v_sub_f32 v98, v98, v216
    v_sub_f32 v99, v99, v216
    v_sub_f32 v100, v100, v216
    v_sub_f32 v101, v101, v216
    v_sub_f32 v102, v102, v216
    v_sub_f32 v103, v103, v216
    v_sub_f32 v104, v104, v216
    v_sub_f32 v105, v105, v216
    v_sub_f32 v106, v106, v216
    v_sub_f32 v107, v107, v216
    v_sub_f32 v108, v108, v216
    v_sub_f32 v109, v109, v216
    v_sub_f32 v110, v110, v216
    v_sub_f32 v111, v111, v216
    v_sub_f32 v112, v112, v216
    v_sub_f32 v113, v113, v216
    v_mul_f32 v118, v96, v96
    v_mul_f32 v119, v97, v97
    v_fmac_f32 v118, v98, v98
    v_fmac_f32 v119, v99, v99
    v_fmac_f32 v118, v100, v100
    v_fmac_f32 v119, v101, v101
    v_fmac_f32 v118, v102, v102
    v_fmac_f32 v119, v103, v103
    v_fmac_f32 v118, v104, v104
    v_fmac_f32 v119, v105, v105
    v_fmac_f32 v118, v106, v106
    v_fmac_f32 v119, v107, v107
    v_fmac_f32 v118, v108, v108
    v_fmac_f32 v119, v109, v109
    v_fmac_f32 v118, v110, v110
    v_fmac_f32 v119, v111, v111
    v_fmac_f32 v118, v112, v112
    v_fmac_f32 v119, v113, v113
    v_add_f32 v118, v118, v119
    s_nop 1
    v_add_f32_dpp v118, v118, v118 row_ror:8 row_mask:0xf bank_mask:0xf
    s_nop 1
    v_add_f32_dpp v118, v118, v118 row_ror:4 row_mask:0xf bank_mask:0xf
    s_nop 1
    v_add_f32_dpp v118, v118, v118 row_ror:2 row_mask:0xf bank_mask:0xf
    s_nop 1
    v_add_f32_dpp v118, v118, v118 row_ror:1 row_mask:0xf bank_mask:0xf
    v_mov_b32 v119, v118
    s_nop 1
    v_permlane16_swap_b32 v118, v119
    v_add_f32 v118, v118, v119
    v_mul_f32 v118, 0x3ae38e39, v118
    v_cvt_pk_bf16_f32 v216, v216, v216
    v_and_b32 v216, 0xffff0000, v216
    v_cvt_pk_bf16_f32 v118, v118, v118
    v_and_b32 v118, 0xffff0000, v118
    v_add_f32 v118, 0x3727c5ac, v118
    v_cvt_pk_bf16_f32 v118, v118, v118
    v_and_b32 v118, 0xffff0000, v118
    v_sqrt_f32 v118, v118
    s_nop 0
    v_cvt_pk_bf16_f32 v118, v118, v118
    v_and_b32 v118, 0xffff0000, v118
    v_rcp_f32 v217, v118
    s_cmp_ge_u32 s63, 18
    s_cbranch_scc1 LP_nofl
    s_add_u32 m0, s44, 158352
    s_mul_i32 s60, s38, 648
    buffer_load_dwordx4 v6, s[28:31], s60 offen lds
    v_mul_u32_u24 v20, 7282, v1
    v_lshrrev_b32 v20, 16, v20
    v_mul_u32_u24 v21, 9, v20
    v_sub_u32 v21, v1, v21
    v_mul_u32_u24 v20, 3456, v20
    v_lshl_add_u32 v20, v21, 2, v20
    s_mul_i32 s60, s63, 110592
    s_mul_i32 s41, s38, 36
    s_add_u32 s60, s60, s41
    s_add_u32 m0, s40, 0
    s_add_u32 s41, s60, 0
    buffer_load_dword v20, s[24:27], s41 offen lds
    s_add_u32 m0, s40, 252
    s_add_u32 s41, s60, 24192
    buffer_load_dword v20, s[24:27], s41 offen lds
    s_add_u32 m0, s40, 504
    s_add_u32 s41, s60, 48384
    buffer_load_dword v20, s[24:27], s41 offen lds
    s_add_u32 m0, s40, 756
    s_add_u32 s41, s60, 72576
    buffer_load_dword v20, s[24:27], s41 offen lds
    s_add_u32 m0, s40, 1008
    s_add_u32 s41, s60, 96768
    buffer_load_dword v20, s[24:27], s41 offen lds
    s_add_u32 m0, s40, 1152
    s_add_u32 s41, s60, 1152
    buffer_load_dword v20, s[24:27], s41 offen lds
    s_add_u32 m0, s40, 1404
    s_add_u32 s41, s60, 25344
    buffer_load_dword v20, s[24:27], s41 offen lds
    s_add_u32 m0, s40, 1656
    s_add_u32 s41, s60, 49536
    buffer_load_dword v20, s[24:27], s41 offen lds
    s_add_u32 m0, s40, 1908
    s_add_u32 s41, s60, 73728
    buffer_load_dword v20, s[24:27], s41 offen lds
    s_add_u32 m0, s40, 2160
    s_add_u32 s41, s60, 97920
    buffer_load_dword v20, s[24:27], s41 offen lds
    s_add_u32 m0, s40, 2304
    s_add_u32 s41, s60, 2304
    buffer_load_dword v20, s[24:27], s41 offen lds
    s_add_u32 m0, s40, 2556
    s_add_u32 s41, s60, 26496
    buffer_load_dword v20, s[24:27], s41 offen lds
    s_add_u32 m0, s40, 2808
    s_add_u32 s41, s60, 50688
    buffer_load_dword v20, s[24:27], s41 offen lds
    s_add_u32 m0, s40, 3060
    s_add_u32 s41, s60, 74880
    buffer_load_dword v20, s[24:27], s41 offen lds
    s_add_u32 m0, s40, 3312
    s_add_u32 s41, s60, 99072
    buffer_load_dword v20, s[24:27], s41 offen lds
LP_nofl:
    v_mov_b32 v221, s81
    s_add_u32 s24, s82, 4718592
    s_addc_u32 s25, s83, 0
    s_mov_b32 s26, 147456
    s_mov_b32 s27, 0x20000
    s_add_u32 s28, s82, 4980736
    s_addc_u32 s29, s83, 0
    s_mov_b32 s30, 2359296
    s_mov_b32 s31, 0x20000
    s_mul_i32 s60, s100, 589824
    s_add_u32 s60, s60, s45
    s_add_u32 m0, s56, 49184
    s_nop 0
    buffer_load_dwordx4 v214, s[12:15], s60 offen lds
    s_add_u32 m0, s56, 57408
    s_nop 0
    buffer_load_dwordx4 v214, s[16:19], s60 offen lds
    s_add_u32 m0, s56, 50208
    s_add_u32 s60, s60, 73728
    buffer_load_dwordx4 v214, s[12:15], s60 offen lds
    s_add_u32 m0, s56, 58432
    s_nop 0
    buffer_load_dwordx4 v214, s[16:19], s60 offen lds
    s_add_u32 m0, s3, 65600
    s_lshl_b32 s60, s100, 7
    buffer_load_dwordx4 v212, s[4:7], s60 offen lds
    s_add_u32 m0, s3, 66624
    s_add_u32 s60, s60, 9216
    buffer_load_dwordx4 v213, s[4:7], s60 offen lds
    s_add_u32 m0, s3, 67648
    s_add_u32 s60, s60, 9216
    buffer_load_dwordx4 v212, s[4:7], s60 offen lds
    s_add_u32 m0, s3, 68672
    s_add_u32 s60, s60, 9216
    buffer_load_dwordx4 v213, s[4:7], s60 offen lds
    s_add_u32 m0, s3, 69696
    s_add_u32 s60, s60, 9216
    buffer_load_dwordx4 v212, s[4:7], s60 offen lds
    s_add_u32 m0, s3, 70720
    s_add_u32 s60, s60, 9216
    buffer_load_dwordx4 v213, s[4:7], s60 offen lds
    s_add_u32 m0, s3, 71744
    s_add_u32 s60, s60, 9216
    buffer_load_dwordx4 v212, s[4:7], s60 offen lds
    s_add_u32 m0, s3, 72768
    s_add_u32 s60, s60, 9216
    buffer_load_dwordx4 v213, s[4:7], s60 offen lds
    s_add_u32 s100, s100, 1
    s_cmp_eq_u32 s100, 9
    s_cselect_b32 s100, 0, s100
    s_waitcnt vmcnt(12)
    ds_read_b128 a[0:3], v208 offset:0
    ds_read_b128 a[144:147], v208 offset:4096
    ds_read_b128 a[4:7], v209 offset:0
    ds_read_b128 a[148:151], v209 offset:4096
    ds_read_b128 a[8:11], v210 offset:0
    ds_read_b128 a[152:155], v210 offset:4096
    ds_read_b128 a[12:15], v211 offset:0
    ds_read_b128 a[156:159], v211 offset:4096
    s_waitcnt lgkmcnt(0)
    s_barrier
    ds_read_b64_tr_b16 v[176:177], v8 offset:0
    ds_read_b64_tr_b16 v[178:179], v8 offset:256
    ds_read_b64_tr_b16 v[180:181], v8 offset:32
    ds_read_b64_tr_b16 v[182:183], v8 offset:288
    ds_read_b64_tr_b16 v[184:185], v8 offset:512
    ds_read_b64_tr_b16 v[186:187], v8 offset:768
    ds_read_b64_tr_b16 v[188:189], v8 offset:544
    ds_read_b64_tr_b16 v[190:191], v8 offset:800
    s_waitcnt lgkmcnt(6)
    v_mfma_f32_16x16x32_bf16 v[192:195], v[232:235], v[176:179], 0
    s_mul_i32 s60, s100, 589824
    v_mfma_f32_32x32x16_bf16 v[48:63], v[176:179], a[0:3], 0
    s_add_u32 s60, s60, s45
    s_add_u32 m0, s56, 98368
    v_mfma_f32_32x32x16_bf16 v[64:79], v[176:179], a[144:147], 0
    s_waitcnt lgkmcnt(4)
    ds_read_b64_tr_b16 v[176:177], v9 offset:0
    ds_read_b64_tr_b16 v[178:179], v9 offset:256
    s_nop 0
    v_mfma_f32_16x16x32_bf16 v[196:199], v[232:235], v[180:183], 0
    buffer_load_dwordx4 v214, s[12:15], s60 offen lds
    v_mfma_f32_32x32x16_bf16 v[80:95], v[180:183], a[0:3], 0
    s_add_u32 m0, s56, 106592
    v_mfma_f32_32x32x16_bf16 v[96:111], v[180:183], a[144:147], 0
    s_waitcnt lgkmcnt(4)
    ds_read_b64_tr_b16 v[180:181], v9 offset:32
    ds_read_b64_tr_b16 v[182:183], v9 offset:288
    s_nop 0
    buffer_load_dwordx4 v214, s[16:19], s60 offen lds
    v_mfma_f32_16x16x32_bf16 v[200:203], v[232:235], v[184:187], 0
    v_mfma_f32_32x32x16_bf16 v[112:127], v[184:187], a[0:3], 0
    s_add_u32 m0, s56, 99392
    s_add_u32 s60, s60, 73728
    v_mfma_f32_32x32x16_bf16 v[128:143], v[184:187], a[144:147], 0
    s_waitcnt lgkmcnt(4)
    ds_read_b64_tr_b16 v[184:185], v9 offset:512
    ds_read_b64_tr_b16 v[186:187], v9 offset:768
    buffer_load_dwordx4 v214, s[12:15], s60 offen lds
    v_mfma_f32_16x16x32_bf16 v[204:207], v[232:235], v[188:191], 0
    s_add_u32 m0, s56, 107616
    v_mfma_f32_32x32x16_bf16 v[144:159], v[188:191], a[0:3], 0
    s_nop 0
    v_mfma_f32_32x32x16_bf16 v[160:175], v[188:191], a[144:147], 0
    s_waitcnt lgkmcnt(4)
    ds_read_b64_tr_b16 v[188:189], v9 offset:544
    ds_read_b64_tr_b16 v[190:191], v9 offset:800
    buffer_load_dwordx4 v214, s[16:19], s60 offen lds
    v_mfma_f32_32x32x16_bf16 v[48:63], v[176:179], a[4:7], v[48:63]
    s_add_u32 m0, s3, 114784
    s_waitcnt vmcnt(12)
    v_add_u32 v32, 0, v247
    ds_read2_b32 a[112:113], v32 offset0:0 offset1:1
    ds_read2_b32 a[114:115], v32 offset0:2 offset1:3
    ds_read_b32 a124, v246 offset:32
    v_add_u32 v32, 1152, v247
    v_mfma_f32_32x32x16_bf16 v[64:79], v[176:179], a[148:151], v[64:79]
    s_waitcnt lgkmcnt(7)
    ds_read_b64_tr_b16 v[176:177], v10 offset:0
    ds_read_b64_tr_b16 v[178:179], v10 offset:256
    s_lshl_b32 s60, s100, 7
    buffer_load_dwordx4 v212, s[4:7], s60 offen lds
    ds_read2_b32 a[116:117], v32 offset0:0 offset1:1
    v_mfma_f32_32x32x16_bf16 v[80:95], v[180:183], a[4:7], v[80:95]
    ds_read2_b32 a[118:119], v32 offset0:2 offset1:3
    ds_read_b32 a128, v246 offset:1184
    v_add_u32 v32, 2304, v247
    ds_read2_b32 a[120:121], v32 offset0:0 offset1:1
    ds_read2_b32 a[122:123], v32 offset0:2 offset1:3
    v_mfma_f32_32x32x16_bf16 v[96:111], v[180:183], a[148:151], v[96:111]
    s_waitcnt lgkmcnt(12)
    ds_read_b64_tr_b16 v[180:181], v10 offset:32
    ds_read_b64_tr_b16 v[182:183], v10 offset:288
    s_add_u32 m0, s3, 115808
    s_add_u32 s60, s60, 9216
    v_mfma_f32_32x32x16_bf16 v[112:127], v[184:187], a[4:7], v[112:127]
    buffer_load_dwordx4 v213, s[4:7], s60 offen lds
    ds_read_b32 a132, v246 offset:2336
    s_lshl_b32 s41, s63, 11
    s_add_u32 s41, s80, s41
    s_sub_u32 s41, s41, s44
    v_mfma_f32_32x32x16_bf16 v[128:143], v[184:187], a[148:151], v[128:143]
    s_waitcnt lgkmcnt(13)
    ds_read_b64_tr_b16 v[184:185], v10 offset:512
    ds_read_b64_tr_b16 v[186:187], v10 offset:768
    s_add_u32 m0, s3, 116832
    s_lshl_b32 s43, s63, 8
    s_add_u32 s43, s43, s62
    v_mfma_f32_32x32x16_bf16 v[144:159], v[188:191], a[4:7], v[144:159]
    s_add_u32 s60, s60, 9216
    buffer_load_dwordx4 v212, s[4:7], s60 offen lds
    s_cmp_lt_u32 s63, 18
    s_cselect_b32 s41, s41, 2146435072
    s_cselect_b32 s43, s43, 2146435072
    s_add_u32 s42, s41, 36864
    v_mfma_f32_32x32x16_bf16 v[160:175], v[188:191], a[148:151], v[160:175]
    s_waitcnt lgkmcnt(10)
    ds_read_b64_tr_b16 v[188:189], v10 offset:544
    ds_read_b64_tr_b16 v[190:191], v10 offset:800
    v_mov_b32 v21, 0
    v_mov_b32 v22, 0
    v_mov_b32 v23, 0
    v_mov_b32 v29, 0
    v_mfma_f32_32x32x16_bf16 v[48:63], v[176:179], a[8:11], v[48:63]
    s_add_u32 m0, s3, 117856
    s_add_u32 s60, s60, 9216
    v_mov_b32 v30, 0
    v_mov_b32 v31, 0
    ds_read_u16 v32, v236 offset:0
    ds_read_u16 v33, v236 offset:36
    ds_read_u16 v34, v236 offset:72
    v_mfma_f32_32x32x16_bf16 v[64:79], v[176:179], a[152:155], v[64:79]
    s_waitcnt lgkmcnt(8)
    ds_read_b64_tr_b16 v[176:177], v11 offset:0
    ds_read_b64_tr_b16 v[178:179], v11 offset:256
    buffer_load_dwordx4 v213, s[4:7], s60 offen lds
    ds_read_u16 v35, v236 offset:108
    s_waitcnt vmcnt(8)
    v_mfma_f32_32x32x16_bf16 v[80:95], v[180:183], a[8:11], v[80:95]
    s_add_u32 m0, s3, 118880
    ds_read_u16 v36, v236 offset:144
    ds_read_u16 v37, v236 offset:180
    ds_read_u16 v38, v236 offset:216
    ds_read_u16 v39, v236 offset:252
    v_mfma_f32_32x32x16_bf16 v[96:111], v[180:183], a[152:155], v[96:111]
    s_waitcnt lgkmcnt(12)
    ds_read_b64_tr_b16 v[180:181], v11 offset:32
    ds_read_b64_tr_b16 v[182:183], v11 offset:288
    s_add_u32 s60, s60, 9216
    v_add_u32 v208, 49184, v208
    v_mfma_f32_32x32x16_bf16 v[112:127], v[184:187], a[8:11], v[112:127]
    buffer_load_dwordx4 v212, s[4:7], s60 offen lds
    ds_read_b128 a[16:19], v208 offset:0
    s_waitcnt lgkmcnt(14)
    ds_read_b128 a[160:163], v208 offset:4096
    s_waitcnt lgkmcnt(14)
    ds_read_u16 v40, v238 offset:576
    s_waitcnt lgkmcnt(14)
    ds_read_u16 v41, v238 offset:612
    v_mfma_f32_32x32x16_bf16 v[128:143], v[184:187], a[152:155], v[128:143]
    s_waitcnt lgkmcnt(14)
    ds_read_b64_tr_b16 v[184:185], v11 offset:512
    s_waitcnt lgkmcnt(14)
    ds_read_b64_tr_b16 v[186:187], v11 offset:768
    s_add_u32 m0, s3, 119904
    v_add_u32 v209, 49184, v209
    v_cmp_eq_u32 vcc, 0, v241
    v_mfma_f32_32x32x16_bf16 v[144:159], v[188:191], a[8:11], v[144:159]
    s_add_u32 s60, s60, 9216
    buffer_load_dwordx4 v213, s[4:7], s60 offen lds
    s_waitcnt lgkmcnt(14)
    ds_read_b128 a[20:23], v209 offset:0
    s_waitcnt lgkmcnt(14)
    ds_read_b128 a[164:167], v209 offset:4096
    v_lshl_or_b32 v32, v33, 16, v32
    v_mfma_f32_32x32x16_bf16 v[160:175], v[188:191], a[152:155], v[160:175]
    s_waitcnt lgkmcnt(14)
    ds_read_b64_tr_b16 v[188:189], v11 offset:544
    s_waitcnt lgkmcnt(14)
    ds_read_b64_tr_b16 v[190:191], v11 offset:800
    v_add_u32 v210, 49184, v210
    s_waitcnt lgkmcnt(14)
    ds_read_b128 a[24:27], v210 offset:0
    v_lshl_or_b32 v33, v35, 16, v34
    v_mfma_f32_32x32x16_bf16 v[48:63], v[176:179], a[12:15], v[48:63]
    s_add_u32 m0, s3, 120928
    s_add_u32 s60, s60, 9216
    s_waitcnt lgkmcnt(14)
    ds_read_b128 a[168:171], v210 offset:4096
    v_lshl_or_b32 v34, v37, 16, v36
    s_waitcnt lgkmcnt(14)
    v_lshl_or_b32 v35, v39, 16, v38
    v_mfma_f32_32x32x16_bf16 v[64:79], v[176:179], a[156:159], v[64:79]
    s_waitcnt lgkmcnt(12)
    buffer_load_dwordx4 v212, s[4:7], s60 offen lds
    v_add_u32 v211, 49184, v211
    ds_read_b128 a[28:31], v211 offset:0
    s_waitcnt lgkmcnt(9)
    v_lshl_or_b32 v36, v41, 16, v40
    v_cndmask_b32 v36, v243, v36, vcc
    ds_read_b128 a[172:175], v211 offset:4096
    v_mfma_f32_32x32x16_bf16 v[80:95], v[180:183], a[12:15], v[80:95]
    s_waitcnt lgkmcnt(0)
    s_barrier
    v_add_u32 v8, 49184, v8
    ds_read_b64_tr_b16 v[176:177], v8 offset:0
    ds_read_b64_tr_b16 v[178:179], v8 offset:256
    v_cmp_gt_u32 vcc, 9, v240
    v_mfma_f32_32x32x16_bf16 v[96:111], v[180:183], a[156:159], v[96:111]
    ds_read_b64_tr_b16 v[180:181], v8 offset:32
    ds_read_b64_tr_b16 v[182:183], v8 offset:288
    s_add_u32 m0, s3, 121952
    s_add_u32 s60, s60, 9216
    s_nop 0
    v_mfma_f32_32x32x16_bf16 v[112:127], v[184:187], a[12:15], v[112:127]
    buffer_load_dwordx4 v213, s[4:7], s60 offen lds
    v_cndmask_b32 v16, v243, v32, vcc
    v_cndmask_b32 v17, v243, v33, vcc
    v_cndmask_b32 v18, v243, v34, vcc
    v_cndmask_b32 v19, v243, v35, vcc
    v_mfma_f32_32x32x16_bf16 v[128:143], v[184:187], a[156:159], v[128:143]
    ds_read_b64_tr_b16 v[184:185], v8 offset:512
    ds_read_b64_tr_b16 v[186:187], v8 offset:768
    s_add_u32 s100, s100, 1
    s_cmp_eq_u32 s100, 9
    s_cselect_b32 s100, 0, s100
    v_cndmask_b32 v20, v243, v36, vcc
    v_mfma_f32_32x32x16_bf16 v[144:159], v[188:191], a[12:15], v[144:159]
    v_cndmask_b32 v24, v32, v243, vcc
    v_cndmask_b32 v25, v33, v243, vcc
    v_cndmask_b32 v26, v34, v243, vcc
    v_cndmask_b32 v27, v35, v243, vcc
    v_cndmask_b32 v28, v36, v243, vcc
    v_mfma_f32_32x32x16_bf16 v[160:175], v[188:191], a[156:159], v[160:175]
    s_waitcnt lgkmcnt(4)
    ds_read_b64_tr_b16 v[188:189], v8 offset:544
    ds_read_b64_tr_b16 v[190:191], v8 offset:800
    v_mfma_f32_32x32x16_bf16 v[32:47], a[112:115], v[16:19], 0
    v_mfma_f32_16x16x32_bf16 v[192:195], v[232:235], v[176:179], v[192:195]
    s_mul_i32 s60, s100, 589824
    v_mfma_f32_32x32x16_bf16 v[48:63], v[176:179], a[16:19], v[48:63]
    s_add_u32 s60, s60, s45
    s_add_u32 m0, s56, 0
    v_mfma_f32_32x32x16_bf16 v[64:79], v[176:179], a[160:163], v[64:79]
    s_waitcnt lgkmcnt(4)
    v_add_u32 v9, 49184, v9
    ds_read_b64_tr_b16 v[176:177], v9 offset:0
    ds_read_b64_tr_b16 v[178:179], v9 offset:256
    s_nop 0
    v_mfma_f32_32x32x16_bf16 v[32:47], a[124:127], v[20:23], v[32:47]
    v_mfma_f32_16x16x32_bf16 v[196:199], v[232:235], v[180:183], v[196:199]
    buffer_load_dwordx4 v214, s[12:15], s60 offen lds
    v_mfma_f32_32x32x16_bf16 v[80:95], v[180:183], a[16:19], v[80:95]
    s_add_u32 m0, s56, 8224
    v_mfma_f32_32x32x16_bf16 v[96:111], v[180:183], a[160:163], v[96:111]
    s_waitcnt lgkmcnt(4)
    ds_read_b64_tr_b16 v[180:181], v9 offset:32
    ds_read_b64_tr_b16 v[182:183], v9 offset:288
    s_nop 0
    buffer_load_dwordx4 v214, s[16:19], s60 offen lds
    v_mfma_f32_16x16x32_bf16 v[200:203], v[232:235], v[184:187], v[200:203]
    v_mfma_f32_32x32x16_bf16 v[32:47], a[116:119], v[24:27], v[32:47]
    v_mfma_f32_32x32x16_bf16 v[112:127], v[184:187], a[16:19], v[112:127]
    s_add_u32 m0, s56, 1024
    s_add_u32 s60, s60, 73728
    v_mfma_f32_32x32x16_bf16 v[128:143], v[184:187], a[160:163], v[128:143]
    s_waitcnt lgkmcnt(4)
    ds_read_b64_tr_b16 v[184:185], v9 offset:512
    ds_read_b64_tr_b16 v[186:187], v9 offset:768
    buffer_load_dwordx4 v214, s[12:15], s60 offen lds
    v_mfma_f32_16x16x32_bf16 v[204:207], v[232:235], v[188:191], v[204:207]
    s_add_u32 m0, s56, 9248
    v_mfma_f32_32x32x16_bf16 v[32:47], a[128:131], v[28:31], v[32:47]
    v_mfma_f32_32x32x16_bf16 v[144:159], v[188:191], a[16:19], v[144:159]
    s_nop 0
    v_mfma_f32_32x32x16_bf16 v[160:175], v[188:191], a[160:163], v[160:175]
    s_waitcnt lgkmcnt(4)
    ds_read_b64_tr_b16 v[188:189], v9 offset:544
    ds_read_b64_tr_b16 v[190:191], v9 offset:800
    buffer_load_dwordx4 v214, s[16:19], s60 offen lds
    v_mfma_f32_32x32x16_bf16 v[48:63], v[176:179], a[20:23], v[48:63]
    s_add_u32 m0, s3, 16416
    buffer_load_dwordx2 v[222:223], v221, s[20:23], 0 offen sc1
    v_mfma_f32_32x32x16_bf16 v[64:79], v[176:179], a[164:167], v[64:79]
    s_waitcnt lgkmcnt(4)
    v_add_u32 v10, 49184, v10
    ds_read_b64_tr_b16 v[176:177], v10 offset:0
    ds_read_b64_tr_b16 v[178:179], v10 offset:256
    s_lshl_b32 s60, s100, 7
    buffer_load_dwordx4 v212, s[4:7], s60 offen lds
    v_mfma_f32_32x32x16_bf16 v[80:95], v[180:183], a[20:23], v[80:95]
    v_cvt_pk_bf16_f32 v248, v32, v33
    v_cvt_pk_bf16_f32 v249, v34, v35
    v_cvt_pk_bf16_f32 v250, v36, v37
    v_cvt_pk_bf16_f32 v251, v38, v39
    v_cvt_pk_bf16_f32 v252, v40, v41
    v_cvt_pk_bf16_f32 v253, v42, v43
    v_mfma_f32_32x32x16_bf16 v[96:111], v[180:183], a[164:167], v[96:111]
    s_waitcnt lgkmcnt(4)
    ds_read_b64_tr_b16 v[180:181], v10 offset:32
    ds_read_b64_tr_b16 v[182:183], v10 offset:288
    s_add_u32 m0, s3, 17440
    s_add_u32 s60, s60, 9216
    v_mfma_f32_32x32x16_bf16 v[112:127], v[184:187], a[20:23], v[112:127]
    buffer_load_dwordx4 v213, s[4:7], s60 offen lds
    v_cvt_pk_bf16_f32 v254, v44, v45
    v_cvt_pk_bf16_f32 v255, v46, v47
    buffer_store_dwordx4 v[248:251], v6, s[8:11], s41 offen offset:0 sc1
    v_mfma_f32_32x32x16_bf16 v[128:143], v[184:187], a[164:167], v[128:143]
    s_waitcnt lgkmcnt(4)
    ds_read_b64_tr_b16 v[184:185], v10 offset:512
    ds_read_b64_tr_b16 v[186:187], v10 offset:768
    s_add_u32 m0, s3, 18464
    buffer_store_dwordx4 v[252:255], v6, s[8:11], s41 offen offset:1024 sc1
    ds_read_u16 v32, v237 offset:0
    v_mfma_f32_32x32x16_bf16 v[144:159], v[188:191], a[20:23], v[144:159]
    s_add_u32 s60, s60, 9216
    buffer_load_dwordx4 v212, s[4:7], s60 offen lds
    ds_read_u16 v33, v237 offset:36
    ds_read_u16 v34, v237 offset:72
    ds_read_u16 v35, v237 offset:108
    v_mfma_f32_32x32x16_bf16 v[160:175], v[188:191], a[164:167], v[160:175]
    s_waitcnt lgkmcnt(8)
    ds_read_b64_tr_b16 v[188:189], v10 offset:544
    ds_read_b64_tr_b16 v[190:191], v10 offset:800
    ds_read_u16 v36, v237 offset:144
    ds_read_u16 v37, v237 offset:180
    ds_read_u16 v38, v237 offset:216
    v_mfma_f32_32x32x16_bf16 v[48:63], v[176:179], a[24:27], v[48:63]
    s_add_u32 m0, s3, 19488
    s_add_u32 s60, s60, 9216
    ds_read_u16 v39, v237 offset:252
    ds_read_u16 v40, v239 offset:576
    s_waitcnt lgkmcnt(14)
    ds_read_u16 v41, v239 offset:612
    v_mfma_f32_32x32x16_bf16 v[64:79], v[176:179], a[168:171], v[64:79]
    s_waitcnt lgkmcnt(14)
    v_add_u32 v11, 49184, v11
    ds_read_b64_tr_b16 v[176:177], v11 offset:0
    s_waitcnt lgkmcnt(14)
    ds_read_b64_tr_b16 v[178:179], v11 offset:256
    buffer_load_dwordx4 v213, s[4:7], s60 offen lds
    s_waitcnt vmcnt(11)
    v_mfma_f32_32x32x16_bf16 v[80:95], v[180:183], a[24:27], v[80:95]
    s_add_u32 m0, s3, 20512
    v_mov_b32 v42, 0x3f80
    v_subrev_u32 v43, 0, v242
    v_lshlrev_b32 v44, 4, v43
    v_cmp_gt_u32 vcc, 2, v43
    v_lshlrev_b32 v44, v44, v42
    v_add_u32 v208, 49184, v208
    v_mfma_f32_32x32x16_bf16 v[96:111], v[180:183], a[168:171], v[96:111]
    s_waitcnt lgkmcnt(14)
    ds_read_b64_tr_b16 v[180:181], v11 offset:32
    s_waitcnt lgkmcnt(14)
    ds_read_b64_tr_b16 v[182:183], v11 offset:288
    s_add_u32 s60, s60, 9216
    v_cndmask_b32 v24, v243, v44, vcc
    v_subrev_u32 v43, 2, v242
    v_lshlrev_b32 v44, 4, v43
    v_mfma_f32_32x32x16_bf16 v[112:127], v[184:187], a[24:27], v[112:127]
    buffer_load_dwordx4 v212, s[4:7], s60 offen lds
    s_waitcnt lgkmcnt(14)
    ds_read_b128 a[32:35], v208 offset:0
    s_waitcnt lgkmcnt(14)
    ds_read_b128 a[176:179], v208 offset:4096
    v_cmp_gt_u32 vcc, 2, v43
    v_lshlrev_b32 v44, v44, v42
    v_mfma_f32_32x32x16_bf16 v[128:143], v[184:187], a[168:171], v[128:143]
    s_waitcnt lgkmcnt(12)
    ds_read_b64_tr_b16 v[184:185], v11 offset:512
    ds_read_b64_tr_b16 v[186:187], v11 offset:768
    s_add_u32 m0, s3, 21536
    v_add_u32 v209, 49184, v209
    ds_read_b128 a[36:39], v209 offset:0
    v_cndmask_b32 v25, v243, v44, vcc
    v_mfma_f32_32x32x16_bf16 v[144:159], v[188:191], a[24:27], v[144:159]
    s_add_u32 s60, s60, 9216
    buffer_load_dwordx4 v213, s[4:7], s60 offen lds
    s_waitcnt lgkmcnt(14)
    ds_read_b128 a[180:183], v209 offset:4096
    v_subrev_u32 v43, 4, v242
    v_lshlrev_b32 v44, 4, v43
    v_cmp_gt_u32 vcc, 2, v43
    v_mfma_f32_32x32x16_bf16 v[160:175], v[188:191], a[168:171], v[160:175]
    s_waitcnt lgkmcnt(8)
    ds_read_b64_tr_b16 v[188:189], v11 offset:544
    ds_read_b64_tr_b16 v[190:191], v11 offset:800
    v_add_u32 v210, 49184, v210
    ds_read_b128 a[40:43], v210 offset:0
    v_lshlrev_b32 v44, v44, v42
    v_cndmask_b32 v26, v243, v44, vcc
    v_mfma_f32_32x32x16_bf16 v[48:63], v[176:179], a[28:31], v[48:63]
    s_add_u32 m0, s3, 22560
    s_add_u32 s60, s60, 9216
    ds_read_b128 a[184:187], v210 offset:4096
    v_subrev_u32 v43, 6, v242
    v_lshlrev_b32 v44, 4, v43
    v_add_u32 v211, 49184, v211
    v_mfma_f32_32x32x16_bf16 v[64:79], v[176:179], a[172:175], v[64:79]
    s_waitcnt lgkmcnt(10)
    buffer_load_dwordx4 v212, s[4:7], s60 offen lds
    ds_read_b128 a[44:47], v211 offset:0
    v_cmp_gt_u32 vcc, 2, v43
    v_lshlrev_b32 v44, v44, v42
    ds_read_b128 a[188:191], v211 offset:4096
    v_mfma_f32_32x32x16_bf16 v[80:95], v[180:183], a[28:31], v[80:95]
    s_waitcnt lgkmcnt(0)
    s_barrier
    v_add_u32 v8, 49184, v8
    ds_read_b64_tr_b16 v[176:177], v8 offset:0
    ds_read_b64_tr_b16 v[178:179], v8 offset:256
    s_add_u32 m0, s3, 23584
    v_mfma_f32_32x32x16_bf16 v[96:111], v[180:183], a[172:175], v[96:111]
    ds_read_b64_tr_b16 v[180:181], v8 offset:32
    ds_read_b64_tr_b16 v[182:183], v8 offset:288
    s_add_u32 s60, s60, 9216
    v_cndmask_b32 v27, v243, v44, vcc
    v_subrev_u32 v43, 16, v242
    v_lshlrev_b32 v44, 4, v43
    v_mfma_f32_32x32x16_bf16 v[112:127], v[184:187], a[28:31], v[112:127]
    buffer_load_dwordx4 v213, s[4:7], s60 offen lds
    v_cmp_gt_u32 vcc, 2, v43
    v_lshlrev_b32 v44, v44, v42
    v_mfma_f32_32x32x16_bf16 v[128:143], v[184:187], a[172:175], v[128:143]
    ds_read_b64_tr_b16 v[184:185], v8 offset:512
    ds_read_b64_tr_b16 v[186:187], v8 offset:768
    s_add_u32 s100, s100, 1
    s_cmp_eq_u32 s100, 9
    s_cselect_b32 s100, 0, s100
    v_cndmask_b32 v28, v243, v44, vcc
    v_mfma_f32_32x32x16_bf16 v[144:159], v[188:191], a[28:31], v[144:159]
    v_cmp_eq_u32 vcc, 0, v241
    v_lshl_or_b32 v32, v33, 16, v32
    v_lshl_or_b32 v33, v35, 16, v34
    v_lshl_or_b32 v34, v37, 16, v36
    v_lshl_or_b32 v35, v39, 16, v38
    v_lshl_or_b32 v36, v41, 16, v40
    v_mfma_f32_32x32x16_bf16 v[160:175], v[188:191], a[172:175], v[160:175]
    s_waitcnt lgkmcnt(4)
    ds_read_b64_tr_b16 v[188:189], v8 offset:544
    ds_read_b64_tr_b16 v[190:191], v8 offset:800
    v_cndmask_b32 v36, v243, v36, vcc
    v_cmp_gt_u32 vcc, 2, v240
    s_nop 0
    v_mfma_f32_16x16x32_bf16 v[192:195], v[232:235], v[176:179], v[192:195]
    s_mul_i32 s60, s100, 589824
    v_cndmask_b32 v16, v243, v32, vcc
    v_cndmask_b32 v17, v243, v33, vcc
    v_mfma_f32_32x32x16_bf16 v[48:63], v[176:179], a[32:35], v[48:63]
    s_add_u32 s60, s60, s45
    s_add_u32 m0, s56, 49184
    v_cndmask_b32 v18, v243, v34, vcc
    v_cndmask_b32 v19, v243, v35, vcc
    v_cndmask_b32 v20, v243, v36, vcc
    v_mfma_f32_32x32x16_bf16 v[64:79], v[176:179], a[176:179], v[64:79]
    s_waitcnt lgkmcnt(4)
    v_add_u32 v9, 49184, v9
    ds_read_b64_tr_b16 v[176:177], v9 offset:0
    ds_read_b64_tr_b16 v[178:179], v9 offset:256
    s_nop 0
    v_mfma_f32_32x32x16_bf16 v[32:47], a[116:119], v[16:19], 0
    v_mfma_f32_16x16x32_bf16 v[196:199], v[232:235], v[180:183], v[196:199]
    buffer_load_dwordx4 v214, s[12:15], s60 offen lds
    v_mfma_f32_32x32x16_bf16 v[80:95], v[180:183], a[32:35], v[80:95]
    s_add_u32 m0, s56, 57408
    v_mfma_f32_32x32x16_bf16 v[96:111], v[180:183], a[176:179], v[96:111]
    s_waitcnt lgkmcnt(4)
    ds_read_b64_tr_b16 v[180:181], v9 offset:32
    ds_read_b64_tr_b16 v[182:183], v9 offset:288
    s_nop 0
    buffer_load_dwordx4 v214, s[16:19], s60 offen lds
    v_mfma_f32_16x16x32_bf16 v[200:203], v[232:235], v[184:187], v[200:203]
    v_mfma_f32_32x32x16_bf16 v[32:47], a[128:131], v[20:23], v[32:47]
    v_mfma_f32_32x32x16_bf16 v[112:127], v[184:187], a[32:35], v[112:127]
    s_add_u32 m0, s56, 50208
    s_add_u32 s60, s60, 73728
    v_mfma_f32_32x32x16_bf16 v[128:143], v[184:187], a[176:179], v[128:143]
    s_waitcnt lgkmcnt(4)
    ds_read_b64_tr_b16 v[184:185], v9 offset:512
    ds_read_b64_tr_b16 v[186:187], v9 offset:768
    buffer_load_dwordx4 v214, s[12:15], s60 offen lds
    v_mfma_f32_16x16x32_bf16 v[204:207], v[232:235], v[188:191], v[204:207]
    s_add_u32 m0, s56, 58432
    v_mfma_f32_32x32x16_bf16 v[32:47], a[120:123], v[24:27], v[32:47]
    v_mfma_f32_32x32x16_bf16 v[144:159], v[188:191], a[32:35], v[144:159]
    s_nop 0
    v_mfma_f32_32x32x16_bf16 v[160:175], v[188:191], a[176:179], v[160:175]
    s_waitcnt lgkmcnt(4)
    ds_read_b64_tr_b16 v[188:189], v9 offset:544
    ds_read_b64_tr_b16 v[190:191], v9 offset:800
    buffer_load_dwordx4 v214, s[16:19], s60 offen lds
    v_mfma_f32_32x32x16_bf16 v[48:63], v[176:179], a[36:39], v[48:63]
    s_add_u32 m0, s3, 65600
    v_mfma_f32_32x32x16_bf16 v[32:47], a[132:135], v[28:31], v[32:47]
    v_mfma_f32_32x32x16_bf16 v[64:79], v[176:179], a[180:183], v[64:79]
    s_waitcnt lgkmcnt(4)
    v_add_u32 v10, 49184, v10
    ds_read_b64_tr_b16 v[176:177], v10 offset:0
    ds_read_b64_tr_b16 v[178:179], v10 offset:256
    s_lshl_b32 s60, s100, 7
    buffer_load_dwordx4 v212, s[4:7], s60 offen lds
    v_mfma_f32_32x32x16_bf16 v[80:95], v[180:183], a[36:39], v[80:95]
    v_mfma_f32_32x32x16_bf16 v[96:111], v[180:183], a[180:183], v[96:111]
    s_waitcnt lgkmcnt(4)
    ds_read_b64_tr_b16 v[180:181], v10 offset:32
    ds_read_b64_tr_b16 v[182:183], v10 offset:288
    s_add_u32 m0, s3, 66624
    s_add_u32 s60, s60, 9216
    v_cvt_pk_bf16_f32 v248, v32, v33
    v_mfma_f32_32x32x16_bf16 v[112:127], v[184:187], a[36:39], v[112:127]
    buffer_load_dwordx4 v213, s[4:7], s60 offen lds
    v_cvt_pk_bf16_f32 v249, v34, v35
    v_cvt_pk_bf16_f32 v250, v36, v37
    v_cvt_pk_bf16_f32 v251, v38, v39
    v_cvt_pk_bf16_f32 v252, v40, v41
    v_mfma_f32_32x32x16_bf16 v[128:143], v[184:187], a[180:183], v[128:143]
    s_waitcnt lgkmcnt(4)
    ds_read_b64_tr_b16 v[184:185], v10 offset:512
    ds_read_b64_tr_b16 v[186:187], v10 offset:768
    s_add_u32 m0, s3, 67648
    v_cvt_pk_bf16_f32 v253, v42, v43
    v_cvt_pk_bf16_f32 v254, v44, v45
    v_mfma_f32_32x32x16_bf16 v[144:159], v[188:191], a[36:39], v[144:159]
    s_add_u32 s60, s60, 9216
    buffer_load_dwordx4 v212, s[4:7], s60 offen lds
    v_cvt_pk_bf16_f32 v255, v46, v47
    buffer_store_dwordx4 v[248:251], v6, s[8:11], s42 offen offset:0 sc1
    v_mfma_f32_32x32x16_bf16 v[160:175], v[188:191], a[180:183], v[160:175]
    s_waitcnt lgkmcnt(4)
    ds_read_b64_tr_b16 v[188:189], v10 offset:544
    ds_read_b64_tr_b16 v[190:191], v10 offset:800
    buffer_store_dwordx4 v[252:255], v6, s[8:11], s42 offen offset:1024 sc1
    v_cmp_gt_u32 vcc, 16, v1
    v_mov_b32 v32, 2146435072
    v_mfma_f32_32x32x16_bf16 v[48:63], v[176:179], a[40:43], v[48:63]
    s_add_u32 m0, s3, 68672
    s_add_u32 s60, s60, 9216
    s_waitcnt vmcnt(9)
    v_add_u32 v208, 4294868928, v208
    ds_read_b128 a[48:51], v208 offset:0
    ds_read_b128 a[192:195], v208 offset:4096
    v_mov_b32 v20, 0
    v_mfma_f32_32x32x16_bf16 v[64:79], v[176:179], a[184:187], v[64:79]
    s_waitcnt lgkmcnt(6)
    v_add_u32 v11, 49184, v11
    ds_read_b64_tr_b16 v[176:177], v11 offset:0
    ds_read_b64_tr_b16 v[178:179], v11 offset:256
    buffer_load_dwordx4 v213, s[4:7], s60 offen lds
    v_cndmask_b32 v32, v32, v6, vcc
    v_mfma_f32_32x32x16_bf16 v[80:95], v[180:183], a[40:43], v[80:95]
    s_add_u32 m0, s3, 69696
    v_add_u32 v209, 4294868928, v209
    ds_read_b128 a[52:55], v209 offset:0
    buffer_store_dwordx4 v[20:23], v32, s[24:27], s43 offen sc1
    ds_read_b128 a[196:199], v209 offset:4096
    v_mfma_f32_32x32x16_bf16 v[96:111], v[180:183], a[184:187], v[96:111]
    s_waitcnt lgkmcnt(8)
    ds_read_b64_tr_b16 v[180:181], v11 offset:32
    ds_read_b64_tr_b16 v[182:183], v11 offset:288
    s_add_u32 s60, s60, 9216
    v_add_u32 v210, 4294868928, v210
    v_mfma_f32_32x32x16_bf16 v[112:127], v[184:187], a[40:43], v[112:127]
    s_lshl_b32 s40, s36, 3
    buffer_load_dwordx4 v212, s[4:7], s60 offen lds
    s_add_u32 s40, s40, 163488
    ds_read_b128 a[56:59], v210 offset:0
    v_mov_b32 v12, s40
    ds_read_b128 a[200:203], v210 offset:4096
    v_mfma_f32_32x32x16_bf16 v[128:143], v[184:187], a[184:187], v[128:143]
    s_waitcnt lgkmcnt(10)
    ds_read_b64_tr_b16 v[184:185], v11 offset:512
    ds_read_b64_tr_b16 v[186:187], v11 offset:768
    s_add_u32 m0, s3, 70720
    v_readfirstlane_b32 s40, v222
    s_nop 0
    s_or_b32 s40, s40, s36
    s_cbranch_scc0 LT_slow
LT_ok:
    v_mfma_f32_32x32x16_bf16 v[144:159], v[188:191], a[40:43], v[144:159]
    s_add_u32 s60, s60, 9216
    buffer_load_dwordx4 v213, s[4:7], s60 offen lds
    v_add_u32 v211, 4294868928, v211
    ds_read_b128 a[60:63], v211 offset:0
    ds_read_b128 a[204:207], v211 offset:4096
    v_mfma_f32_32x32x16_bf16 v[160:175], v[188:191], a[184:187], v[160:175]
    s_waitcnt lgkmcnt(10)
    ds_read_b64_tr_b16 v[188:189], v11 offset:544
    ds_read_b64_tr_b16 v[190:191], v11 offset:800
    ds_write_b64 v12, v[222:223]
    v_mfma_f32_32x32x16_bf16 v[48:63], v[176:179], a[44:47], v[48:63]
    s_add_u32 m0, s3, 71744
    s_add_u32 s60, s60, 9216
    v_mfma_f32_32x32x16_bf16 v[64:79], v[176:179], a[188:191], v[64:79]
    s_waitcnt lgkmcnt(9)
    buffer_load_dwordx4 v212, s[4:7], s60 offen lds
    v_mfma_f32_32x32x16_bf16 v[80:95], v[180:183], a[44:47], v[80:95]
    s_waitcnt lgkmcnt(0)
    s_barrier
    v_add_u32 v8, 4294868928, v8
    ds_read_b64_tr_b16 v[176:177], v8 offset:0
    ds_read_b64_tr_b16 v[178:179], v8 offset:256
    s_add_u32 m0, s3, 72768
    v_mfma_f32_32x32x16_bf16 v[96:111], v[180:183], a[188:191], v[96:111]
    ds_read_b64_tr_b16 v[180:181], v8 offset:32
    ds_read_b64_tr_b16 v[182:183], v8 offset:288
    s_add_u32 s60, s60, 9216
    v_mfma_f32_32x32x16_bf16 v[112:127], v[184:187], a[44:47], v[112:127]
    buffer_load_dwordx4 v213, s[4:7], s60 offen lds
    v_mfma_f32_32x32x16_bf16 v[128:143], v[184:187], a[188:191], v[128:143]
    ds_read_b64_tr_b16 v[184:185], v8 offset:512
    ds_read_b64_tr_b16 v[186:187], v8 offset:768
    s_add_u32 s100, s100, 1
    s_cmp_eq_u32 s100, 9
    s_cselect_b32 s100, 0, s100
    v_mfma_f32_32x32x16_bf16 v[144:159], v[188:191], a[44:47], v[144:159]
    v_mfma_f32_32x32x16_bf16 v[160:175], v[188:191], a[188:191], v[160:175]
    s_waitcnt lgkmcnt(4)
    ds_read_b64_tr_b16 v[188:189], v8 offset:544
    ds_read_b64_tr_b16 v[190:191], v8 offset:800
    v_mfma_f32_16x16x32_bf16 v[192:195], v[232:235], v[176:179], v[192:195]
    s_mul_i32 s60, s100, 589824
    v_mov_b32 v12, 163488
    ds_read_b64 v[222:223], v12
    v_mfma_f32_32x32x16_bf16 v[48:63], v[176:179], a[48:51], v[48:63]
    s_add_u32 s60, s60, s45
    s_add_u32 m0, s56, 98368
    v_mfma_f32_32x32x16_bf16 v[64:79], v[176:179], a[192:195], v[64:79]
    s_waitcnt lgkmcnt(5)
    v_add_u32 v9, 4294868928, v9
    ds_read_b64_tr_b16 v[176:177], v9 offset:0
    ds_read_b64_tr_b16 v[178:179], v9 offset:256
    s_nop 0
    v_mfma_f32_16x16x32_bf16 v[196:199], v[232:235], v[180:183], v[196:199]
    buffer_load_dwordx4 v214, s[12:15], s60 offen lds
    v_mfma_f32_32x32x16_bf16 v[80:95], v[180:183], a[48:51], v[80:95]
    s_add_u32 m0, s56, 106592
    s_waitcnt lgkmcnt(2)
    v_readfirstlane_b32 s58, v222
    v_readfirstlane_b32 s59, v223
    v_mov_b32 v218, v222
    v_mov_b32 v219, v223
    buffer_store_dwordx4 v[216:219], v220, s[32:35], 0 offen sc1
    v_mfma_f32_32x32x16_bf16 v[96:111], v[180:183], a[192:195], v[96:111]
    ds_read_b64_tr_b16 v[180:181], v9 offset:32
    ds_read_b64_tr_b16 v[182:183], v9 offset:288
    s_nop 0
    buffer_load_dwordx4 v214, s[16:19], s60 offen lds
    v_mfma_f32_16x16x32_bf16 v[200:203], v[232:235], v[184:187], v[200:203]
    s_add_u32 s20, s82, 7602176
    s_addc_u32 s21, s83, 0
    v_mfma_f32_32x32x16_bf16 v[112:127], v[184:187], a[48:51], v[112:127]
    s_add_u32 m0, s56, 99392
    s_add_u32 s60, s60, 73728
    s_mov_b32 s22, 18874368
    v_mfma_f32_32x32x16_bf16 v[128:143], v[184:187], a[192:195], v[128:143]
    ds_read_b64_tr_b16 v[184:185], v9 offset:512
    ds_read_b64_tr_b16 v[186:187], v9 offset:768
    buffer_load_dwordx4 v214, s[12:15], s60 offen lds
    v_mfma_f32_16x16x32_bf16 v[204:207], v[232:235], v[188:191], v[204:207]
    s_add_u32 m0, s56, 107616
    v_mfma_f32_32x32x16_bf16 v[144:159], v[188:191], a[48:51], v[144:159]
    s_nop 0
    v_mfma_f32_32x32x16_bf16 v[160:175], v[188:191], a[192:195], v[160:175]
    s_waitcnt lgkmcnt(4)
    ds_read_b64_tr_b16 v[188:189], v9 offset:544
    ds_read_b64_tr_b16 v[190:191], v9 offset:800
    buffer_load_dwordx4 v214, s[16:19], s60 offen lds
    v_mfma_f32_32x32x16_bf16 v[48:63], v[176:179], a[52:55], v[48:63]
    s_add_u32 m0, s3, 114784
    v_mfma_f32_32x32x16_bf16 v[64:79], v[176:179], a[196:199], v[64:79]
    s_waitcnt lgkmcnt(4)
    v_add_u32 v10, 4294868928, v10
    ds_read_b64_tr_b16 v[176:177], v10 offset:0
    ds_read_b64_tr_b16 v[178:179], v10 offset:256
    s_lshl_b32 s60, s100, 7
    buffer_load_dwordx4 v212, s[4:7], s60 offen lds
    v_mfma_f32_32x32x16_bf16 v[80:95], v[180:183], a[52:55], v[80:95]
    v_mfma_f32_32x32x16_bf16 v[96:111], v[180:183], a[196:199], v[96:111]
    s_waitcnt lgkmcnt(4)
    ds_read_b64_tr_b16 v[180:181], v10 offset:32
    ds_read_b64_tr_b16 v[182:183], v10 offset:288
    s_add_u32 m0, s3, 115808
    s_add_u32 s60, s60, 9216
    v_mfma_f32_32x32x16_bf16 v[112:127], v[184:187], a[52:55], v[112:127]
    buffer_load_dwordx4 v213, s[4:7], s60 offen lds
    v_mfma_f32_32x32x16_bf16 v[128:143], v[184:187], a[196:199], v[128:143]
    s_waitcnt lgkmcnt(4)
    ds_read_b64_tr_b16 v[184:185], v10 offset:512
    ds_read_b64_tr_b16 v[186:187], v10 offset:768
    s_add_u32 m0, s3, 116832
    v_mfma_f32_32x32x16_bf16 v[144:159], v[188:191], a[52:55], v[144:159]
    s_add_u32 s60, s60, 9216
    buffer_load_dwordx4 v212, s[4:7], s60 offen lds
    v_mfma_f32_32x32x16_bf16 v[160:175], v[188:191], a[196:199], v[160:175]
    s_waitcnt lgkmcnt(4)
    ds_read_b64_tr_b16 v[188:189], v10 offset:544
    ds_read_b64_tr_b16 v[190:191], v10 offset:800
    v_mfma_f32_32x32x16_bf16 v[48:63], v[176:179], a[56:59], v[48:63]
    s_add_u32 m0, s3, 117856
    s_add_u32 s60, s60, 9216
    s_waitcnt vmcnt(8)
    v_add_u32 v208, 49184, v208
    ds_read_b128 a[64:67], v208 offset:0
    ds_read_b128 a[208:211], v208 offset:4096
    v_mfma_f32_32x32x16_bf16 v[64:79], v[176:179], a[200:203], v[64:79]
    s_waitcnt lgkmcnt(6)
    v_add_u32 v11, 4294868928, v11
    ds_read_b64_tr_b16 v[176:177], v11 offset:0
    ds_read_b64_tr_b16 v[178:179], v11 offset:256
    buffer_load_dwordx4 v213, s[4:7], s60 offen lds
    v_add_u32 v209, 49184, v209
    v_mfma_f32_32x32x16_bf16 v[80:95], v[180:183], a[56:59], v[80:95]
    s_add_u32 m0, s3, 118880
    ds_read_b128 a[68:71], v209 offset:0
    ds_read_b128 a[212:215], v209 offset:4096
    v_add_u32 v210, 49184, v210
    ds_read_b128 a[72:75], v210 offset:0
    v_mfma_f32_32x32x16_bf16 v[96:111], v[180:183], a[200:203], v[96:111]
    s_waitcnt lgkmcnt(9)
    ds_read_b64_tr_b16 v[180:181], v11 offset:32
    ds_read_b64_tr_b16 v[182:183], v11 offset:288
    s_add_u32 s60, s60, 9216
    ds_read_b128 a[216:219], v210 offset:4096
    v_mfma_f32_32x32x16_bf16 v[112:127], v[184:187], a[56:59], v[112:127]
    buffer_load_dwordx4 v212, s[4:7], s60 offen lds
    v_add_u32 v211, 49184, v211
    ds_read_b128 a[76:79], v211 offset:0
    ds_read_b128 a[220:223], v211 offset:4096
    v_mfma_f32_32x32x16_bf16 v[128:143], v[184:187], a[200:203], v[128:143]
    s_waitcnt lgkmcnt(12)
    ds_read_b64_tr_b16 v[184:185], v11 offset:512
    ds_read_b64_tr_b16 v[186:187], v11 offset:768
    s_add_u32 m0, s3, 119904
    v_mfma_f32_32x32x16_bf16 v[144:159], v[188:191], a[56:59], v[144:159]
    s_add_u32 s60, s60, 9216
    buffer_load_dwordx4 v213, s[4:7], s60 offen lds
    v_mfma_f32_32x32x16_bf16 v[160:175], v[188:191], a[200:203], v[160:175]
    s_waitcnt lgkmcnt(10)
    ds_read_b64_tr_b16 v[188:189], v11 offset:544
    ds_read_b64_tr_b16 v[190:191], v11 offset:800
    v_mfma_f32_32x32x16_bf16 v[48:63], v[176:179], a[60:63], v[48:63]
    s_add_u32 m0, s3, 120928
    s_add_u32 s60, s60, 9216
    v_mfma_f32_32x32x16_bf16 v[64:79], v[176:179], a[204:207], v[64:79]
    s_waitcnt lgkmcnt(7)
    buffer_load_dwordx4 v212, s[4:7], s60 offen lds
    v_mfma_f32_32x32x16_bf16 v[80:95], v[180:183], a[60:63], v[80:95]
    s_waitcnt lgkmcnt(0)
    s_barrier
    v_add_u32 v8, 49184, v8
    ds_read_b64_tr_b16 v[176:177], v8 offset:0
    ds_read_b64_tr_b16 v[178:179], v8 offset:256
    s_add_u32 m0, s3, 121952
    v_mfma_f32_32x32x16_bf16 v[96:111], v[180:183], a[204:207], v[96:111]
    ds_read_b64_tr_b16 v[180:181], v8 offset:32
    ds_read_b64_tr_b16 v[182:183], v8 offset:288
    s_add_u32 s60, s60, 9216
    v_mfma_f32_32x32x16_bf16 v[112:127], v[184:187], a[60:63], v[112:127]
    buffer_load_dwordx4 v213, s[4:7], s60 offen lds
    v_mfma_f32_32x32x16_bf16 v[128:143], v[184:187], a[204:207], v[128:143]
    ds_read_b64_tr_b16 v[184:185], v8 offset:512
    ds_read_b64_tr_b16 v[186:187], v8 offset:768
    s_add_u32 s100, s100, 1
    s_cmp_eq_u32 s100, 9
    s_cselect_b32 s100, 0, s100
    v_mfma_f32_32x32x16_bf16 v[144:159], v[188:191], a[60:63], v[144:159]
    v_mfma_f32_32x32x16_bf16 v[160:175], v[188:191], a[204:207], v[160:175]
    s_waitcnt lgkmcnt(4)
    ds_read_b64_tr_b16 v[188:189], v8 offset:544
    ds_read_b64_tr_b16 v[190:191], v8 offset:800
    v_mfma_f32_16x16x32_bf16 v[192:195], v[232:235], v[176:179], v[192:195]
    s_mul_i32 s60, s100, 589824
    v_mfma_f32_32x32x16_bf16 v[48:63], v[176:179], a[64:67], v[48:63]
    s_add_u32 s60, s60, s45
    s_add_u32 m0, s56, 0
    v_mfma_f32_32x32x16_bf16 v[64:79], v[176:179], a[208:211], v[64:79]
    s_waitcnt lgkmcnt(4)
    v_add_u32 v9, 49184, v9
    ds_read_b64_tr_b16 v[176:177], v9 offset:0
    ds_read_b64_tr_b16 v[178:179], v9 offset:256
    s_nop 0
    v_mfma_f32_16x16x32_bf16 v[196:199], v[232:235], v[180:183], v[196:199]
    buffer_load_dwordx4 v214, s[12:15], s60 offen lds
    v_mfma_f32_32x32x16_bf16 v[80:95], v[180:183], a[64:67], v[80:95]
    s_add_u32 m0, s56, 8224
    v_mfma_f32_32x32x16_bf16 v[96:111], v[180:183], a[208:211], v[96:111]
    s_waitcnt lgkmcnt(4)
    ds_read_b64_tr_b16 v[180:181], v9 offset:32
    ds_read_b64_tr_b16 v[182:183], v9 offset:288
    s_nop 0
    buffer_load_dwordx4 v214, s[16:19], s60 offen lds
    v_mfma_f32_16x16x32_bf16 v[200:203], v[232:235], v[184:187], v[200:203]
    v_mfma_f32_32x32x16_bf16 v[112:127], v[184:187], a[64:67], v[112:127]
    s_add_u32 m0, s56, 1024
    s_add_u32 s60, s60, 73728
    v_mfma_f32_32x32x16_bf16 v[128:143], v[184:187], a[208:211], v[128:143]
    s_waitcnt lgkmcnt(4)
    ds_read_b64_tr_b16 v[184:185], v9 offset:512
    ds_read_b64_tr_b16 v[186:187], v9 offset:768
    buffer_load_dwordx4 v214, s[12:15], s60 offen lds
    v_mfma_f32_16x16x32_bf16 v[204:207], v[232:235], v[188:191], v[204:207]
    s_add_u32 m0, s56, 9248
    v_mfma_f32_32x32x16_bf16 v[144:159], v[188:191], a[64:67], v[144:159]
    s_nop 0
    v_mfma_f32_32x32x16_bf16 v[160:175], v[188:191], a[208:211], v[160:175]
    s_waitcnt lgkmcnt(4)
    ds_read_b64_tr_b16 v[188:189], v9 offset:544
    ds_read_b64_tr_b16 v[190:191], v9 offset:800
    buffer_load_dwordx4 v214, s[16:19], s60 offen lds
    v_mfma_f32_32x32x16_bf16 v[48:63], v[176:179], a[68:71], v[48:63]
    s_add_u32 m0, s3, 16416
    v_mfma_f32_32x32x16_bf16 v[64:79], v[176:179], a[212:215], v[64:79]
    s_waitcnt lgkmcnt(4)
    v_add_u32 v10, 49184, v10
    ds_read_b64_tr_b16 v[176:177], v10 offset:0
    ds_read_b64_tr_b16 v[178:179], v10 offset:256
    s_lshl_b32 s60, s100, 7
    buffer_load_dwordx4 v212, s[4:7], s60 offen lds
    v_mfma_f32_32x32x16_bf16 v[80:95], v[180:183], a[68:71], v[80:95]
    v_mfma_f32_32x32x16_bf16 v[96:111], v[180:183], a[212:215], v[96:111]
    s_waitcnt lgkmcnt(4)
    ds_read_b64_tr_b16 v[180:181], v10 offset:32
    ds_read_b64_tr_b16 v[182:183], v10 offset:288
    s_add_u32 m0, s3, 17440
    s_add_u32 s60, s60, 9216
    v_mfma_f32_32x32x16_bf16 v[112:127], v[184:187], a[68:71], v[112:127]
    buffer_load_dwordx4 v213, s[4:7], s60 offen lds
    v_mfma_f32_32x32x16_bf16 v[128:143], v[184:187], a[212:215], v[128:143]
    s_waitcnt lgkmcnt(4)
    ds_read_b64_tr_b16 v[184:185], v10 offset:512
    ds_read_b64_tr_b16 v[186:187], v10 offset:768
    s_add_u32 m0, s3, 18464
    v_mfma_f32_32x32x16_bf16 v[144:159], v[188:191], a[68:71], v[144:159]
    s_add_u32 s60, s60, 9216
    buffer_load_dwordx4 v212, s[4:7], s60 offen lds
    v_mfma_f32_32x32x16_bf16 v[160:175], v[188:191], a[212:215], v[160:175]
    s_waitcnt lgkmcnt(4)
    ds_read_b64_tr_b16 v[188:189], v10 offset:544
    ds_read_b64_tr_b16 v[190:191], v10 offset:800
    v_mfma_f32_32x32x16_bf16 v[48:63], v[176:179], a[72:75], v[48:63]
    s_add_u32 m0, s3, 19488
    s_add_u32 s60, s60, 9216
    s_lshl_b32 s40, s38, 5
    s_waitcnt vmcnt(7)
    v_add_u32 v208, 49184, v208
    s_add_u32 s40, s40, s63
    ds_read_b128 a[80:83], v208 offset:0
    v_mfma_f32_32x32x16_bf16 v[64:79], v[176:179], a[216:219], v[64:79]
    s_waitcnt lgkmcnt(5)
    v_add_u32 v11, 49184, v11
    ds_read_b64_tr_b16 v[176:177], v11 offset:0
    ds_read_b64_tr_b16 v[178:179], v11 offset:256
    buffer_load_dwordx4 v213, s[4:7], s60 offen lds
    s_lshl_b32 s40, s40, 3
    v_mfma_f32_32x32x16_bf16 v[80:95], v[180:183], a[72:75], v[80:95]
    s_add_u32 m0, s3, 20512
    ds_read_b128 a[224:227], v208 offset:4096
    v_add_u32 v209, 49184, v209
    ds_read_b128 a[84:87], v209 offset:0
    v_mov_b32 v12, s58
    v_mov_b32 v13, s59
    v_mfma_f32_32x32x16_bf16 v[96:111], v[180:183], a[216:219], v[96:111]
    s_waitcnt lgkmcnt(7)
    ds_read_b64_tr_b16 v[180:181], v11 offset:32
    ds_read_b64_tr_b16 v[182:183], v11 offset:288
    s_add_u32 s60, s60, 9216
    ds_read_b128 a[228:231], v209 offset:4096
    v_mfma_f32_32x32x16_bf16 v[112:127], v[184:187], a[72:75], v[112:127]
    buffer_load_dwordx4 v212, s[4:7], s60 offen lds
    v_add_u32 v210, 49184, v210
    buffer_store_dwordx2 v[12:13], v0, s[32:35], s40 offen sc1
    ds_read_b128 a[88:91], v210 offset:0
    v_mfma_f32_32x32x16_bf16 v[128:143], v[184:187], a[216:219], v[128:143]
    s_waitcnt lgkmcnt(9)
    ds_read_b64_tr_b16 v[184:185], v11 offset:512
    ds_read_b64_tr_b16 v[186:187], v11 offset:768
    s_add_u32 m0, s3, 21536
    ds_read_b128 a[232:235], v210 offset:4096
    v_add_u32 v211, 49184, v211
    v_mfma_f32_32x32x16_bf16 v[144:159], v[188:191], a[72:75], v[144:159]
    s_add_u32 s60, s60, 9216
    buffer_load_dwordx4 v213, s[4:7], s60 offen lds
    ds_read_b128 a[92:95], v211 offset:0
    ds_read_b128 a[236:239], v211 offset:4096
    v_mfma_f32_32x32x16_bf16 v[160:175], v[188:191], a[216:219], v[160:175]
    s_waitcnt lgkmcnt(11)
    ds_read_b64_tr_b16 v[188:189], v11 offset:544
    ds_read_b64_tr_b16 v[190:191], v11 offset:800
    v_mfma_f32_32x32x16_bf16 v[48:63], v[176:179], a[76:79], v[48:63]
    s_add_u32 m0, s3, 22560
    s_add_u32 s60, s60, 9216
    v_mfma_f32_32x32x16_bf16 v[64:79], v[176:179], a[220:223], v[64:79]
    s_waitcnt lgkmcnt(9)
    buffer_load_dwordx4 v212, s[4:7], s60 offen lds
    v_mfma_f32_32x32x16_bf16 v[80:95], v[180:183], a[76:79], v[80:95]
    s_waitcnt lgkmcnt(0)
    s_barrier
    v_add_u32 v8, 49184, v8
    ds_read_b64_tr_b16 v[176:177], v8 offset:0
    ds_read_b64_tr_b16 v[178:179], v8 offset:256
    s_add_u32 m0, s3, 23584
    v_mfma_f32_32x32x16_bf16 v[96:111], v[180:183], a[220:223], v[96:111]
    ds_read_b64_tr_b16 v[180:181], v8 offset:32
    ds_read_b64_tr_b16 v[182:183], v8 offset:288
    s_add_u32 s60, s60, 9216
    v_mfma_f32_32x32x16_bf16 v[112:127], v[184:187], a[76:79], v[112:127]
    buffer_load_dwordx4 v213, s[4:7], s60 offen lds
    v_mfma_f32_32x32x16_bf16 v[128:143], v[184:187], a[220:223], v[128:143]
    ds_read_b64_tr_b16 v[184:185], v8 offset:512
    ds_read_b64_tr_b16 v[186:187], v8 offset:768
    s_add_u32 s100, s100, 1
    s_cmp_eq_u32 s100, 9
    s_cselect_b32 s100, 0, s100
    v_mfma_f32_32x32x16_bf16 v[144:159], v[188:191], a[76:79], v[144:159]
    v_mfma_f32_32x32x16_bf16 v[160:175], v[188:191], a[220:223], v[160:175]
    s_waitcnt lgkmcnt(4)
    ds_read_b64_tr_b16 v[188:189], v8 offset:544
    ds_read_b64_tr_b16 v[190:191], v8 offset:800
    v_mfma_f32_16x16x32_bf16 v[192:195], v[232:235], v[176:179], v[192:195]
    s_mul_i32 s60, s100, 589824
    v_mfma_f32_32x32x16_bf16 v[48:63], v[176:179], a[80:83], v[48:63]
    s_add_u32 s60, s60, s45
    s_add_u32 m0, s56, 49184
    v_mfma_f32_32x32x16_bf16 v[64:79], v[176:179], a[224:227], v[64:79]
    s_waitcnt lgkmcnt(4)
    v_add_u32 v9, 49184, v9
    ds_read_b64_tr_b16 v[176:177], v9 offset:0
    ds_read_b64_tr_b16 v[178:179], v9 offset:256
    s_nop 0
    v_mfma_f32_16x16x32_bf16 v[196:199], v[232:235], v[180:183], v[196:199]
    buffer_load_dwordx4 v214, s[12:15], s60 offen lds
    v_mfma_f32_32x32x16_bf16 v[80:95], v[180:183], a[80:83], v[80:95]
    s_add_u32 m0, s56, 57408
    v_mfma_f32_32x32x16_bf16 v[96:111], v[180:183], a[224:227], v[96:111]
    s_waitcnt lgkmcnt(4)
    ds_read_b64_tr_b16 v[180:181], v9 offset:32
    ds_read_b64_tr_b16 v[182:183], v9 offset:288
    s_nop 0
    buffer_load_dwordx4 v214, s[16:19], s60 offen lds
    v_mfma_f32_16x16x32_bf16 v[200:203], v[232:235], v[184:187], v[200:203]
    v_mfma_f32_32x32x16_bf16 v[112:127], v[184:187], a[80:83], v[112:127]
    s_add_u32 m0, s56, 50208
    s_add_u32 s60, s60, 73728
    v_mfma_f32_32x32x16_bf16 v[128:143], v[184:187], a[224:227], v[128:143]
    s_waitcnt lgkmcnt(4)
    ds_read_b64_tr_b16 v[184:185], v9 offset:512
    ds_read_b64_tr_b16 v[186:187], v9 offset:768
    buffer_load_dwordx4 v214, s[12:15], s60 offen lds
    v_mfma_f32_16x16x32_bf16 v[204:207], v[232:235], v[188:191], v[204:207]
    s_add_u32 m0, s56, 58432
    v_mfma_f32_32x32x16_bf16 v[144:159], v[188:191], a[80:83], v[144:159]
    s_nop 0
    v_mfma_f32_32x32x16_bf16 v[160:175], v[188:191], a[224:227], v[160:175]
    s_waitcnt lgkmcnt(4)
    ds_read_b64_tr_b16 v[188:189], v9 offset:544
    ds_read_b64_tr_b16 v[190:191], v9 offset:800
    buffer_load_dwordx4 v214, s[16:19], s60 offen lds
    v_mfma_f32_32x32x16_bf16 v[48:63], v[176:179], a[84:87], v[48:63]
    s_add_u32 m0, s3, 65600
    v_mfma_f32_32x32x16_bf16 v[64:79], v[176:179], a[228:231], v[64:79]
    s_waitcnt lgkmcnt(4)
    v_add_u32 v10, 49184, v10
    ds_read_b64_tr_b16 v[176:177], v10 offset:0
    ds_read_b64_tr_b16 v[178:179], v10 offset:256
    s_lshl_b32 s60, s100, 7
    buffer_load_dwordx4 v212, s[4:7], s60 offen lds
    v_mfma_f32_32x32x16_bf16 v[80:95], v[180:183], a[84:87], v[80:95]
    v_mfma_f32_32x32x16_bf16 v[96:111], v[180:183], a[228:231], v[96:111]
    s_waitcnt lgkmcnt(4)
    ds_read_b64_tr_b16 v[180:181], v10 offset:32
    ds_read_b64_tr_b16 v[182:183], v10 offset:288
    s_add_u32 m0, s3, 66624
    s_add_u32 s60, s60, 9216
    v_mfma_f32_32x32x16_bf16 v[112:127], v[184:187], a[84:87], v[112:127]
    buffer_load_dwordx4 v213, s[4:7], s60 offen lds
    v_mfma_f32_32x32x16_bf16 v[128:143], v[184:187], a[228:231], v[128:143]
    s_waitcnt lgkmcnt(4)
    ds_read_b64_tr_b16 v[184:185], v10 offset:512
    ds_read_b64_tr_b16 v[186:187], v10 offset:768
    s_add_u32 m0, s3, 67648
    v_mfma_f32_32x32x16_bf16 v[144:159], v[188:191], a[84:87], v[144:159]
    s_add_u32 s60, s60, 9216
    buffer_load_dwordx4 v212, s[4:7], s60 offen lds
    v_mfma_f32_32x32x16_bf16 v[160:175], v[188:191], a[228:231], v[160:175]
    s_waitcnt lgkmcnt(4)
    ds_read_b64_tr_b16 v[188:189], v10 offset:544
    ds_read_b64_tr_b16 v[190:191], v10 offset:800
    v_mfma_f32_32x32x16_bf16 v[48:63], v[176:179], a[88:91], v[48:63]
    s_add_u32 m0, s3, 68672
    s_add_u32 s60, s60, 9216
    s_waitcnt vmcnt(7)
    v_add_u32 v208, 4294868928, v208
    ds_read_b128 a[96:99], v208 offset:0
    ds_read_b128 a[240:243], v208 offset:4096
    v_mfma_f32_32x32x16_bf16 v[64:79], v[176:179], a[232:235], v[64:79]
    s_waitcnt lgkmcnt(6)
    v_add_u32 v11, 49184, v11
    ds_read_b64_tr_b16 v[176:177], v11 offset:0
    ds_read_b64_tr_b16 v[178:179], v11 offset:256
    buffer_load_dwordx4 v213, s[4:7], s60 offen lds
    v_add_u32 v209, 4294868928, v209
    v_mfma_f32_32x32x16_bf16 v[80:95], v[180:183], a[88:91], v[80:95]
    s_add_u32 m0, s3, 69696
    ds_read_b128 a[100:103], v209 offset:0
    ds_read_b128 a[244:247], v209 offset:4096
    v_add_u32 v210, 4294868928, v210
    ds_read_b128 a[104:107], v210 offset:0
    v_mfma_f32_32x32x16_bf16 v[96:111], v[180:183], a[232:235], v[96:111]
    s_waitcnt lgkmcnt(9)
    ds_read_b64_tr_b16 v[180:181], v11 offset:32
    ds_read_b64_tr_b16 v[182:183], v11 offset:288
    s_add_u32 s60, s60, 9216
    ds_read_b128 a[248:251], v210 offset:4096
    v_mfma_f32_32x32x16_bf16 v[112:127], v[184:187], a[88:91], v[112:127]
    buffer_load_dwordx4 v212, s[4:7], s60 offen lds
    v_add_u32 v211, 4294868928, v211
    ds_read_b128 a[108:111], v211 offset:0
    ds_read_b128 a[252:255], v211 offset:4096
    v_mfma_f32_32x32x16_bf16 v[128:143], v[184:187], a[232:235], v[128:143]
    s_waitcnt lgkmcnt(12)
    ds_read_b64_tr_b16 v[184:185], v11 offset:512
    ds_read_b64_tr_b16 v[186:187], v11 offset:768
    s_add_u32 m0, s3, 70720
    v_mfma_f32_32x32x16_bf16 v[144:159], v[188:191], a[88:91], v[144:159]
    s_add_u32 s60, s60, 9216
    buffer_load_dwordx4 v213, s[4:7], s60 offen lds
    v_mfma_f32_32x32x16_bf16 v[160:175], v[188:191], a[232:235], v[160:175]
    s_waitcnt lgkmcnt(10)
    ds_read_b64_tr_b16 v[188:189], v11 offset:544
    ds_read_b64_tr_b16 v[190:191], v11 offset:800
    v_mfma_f32_32x32x16_bf16 v[48:63], v[176:179], a[92:95], v[48:63]
    s_add_u32 m0, s3, 71744
    s_add_u32 s60, s60, 9216
    v_mfma_f32_32x32x16_bf16 v[64:79], v[176:179], a[236:239], v[64:79]
    s_waitcnt lgkmcnt(7)
    buffer_load_dwordx4 v212, s[4:7], s60 offen lds
    v_mfma_f32_32x32x16_bf16 v[80:95], v[180:183], a[92:95], v[80:95]
    s_waitcnt lgkmcnt(0)
    s_barrier
    v_add_u32 v8, 4294868928, v8
    ds_read_b64_tr_b16 v[176:177], v8 offset:0
    ds_read_b64_tr_b16 v[178:179], v8 offset:256
    s_add_u32 m0, s3, 72768
    v_mfma_f32_32x32x16_bf16 v[96:111], v[180:183], a[236:239], v[96:111]
    ds_read_b64_tr_b16 v[180:181], v8 offset:32
    ds_read_b64_tr_b16 v[182:183], v8 offset:288
    s_add_u32 s60, s60, 9216
    v_mfma_f32_32x32x16_bf16 v[112:127], v[184:187], a[92:95], v[112:127]
    buffer_load_dwordx4 v213, s[4:7], s60 offen lds
    v_mfma_f32_32x32x16_bf16 v[128:143], v[184:187], a[236:239], v[128:143]
    ds_read_b64_tr_b16 v[184:185], v8 offset:512
    ds_read_b64_tr_b16 v[186:187], v8 offset:768
    s_add_u32 s100, s100, 1
    s_cmp_eq_u32 s100, 9
    s_cselect_b32 s100, 0, s100
    v_mfma_f32_32x32x16_bf16 v[144:159], v[188:191], a[92:95], v[144:159]
    v_mfma_f32_32x32x16_bf16 v[160:175], v[188:191], a[236:239], v[160:175]
    s_waitcnt lgkmcnt(4)
    ds_read_b64_tr_b16 v[188:189], v8 offset:544
    ds_read_b64_tr_b16 v[190:191], v8 offset:800
    v_mfma_f32_16x16x32_bf16 v[192:195], v[232:235], v[176:179], v[192:195]
    s_mul_i32 s60, s100, 589824
    v_mfma_f32_32x32x16_bf16 v[48:63], v[176:179], a[96:99], v[48:63]
    s_add_u32 s60, s60, s45
    s_add_u32 m0, s56, 98368
    v_mfma_f32_32x32x16_bf16 v[64:79], v[176:179], a[240:243], v[64:79]
    s_waitcnt lgkmcnt(4)
    v_add_u32 v9, 4294868928, v9
    ds_read_b64_tr_b16 v[176:177], v9 offset:0
    ds_read_b64_tr_b16 v[178:179], v9 offset:256
    s_nop 0
    v_mfma_f32_16x16x32_bf16 v[196:199], v[232:235], v[180:183], v[196:199]
    buffer_load_dwordx4 v214, s[12:15], s60 offen lds
    v_mfma_f32_32x32x16_bf16 v[80:95], v[180:183], a[96:99], v[80:95]
    s_add_u32 m0, s56, 106592
    v_mfma_f32_32x32x16_bf16 v[96:111], v[180:183], a[240:243], v[96:111]
    s_waitcnt lgkmcnt(4)
    ds_read_b64_tr_b16 v[180:181], v9 offset:32
    ds_read_b64_tr_b16 v[182:183], v9 offset:288
    s_nop 0
    buffer_load_dwordx4 v214, s[16:19], s60 offen lds
    v_mfma_f32_16x16x32_bf16 v[200:203], v[232:235], v[184:187], v[200:203]
    v_mfma_f32_32x32x16_bf16 v[112:127], v[184:187], a[96:99], v[112:127]
    s_add_u32 m0, s56, 99392
    s_add_u32 s60, s60, 73728
    v_mfma_f32_32x32x16_bf16 v[128:143], v[184:187], a[240:243], v[128:143]
    s_waitcnt lgkmcnt(4)
    ds_read_b64_tr_b16 v[184:185], v9 offset:512
    ds_read_b64_tr_b16 v[186:187], v9 offset:768
    buffer_load_dwordx4 v214, s[12:15], s60 offen lds
    s_lshl_b32 s40, s37, 2
    s_add_u32 s40, s40, s36
    v_mfma_f32_16x16x32_bf16 v[204:207], v[232:235], v[188:191], v[204:207]
    s_add_u32 m0, s56, 107616
    s_lshl_b32 s40, s40, 10
    s_add_u32 s40, s40, 32768
    v_mfma_f32_32x32x16_bf16 v[144:159], v[188:191], a[96:99], v[144:159]
    s_nop 0
    v_and_b32 v14, 31, v1
    v_lshl_add_u32 v14, v14, 4, s40
    s_lshl_b32 s40, s38, 8
    v_min_u32 v15, 17, v1
    v_lshl_add_u32 v15, v15, 3, s40
    v_mfma_f32_32x32x16_bf16 v[160:175], v[188:191], a[240:243], v[160:175]
    s_waitcnt lgkmcnt(4)
    ds_read_b64_tr_b16 v[188:189], v9 offset:544
    ds_read_b64_tr_b16 v[190:191], v9 offset:800
    buffer_load_dwordx4 v214, s[16:19], s60 offen lds
    buffer_load_dwordx2 v[12:13], v15, s[32:35], 0 offen sc1
    v_mfma_f32_32x32x16_bf16 v[48:63], v[176:179], a[100:103], v[48:63]
    s_add_u32 m0, s3, 114784
    buffer_load_dwordx4 v[216:219], v14, s[32:35], 0 offen offset:0 sc1
    buffer_load_dwordx4 v[220:223], v14, s[32:35], 0 offen offset:512 sc1
    v_mfma_f32_32x32x16_bf16 v[64:79], v[176:179], a[244:247], v[64:79]
    s_waitcnt lgkmcnt(4)
    v_add_u32 v10, 4294868928, v10
    ds_read_b64_tr_b16 v[176:177], v10 offset:0
    ds_read_b64_tr_b16 v[178:179], v10 offset:256
    s_lshl_b32 s60, s100, 7
    buffer_load_dwordx4 v212, s[4:7], s60 offen lds
    v_mfma_f32_32x32x16_bf16 v[80:95], v[180:183], a[100:103], v[80:95]
    v_mfma_f32_32x32x16_bf16 v[96:111], v[180:183], a[244:247], v[96:111]
    s_waitcnt lgkmcnt(4)
    ds_read_b64_tr_b16 v[180:181], v10 offset:32
    ds_read_b64_tr_b16 v[182:183], v10 offset:288
    s_add_u32 m0, s3, 115808
    s_add_u32 s60, s60, 9216
    v_mfma_f32_32x32x16_bf16 v[112:127], v[184:187], a[100:103], v[112:127]
    buffer_load_dwordx4 v213, s[4:7], s60 offen lds
    v_mfma_f32_32x32x16_bf16 v[128:143], v[184:187], a[244:247], v[128:143]
    s_waitcnt lgkmcnt(4)
    ds_read_b64_tr_b16 v[184:185], v10 offset:512
    ds_read_b64_tr_b16 v[186:187], v10 offset:768
    s_add_u32 m0, s3, 116832
    v_mfma_f32_32x32x16_bf16 v[144:159], v[188:191], a[100:103], v[144:159]
    s_add_u32 s60, s60, 9216
    buffer_load_dwordx4 v212, s[4:7], s60 offen lds
    v_mfma_f32_32x32x16_bf16 v[160:175], v[188:191], a[244:247], v[160:175]
    s_waitcnt lgkmcnt(4)
    ds_read_b64_tr_b16 v[188:189], v10 offset:544
    ds_read_b64_tr_b16 v[190:191], v10 offset:800
    v_mfma_f32_32x32x16_bf16 v[48:63], v[176:179], a[104:107], v[48:63]
    s_add_u32 m0, s3, 117856
    s_add_u32 s60, s60, 9216
    s_waitcnt vmcnt(10)
    v_add_u32 v208, 49184, v208
    ds_read_b128 a[112:115], v208 offset:0
    ds_read_b128 v[16:19], v208 offset:4096
    v_mfma_f32_32x32x16_bf16 v[64:79], v[176:179], a[248:251], v[64:79]
    s_waitcnt lgkmcnt(6)
    v_add_u32 v11, 4294868928, v11
    ds_read_b64_tr_b16 v[176:177], v11 offset:0
    ds_read_b64_tr_b16 v[178:179], v11 offset:256
    buffer_load_dwordx4 v213, s[4:7], s60 offen lds
    v_add_u32 v209, 49184, v209
    v_mfma_f32_32x32x16_bf16 v[80:95], v[180:183], a[104:107], v[80:95]
    s_add_u32 m0, s3, 118880
    ds_read_b128 a[116:119], v209 offset:0
    ds_read_b128 v[20:23], v209 offset:4096
    v_add_u32 v210, 49184, v210
    ds_read_b128 a[120:123], v210 offset:0
    v_mfma_f32_32x32x16_bf16 v[96:111], v[180:183], a[248:251], v[96:111]
    s_waitcnt lgkmcnt(9)
    ds_read_b64_tr_b16 v[180:181], v11 offset:32
    ds_read_b64_tr_b16 v[182:183], v11 offset:288
    s_add_u32 s60, s60, 9216
    ds_read_b128 v[24:27], v210 offset:4096
    v_mfma_f32_32x32x16_bf16 v[112:127], v[184:187], a[104:107], v[112:127]
    buffer_load_dwordx4 v212, s[4:7], s60 offen lds
    v_add_u32 v211, 49184, v211
    ds_read_b128 a[124:127], v211 offset:0
    ds_read_b128 v[28:31], v211 offset:4096
    v_mfma_f32_32x32x16_bf16 v[128:143], v[184:187], a[248:251], v[128:143]
    s_waitcnt lgkmcnt(12)
    ds_read_b64_tr_b16 v[184:185], v11 offset:512
    ds_read_b64_tr_b16 v[186:187], v11 offset:768
    s_add_u32 m0, s3, 119904
    v_mfma_f32_32x32x16_bf16 v[144:159], v[188:191], a[104:107], v[144:159]
    s_add_u32 s60, s60, 9216
    buffer_load_dwordx4 v213, s[4:7], s60 offen lds
    v_mfma_f32_32x32x16_bf16 v[160:175], v[188:191], a[248:251], v[160:175]
    s_waitcnt lgkmcnt(10)
    ds_read_b64_tr_b16 v[188:189], v11 offset:544
    ds_read_b64_tr_b16 v[190:191], v11 offset:800
    v_mfma_f32_32x32x16_bf16 v[48:63], v[176:179], a[108:111], v[48:63]
    s_add_u32 m0, s3, 120928
    s_add_u32 s60, s60, 9216
    v_mfma_f32_32x32x16_bf16 v[64:79], v[176:179], a[252:255], v[64:79]
    s_waitcnt lgkmcnt(7)
    buffer_load_dwordx4 v212, s[4:7], s60 offen lds
    v_mfma_f32_32x32x16_bf16 v[80:95], v[180:183], a[108:111], v[80:95]
    s_waitcnt lgkmcnt(0)
    s_barrier
    v_add_u32 v8, 49184, v8
    ds_read_b64_tr_b16 v[176:177], v8 offset:0
    ds_read_b64_tr_b16 v[178:179], v8 offset:256
    s_add_u32 m0, s3, 121952
    v_mfma_f32_32x32x16_bf16 v[96:111], v[180:183], a[252:255], v[96:111]
    ds_read_b64_tr_b16 v[180:181], v8 offset:32
    ds_read_b64_tr_b16 v[182:183], v8 offset:288
    s_add_u32 s60, s60, 9216
    v_mfma_f32_32x32x16_bf16 v[112:127], v[184:187], a[108:111], v[112:127]
    buffer_load_dwordx4 v213, s[4:7], s60 offen lds
    v_mfma_f32_32x32x16_bf16 v[128:143], v[184:187], a[252:255], v[128:143]
    ds_read_b64_tr_b16 v[184:185], v8 offset:512
    ds_read_b64_tr_b16 v[186:187], v8 offset:768
    s_add_u32 s100, s100, 1
    s_cmp_eq_u32 s100, 9
    s_cselect_b32 s100, 0, s100
    v_mfma_f32_32x32x16_bf16 v[144:159], v[188:191], a[108:111], v[144:159]
    v_mfma_f32_32x32x16_bf16 v[160:175], v[188:191], a[252:255], v[160:175]
    s_waitcnt lgkmcnt(4)
    ds_read_b64_tr_b16 v[188:189], v8 offset:544
    ds_read_b64_tr_b16 v[190:191], v8 offset:800
    v_mfma_f32_16x16x32_bf16 v[192:195], v[232:235], v[176:179], v[192:195]
    v_mfma_f32_32x32x16_bf16 v[48:63], v[176:179], a[112:115], v[48:63]
    s_waitcnt vmcnt(10)
    v_cmp_eq_u64 vcc, s[58:59], v[12:13]
    s_nop 1
    s_cmp_eq_u64 vcc, -1
    s_cbranch_scc0 LW_slow
LW_ok:
    v_mfma_f32_32x32x16_bf16 v[64:79], v[176:179], v[16:19], v[64:79]
    s_waitcnt lgkmcnt(4)
    v_add_u32 v9, 49184, v9
    ds_read_b64_tr_b16 v[176:177], v9 offset:0
    ds_read_b64_tr_b16 v[178:179], v9 offset:256
    s_lshl_b32 s60, s100, 12
    s_add_u32 m0, s44, 0
    s_add_u32 s60, s60, s80
    v_mfma_f32_16x16x32_bf16 v[196:199], v[232:235], v[180:183], v[196:199]
    buffer_load_dwordx4 v6, s[8:11], s60 offen sc1 lds
    v_mfma_f32_32x32x16_bf16 v[80:95], v[180:183], a[112:115], v[80:95]
    s_add_u32 s100, s100, 1
    s_cmp_eq_u32 s100, 9
    s_cselect_b32 s100, 0, s100
    s_lshl_b32 s60, s100, 12
    s_add_u32 m0, s44, 4096
    s_add_u32 s60, s60, s80
    v_mfma_f32_32x32x16_bf16 v[96:111], v[180:183], v[16:19], v[96:111]
    s_waitcnt lgkmcnt(4)
    ds_read_b64_tr_b16 v[180:181], v9 offset:32
    ds_read_b64_tr_b16 v[182:183], v9 offset:288
    buffer_load_dwordx4 v6, s[8:11], s60 offen sc1 lds
    v_mfma_f32_16x16x32_bf16 v[200:203], v[232:235], v[184:187], v[200:203]
    v_mfma_f32_32x32x16_bf16 v[112:127], v[184:187], a[112:115], v[112:127]
    s_add_u32 s100, s100, 1
    s_cmp_eq_u32 s100, 9
    s_cselect_b32 s100, 0, s100
    s_lshl_b32 s60, s100, 12
    s_add_u32 m0, s44, 8192
    s_add_u32 s60, s60, s80
    v_mfma_f32_32x32x16_bf16 v[128:143], v[184:187], v[16:19], v[128:143]
    s_waitcnt lgkmcnt(4)
    ds_read_b64_tr_b16 v[184:185], v9 offset:512
    ds_read_b64_tr_b16 v[186:187], v9 offset:768
    buffer_load_dwordx4 v6, s[8:11], s60 offen sc1 lds
    v_mfma_f32_16x16x32_bf16 v[204:207], v[232:235], v[188:191], v[204:207]
    v_mfma_f32_32x32x16_bf16 v[144:159], v[188:191], a[112:115], v[144:159]
    s_add_u32 s100, s100, 1
    s_cmp_eq_u32 s100, 9
    s_cselect_b32 s100, 0, s100
    s_lshl_b32 s60, s100, 12
    s_add_u32 m0, s44, 12288
    s_add_u32 s60, s60, s80
    v_mfma_f32_32x32x16_bf16 v[160:175], v[188:191], v[16:19], v[160:175]
    s_waitcnt lgkmcnt(4)
    ds_read_b64_tr_b16 v[188:189], v9 offset:544
    ds_read_b64_tr_b16 v[190:191], v9 offset:800
    buffer_load_dwordx4 v6, s[8:11], s60 offen sc1 lds
    v_mfma_f32_32x32x16_bf16 v[48:63], v[176:179], a[116:119], v[48:63]
    s_add_u32 s100, s100, 1
    s_cmp_eq_u32 s100, 9
    s_cselect_b32 s100, 0, s100
    s_lshl_b32 s60, s100, 12
    s_add_u32 m0, s44, 16384
    s_add_u32 s60, s60, s80
    v_mfma_f32_32x32x16_bf16 v[64:79], v[176:179], v[20:23], v[64:79]
    s_waitcnt lgkmcnt(4)
    v_add_u32 v10, 49184, v10
    ds_read_b64_tr_b16 v[176:177], v10 offset:0
    ds_read_b64_tr_b16 v[178:179], v10 offset:256
    buffer_load_dwordx4 v6, s[8:11], s60 offen sc1 lds
    s_add_u32 s100, s100, 1
    s_cmp_eq_u32 s100, 9
    s_cselect_b32 s100, 0, s100
    v_mfma_f32_32x32x16_bf16 v[80:95], v[180:183], a[116:119], v[80:95]
    s_lshl_b32 s60, s100, 12
    s_add_u32 m0, s44, 20480
    s_add_u32 s60, s60, s80
    buffer_load_dwordx4 v6, s[8:11], s60 offen sc1 lds
    v_mfma_f32_32x32x16_bf16 v[96:111], v[180:183], v[20:23], v[96:111]
    s_waitcnt lgkmcnt(4)
    ds_read_b64_tr_b16 v[180:181], v10 offset:32
    ds_read_b64_tr_b16 v[182:183], v10 offset:288
    s_add_u32 s100, s100, 1
    s_cmp_eq_u32 s100, 9
    s_cselect_b32 s100, 0, s100
    s_lshl_b32 s60, s100, 12
    v_mfma_f32_32x32x16_bf16 v[112:127], v[184:187], a[116:119], v[112:127]
    s_add_u32 m0, s44, 24576
    s_add_u32 s60, s60, s80
    buffer_load_dwordx4 v6, s[8:11], s60 offen sc1 lds
    s_add_u32 s100, s100, 1
    s_cmp_eq_u32 s100, 9
    s_cselect_b32 s100, 0, s100
    v_mfma_f32_32x32x16_bf16 v[128:143], v[184:187], v[20:23], v[128:143]
    s_waitcnt lgkmcnt(4)
    ds_read_b64_tr_b16 v[184:185], v10 offset:512
    ds_read_b64_tr_b16 v[186:187], v10 offset:768
    s_lshl_b32 s60, s100, 12
    s_add_u32 m0, s44, 28672
    s_add_u32 s60, s60, s80
    v_mfma_f32_32x32x16_bf16 v[144:159], v[188:191], a[116:119], v[144:159]
    buffer_load_dwordx4 v6, s[8:11], s60 offen sc1 lds
    s_add_u32 s100, s100, 1
    s_cmp_eq_u32 s100, 9
    s_cselect_b32 s100, 0, s100
    s_lshl_b32 s60, s100, 12
    v_mfma_f32_32x32x16_bf16 v[160:175], v[188:191], v[20:23], v[160:175]
    s_waitcnt lgkmcnt(4)
    ds_read_b64_tr_b16 v[188:189], v10 offset:544
    ds_read_b64_tr_b16 v[190:191], v10 offset:800
    s_add_u32 m0, s44, 32768
    s_add_u32 s60, s60, s80
    buffer_load_dwordx4 v6, s[8:11], s60 offen sc1 lds
    s_add_u32 s100, s100, 1
    s_cmp_eq_u32 s100, 9
    s_cselect_b32 s100, 0, s100
    s_add_u32 s80, s80, 36864
    v_mfma_f32_32x32x16_bf16 v[48:63], v[176:179], a[120:123], v[48:63]
    s_waitcnt vmcnt(9)
    v_add_u32 v208, 49184, v208
    ds_read_b128 a[128:131], v208 offset:0
    ds_read_b128 v[32:35], v208 offset:4096
    v_add_u32 v209, 49184, v209
    v_mfma_f32_32x32x16_bf16 v[64:79], v[176:179], v[24:27], v[64:79]
    s_waitcnt lgkmcnt(6)
    v_add_u32 v11, 49184, v11
    ds_read_b64_tr_b16 v[176:177], v11 offset:0
    ds_read_b64_tr_b16 v[178:179], v11 offset:256
    ds_read_b128 a[132:135], v209 offset:0
    ds_read_b128 v[36:39], v209 offset:4096
    v_mfma_f32_32x32x16_bf16 v[80:95], v[180:183], a[120:123], v[80:95]
    v_add_u32 v210, 49184, v210
    ds_read_b128 a[136:139], v210 offset:0
    ds_read_b128 v[40:43], v210 offset:4096
    v_add_u32 v211, 49184, v211
    ds_read_b128 a[140:143], v211 offset:0
    v_mfma_f32_32x32x16_bf16 v[96:111], v[180:183], v[24:27], v[96:111]
    s_waitcnt lgkmcnt(11)
    ds_read_b64_tr_b16 v[180:181], v11 offset:32
    ds_read_b64_tr_b16 v[182:183], v11 offset:288
    ds_read_b128 v[44:47], v211 offset:4096
    v_mfma_f32_32x32x16_bf16 v[112:127], v[184:187], a[120:123], v[112:127]
    v_mfma_f32_32x32x16_bf16 v[128:143], v[184:187], v[24:27], v[128:143]
    s_waitcnt lgkmcnt(12)
    ds_read_b64_tr_b16 v[184:185], v11 offset:512
    ds_read_b64_tr_b16 v[186:187], v11 offset:768
    v_mfma_f32_32x32x16_bf16 v[144:159], v[188:191], a[120:123], v[144:159]
    v_mfma_f32_32x32x16_bf16 v[160:175], v[188:191], v[24:27], v[160:175]
    s_waitcnt lgkmcnt(10)
    ds_read_b64_tr_b16 v[188:189], v11 offset:544
    ds_read_b64_tr_b16 v[190:191], v11 offset:800
    v_mfma_f32_32x32x16_bf16 v[48:63], v[176:179], a[124:127], v[48:63]
    v_mfma_f32_32x32x16_bf16 v[64:79], v[176:179], v[28:31], v[64:79]
    s_waitcnt lgkmcnt(5)
    v_mfma_f32_32x32x16_bf16 v[80:95], v[180:183], a[124:127], v[80:95]
    s_waitcnt lgkmcnt(0)
    s_barrier
    v_add_u32 v8, 49184, v8
    ds_read_b64_tr_b16 v[176:177], v8 offset:0
    ds_read_b64_tr_b16 v[178:179], v8 offset:256
    v_mfma_f32_32x32x16_bf16 v[96:111], v[180:183], v[28:31], v[96:111]
    ds_read_b64_tr_b16 v[180:181], v8 offset:32
    ds_read_b64_tr_b16 v[182:183], v8 offset:288
    v_mfma_f32_32x32x16_bf16 v[112:127], v[184:187], a[124:127], v[112:127]
    v_mfma_f32_32x32x16_bf16 v[128:143], v[184:187], v[28:31], v[128:143]
    ds_read_b64_tr_b16 v[184:185], v8 offset:512
    ds_read_b64_tr_b16 v[186:187], v8 offset:768
    v_mfma_f32_32x32x16_bf16 v[144:159], v[188:191], a[124:127], v[144:159]
    v_mfma_f32_32x32x16_bf16 v[160:175], v[188:191], v[28:31], v[160:175]
    s_waitcnt lgkmcnt(4)
    ds_read_b64_tr_b16 v[188:189], v8 offset:544
    ds_read_b64_tr_b16 v[190:191], v8 offset:800
    v_mfma_f32_16x16x32_bf16 v[192:195], v[232:235], v[176:179], v[192:195]
    s_lshl_b32 s60, s100, 12
    s_add_u32 m0, s44, 36896
    v_mfma_f32_32x32x16_bf16 v[48:63], v[176:179], a[128:131], v[48:63]
    s_add_u32 s60, s60, s80
    buffer_load_dwordx4 v6, s[8:11], s60 offen sc1 lds
    v_mfma_f32_32x32x16_bf16 v[64:79], v[176:179], v[32:35], v[64:79]
    s_waitcnt lgkmcnt(4)
    v_add_u32 v9, 49184, v9
    ds_read_b64_tr_b16 v[176:177], v9 offset:0
    ds_read_b64_tr_b16 v[178:179], v9 offset:256
    s_add_u32 s100, s100, 1
    s_cmp_eq_u32 s100, 9
    s_cselect_b32 s100, 0, s100
    v_mfma_f32_16x16x32_bf16 v[196:199], v[232:235], v[180:183], v[196:199]
    s_lshl_b32 s60, s100, 12
    s_add_u32 m0, s44, 40992
    v_mfma_f32_32x32x16_bf16 v[80:95], v[180:183], a[128:131], v[80:95]
    s_add_u32 s60, s60, s80
    buffer_load_dwordx4 v6, s[8:11], s60 offen sc1 lds
    v_mfma_f32_32x32x16_bf16 v[96:111], v[180:183], v[32:35], v[96:111]
    s_waitcnt lgkmcnt(4)
    ds_read_b64_tr_b16 v[180:181], v9 offset:32
    ds_read_b64_tr_b16 v[182:183], v9 offset:288
    s_add_u32 s100, s100, 1
    s_cmp_eq_u32 s100, 9
    s_cselect_b32 s100, 0, s100
    v_mfma_f32_16x16x32_bf16 v[200:203], v[232:235], v[184:187], v[200:203]
    s_lshl_b32 s60, s100, 12
    s_add_u32 m0, s44, 45088
    s_add_u32 s60, s60, s80
    v_mfma_f32_32x32x16_bf16 v[112:127], v[184:187], a[128:131], v[112:127]
    buffer_load_dwordx4 v6, s[8:11], s60 offen sc1 lds
    v_mfma_f32_32x32x16_bf16 v[128:143], v[184:187], v[32:35], v[128:143]
    s_waitcnt lgkmcnt(4)
    ds_read_b64_tr_b16 v[184:185], v9 offset:512
    ds_read_b64_tr_b16 v[186:187], v9 offset:768
    s_add_u32 s100, s100, 1
    s_cmp_eq_u32 s100, 9
    s_cselect_b32 s100, 0, s100
    v_mfma_f32_16x16x32_bf16 v[204:207], v[232:235], v[188:191], v[204:207]
    s_lshl_b32 s60, s100, 12
    s_add_u32 m0, s44, 49184
    s_add_u32 s60, s60, s80
    v_mfma_f32_32x32x16_bf16 v[144:159], v[188:191], a[128:131], v[144:159]
    buffer_load_dwordx4 v6, s[8:11], s60 offen sc1 lds
    s_add_u32 s100, s100, 1
    s_cmp_eq_u32 s100, 9
    s_cselect_b32 s100, 0, s100
    v_mfma_f32_32x32x16_bf16 v[160:175], v[188:191], v[32:35], v[160:175]
    s_waitcnt lgkmcnt(4)
    ds_read_b64_tr_b16 v[188:189], v9 offset:544
    ds_read_b64_tr_b16 v[190:191], v9 offset:800
    v_mfma_f32_32x32x16_bf16 v[48:63], v[176:179], a[132:135], v[48:63]
    s_lshl_b32 s60, s100, 12
    s_add_u32 m0, s44, 53280
    s_add_u32 s60, s60, s80
    v_mfma_f32_32x32x16_bf16 v[64:79], v[176:179], v[36:39], v[64:79]
    s_waitcnt lgkmcnt(4)
    v_add_u32 v10, 49184, v10
    ds_read_b64_tr_b16 v[176:177], v10 offset:0
    ds_read_b64_tr_b16 v[178:179], v10 offset:256
    buffer_load_dwordx4 v6, s[8:11], s60 offen sc1 lds
    v_mfma_f32_32x32x16_bf16 v[80:95], v[180:183], a[132:135], v[80:95]
    s_add_u32 s100, s100, 1
    s_cmp_eq_u32 s100, 9
    s_cselect_b32 s100, 0, s100
    s_lshl_b32 s60, s100, 12
    v_mfma_f32_32x32x16_bf16 v[96:111], v[180:183], v[36:39], v[96:111]
    s_waitcnt lgkmcnt(4)
    ds_read_b64_tr_b16 v[180:181], v10 offset:32
    ds_read_b64_tr_b16 v[182:183], v10 offset:288
    s_add_u32 m0, s44, 57376
    s_add_u32 s60, s60, s80
    v_mfma_f32_32x32x16_bf16 v[112:127], v[184:187], a[132:135], v[112:127]
    buffer_load_dwordx4 v6, s[8:11], s60 offen sc1 lds
    s_add_u32 s100, s100, 1
    s_cmp_eq_u32 s100, 9
    s_cselect_b32 s100, 0, s100
    v_mfma_f32_32x32x16_bf16 v[128:143], v[184:187], v[36:39], v[128:143]
    s_waitcnt lgkmcnt(4)
    ds_read_b64_tr_b16 v[184:185], v10 offset:512
    ds_read_b64_tr_b16 v[186:187], v10 offset:768
    s_lshl_b32 s60, s100, 12
    s_mov_b64 exec, 0xffff
    ds_write_b64 v244, v[192:193] offset:0
    s_mov_b64 exec, -1
    v_mfma_f32_32x32x16_bf16 v[144:159], v[188:191], a[132:135], v[144:159]
    s_add_u32 m0, s44, 61472
    s_add_u32 s60, s60, s80
    buffer_load_dwordx4 v6, s[8:11], s60 offen sc1 lds
    s_mov_b64 exec, 0xffff
    ds_write_b64 v244, v[196:197] offset:512
    s_mov_b64 exec, -1
    v_mfma_f32_32x32x16_bf16 v[160:175], v[188:191], v[36:39], v[160:175]
    s_waitcnt lgkmcnt(6)
    ds_read_b64_tr_b16 v[188:189], v10 offset:544
    ds_read_b64_tr_b16 v[190:191], v10 offset:800
    s_add_u32 s100, s100, 1
    s_cmp_eq_u32 s100, 9
    s_cselect_b32 s100, 0, s100
    v_cmp_eq_u64 vcc, s[58:59], v[218:219]
    v_cmp_eq_u64 s[42:43], s[58:59], v[222:223]
    s_nop 0
    s_and_b64 vcc, vcc, s[42:43]
    s_nop 1
    s_cmp_eq_u64 vcc, -1
    s_cbranch_scc0 LS_slow
LS_ok:
    v_mfma_f32_32x32x16_bf16 v[48:63], v[176:179], a[136:139], v[48:63]
    s_lshl_b32 s60, s100, 12
    v_cmp_gt_u32 vcc, 32, v1
    v_cvt_pk_bf16_f32 v216, -v216, -v216
    v_mul_f32 v230, s55, v217
    v_cvt_pk_bf16_f32 v220, -v220, -v220
    v_mul_f32 v231, s55, v221
    v_cndmask_b32 v226, v225, v216, vcc
    v_mfma_f32_32x32x16_bf16 v[64:79], v[176:179], v[40:43], v[64:79]
    s_waitcnt lgkmcnt(6)
    v_add_u32 v11, 49184, v11
    ds_read_b64_tr_b16 v[176:177], v11 offset:0
    ds_read_b64_tr_b16 v[178:179], v11 offset:256
    s_add_u32 m0, s44, 65568
    s_add_u32 s60, s60, s80
    v_cndmask_b32 v228, v225, v220, vcc
    v_mfma_f32_32x32x16_bf16 v[80:95], v[180:183], a[136:139], v[80:95]
    buffer_load_dwordx4 v6, s[8:11], s60 offen sc1 lds
    s_add_u32 s100, s100, 1
    s_cmp_eq_u32 s100, 9
    s_cselect_b32 s100, 0, s100
    v_mfma_f32_32x32x16_bf16 v[96:111], v[180:183], v[40:43], v[96:111]
    s_waitcnt lgkmcnt(6)
    ds_read_b64_tr_b16 v[180:181], v11 offset:32
    ds_read_b64_tr_b16 v[182:183], v11 offset:288
    s_lshl_b32 s60, s100, 12
    s_add_u32 m0, s44, 69664
    v_mfma_f32_32x32x16_bf16 v[112:127], v[184:187], a[136:139], v[112:127]
    s_add_u32 s60, s60, s80
    buffer_load_dwordx4 v6, s[8:11], s60 offen sc1 lds
    s_mov_b64 exec, 0xffff
    ds_write_b64 v244, v[200:201] offset:1024
    s_mov_b64 exec, -1
    v_mfma_f32_32x32x16_bf16 v[128:143], v[184:187], v[40:43], v[128:143]
    s_waitcnt lgkmcnt(5)
    ds_read_b64_tr_b16 v[184:185], v11 offset:512
    ds_read_b64_tr_b16 v[186:187], v11 offset:768
    s_add_u32 s100, s100, 1
    s_cmp_eq_u32 s100, 9
    s_cselect_b32 s100, 0, s100
    v_mfma_f32_32x32x16_bf16 v[144:159], v[188:191], a[136:139], v[144:159]
    s_mov_b64 exec, 0xffff
    ds_write_b64 v244, v[204:205] offset:1536
    s_mov_b64 exec, -1
    v_mfma_f32_32x32x16_bf16 v[160:175], v[188:191], v[40:43], v[160:175]
    s_waitcnt lgkmcnt(6)
    ds_read_b64_tr_b16 v[188:189], v11 offset:544
    ds_read_b64_tr_b16 v[190:191], v11 offset:800
    v_mfma_f32_32x32x16_bf16 v[48:63], v[176:179], a[140:143], v[48:63]
    v_mfma_f32_32x32x16_bf16 v[64:79], v[176:179], v[44:47], v[64:79]
    s_waitcnt lgkmcnt(6)
    v_mfma_f32_32x32x16_bf16 v[80:95], v[180:183], a[140:143], v[80:95]
    s_waitcnt vmcnt(9)
    s_waitcnt lgkmcnt(0)
    s_barrier
    s_add_u32 s57, s66, 0
    v_add_u32 v8, s57, v6
    ds_read_b128 v[176:179], v8 offset:0
    v_mfma_f32_32x32x16_bf16 v[96:111], v[180:183], v[44:47], v[96:111]
    s_add_u32 s57, s67, 0
    v_add_u32 v9, s57, v6
    ds_read_b128 v[180:183], v9 offset:0
    v_mfma_f32_32x32x16_bf16 v[112:127], v[184:187], a[140:143], v[112:127]
    s_mul_i32 s60, s100, 589824
    v_mfma_f32_32x32x16_bf16 v[128:143], v[184:187], v[44:47], v[128:143]
    s_add_u32 s57, s68, 0
    v_add_u32 v10, s57, v6
    ds_read_b128 v[184:187], v10 offset:0
    s_add_u32 m0, s44, 73760
    ds_read_b32 v248, v245 offset:0
    ds_read_b32 v249, v245 offset:128
    v_mfma_f32_32x32x16_bf16 v[144:159], v[188:191], a[140:143], v[144:159]
    s_add_u32 s60, s60, s47
    ds_read_b32 v250, v245 offset:256
    ds_read_b32 v251, v245 offset:384
    v_mfma_f32_32x32x16_bf16 v[160:175], v[188:191], v[44:47], v[160:175]
    s_waitcnt lgkmcnt(6)
    s_add_u32 s57, s69, 0
    v_add_u32 v11, s57, v6
    ds_read_b128 v[188:191], v11 offset:0
    buffer_load_dwordx4 v2, s[12:15], s60 offen lds
    v_mfma_f32_16x16x32_bf16 v[236:239], v[232:235], v[176:179], 0
    v_mfma_f32_32x32x16_bf16 v[192:207], v[176:179], a[0:3], 0
    s_add_u32 m0, s44, 110656
    s_waitcnt lgkmcnt(3)
    v_add_f32 v248, v248, v249
    v_mfma_f32_32x32x16_bf16 v[208:223], v[176:179], a[144:147], 0
    ds_read_b128 v[176:179], v8 offset:4096
    s_add_u32 s100, s100, 1
    s_cmp_eq_u32 s100, 9
    s_cselect_b32 s100, 0, s100
    s_waitcnt lgkmcnt(2)
    v_add_f32 v250, v250, v251
    v_add_f32 v248, v248, v250
    v_mfma_f32_32x32x16_bf16 v[192:207], v[180:183], a[4:7], v[192:207]
    v_cvt_pk_bf16_f32 v249, v248, v248
    v_lshlrev_b32 v249, 16, v249
    v_sub_f32 v249, v248, v249
    v_cvt_pk_bf16_f32 v224, v248, v249
    v_mfma_f32_32x32x16_bf16 v[208:223], v[180:183], a[148:151], v[208:223]
    ds_read_b128 v[180:183], v9 offset:4096
    v_mfma_f32_32x32x8_bf16 v[48:63], v[224:225], v[226:227], v[48:63]
    v_mfma_f32_32x32x8_bf16 v[64:79], v[224:225], v[228:229], v[64:79]
    ds_read_b32 v248, v245 offset:512
    v_mfma_f32_32x32x16_bf16 v[192:207], v[184:187], a[8:11], v[192:207]
    buffer_load_dwordx4 v2, s[16:19], s60 offen lds
    ds_read_b32 v249, v245 offset:640
    ds_read_b32 v250, v245 offset:768
    ds_read_b32 v251, v245 offset:896
    v_mfma_f32_32x32x16_bf16 v[208:223], v[184:187], a[152:155], v[208:223]
    s_waitcnt lgkmcnt(6)
    ds_read_b128 v[184:187], v10 offset:4096
    v_mfma_f32_32x32x16_bf16 v[192:207], v[188:191], a[12:15], v[192:207]
    s_mul_i32 s60, s100, 589824
    v_mfma_f32_32x32x16_bf16 v[208:223], v[188:191], a[156:159], v[208:223]
    s_waitcnt lgkmcnt(6)
    ds_read_b128 v[188:191], v11 offset:4096
    s_add_u32 m0, s44, 77856
    s_add_u32 s60, s60, s47
    v_mfma_f32_16x16x32_bf16 v[236:239], v[232:235], v[176:179], v[236:239]
    buffer_load_dwordx4 v2, s[12:15], s60 offen lds
    v_mfma_f32_32x32x16_bf16 v[192:207], v[176:179], a[16:19], v[192:207]
    s_waitcnt lgkmcnt(4)
    v_add_f32 v248, v248, v249
    s_waitcnt lgkmcnt(2)
    v_add_f32 v250, v250, v251
    v_add_f32 v248, v248, v250
    v_cvt_pk_bf16_f32 v249, v248, v248
    v_lshlrev_b32 v249, 16, v249
    v_sub_f32 v249, v248, v249
    v_mfma_f32_32x32x16_bf16 v[208:223], v[176:179], a[160:163], v[208:223]
    ds_read_b128 v[176:179], v8 offset:8192
    s_add_u32 m0, s44, 114752
    v_cvt_pk_bf16_f32 v224, v248, v249
    v_mfma_f32_32x32x16_bf16 v[192:207], v[180:183], a[20:23], v[192:207]
    s_add_u32 s100, s100, 1
    s_cmp_eq_u32 s100, 9
    s_cselect_b32 s100, 0, s100
    v_mfma_f32_32x32x8_bf16 v[80:95], v[224:225], v[226:227], v[80:95]
    v_mfma_f32_32x32x16_bf16 v[208:223], v[180:183], a[164:167], v[208:223]
    s_waitcnt lgkmcnt(2)
    ds_read_b128 v[180:183], v9 offset:8192
    v_mfma_f32_32x32x8_bf16 v[96:111], v[224:225], v[228:229], v[96:111]
    v_mul_f32 v248, v230, v48
    v_mul_f32 v249, v230, v49
    v_mul_f32 v250, v230, v50
    v_mfma_f32_32x32x16_bf16 v[192:207], v[184:187], a[24:27], v[192:207]
    v_mul_f32 v251, v230, v51
    v_mul_f32 v252, v230, v52
    v_mul_f32 v253, v230, v53
    v_mul_f32 v254, v230, v54
    v_mul_f32 v255, v230, v55
    v_mfma_f32_32x32x16_bf16 v[208:223], v[184:187], a[168:171], v[208:223]
    s_waitcnt lgkmcnt(2)
    ds_read_b128 v[184:187], v10 offset:8192
    buffer_load_dwordx4 v2, s[16:19], s60 offen lds
    v_exp_f32 v248, v248
    v_mfma_f32_32x32x16_bf16 v[192:207], v[188:191], a[28:31], v[192:207]
    v_exp_f32 v249, v249
    v_exp_f32 v250, v250
    v_exp_f32 v251, v251
    v_mfma_f32_32x32x16_bf16 v[208:223], v[188:191], a[172:175], v[208:223]
    s_waitcnt lgkmcnt(2)
    ds_read_b128 v[188:191], v11 offset:8192
    s_mul_i32 s60, s100, 589824
    v_exp_f32 v252, v252
    v_exp_f32 v253, v253
    v_mfma_f32_16x16x32_bf16 v[236:239], v[232:235], v[176:179], v[236:239]
    s_add_u32 m0, s44, 81952
    v_exp_f32 v254, v254
    v_mfma_f32_32x32x16_bf16 v[192:207], v[176:179], a[32:35], v[192:207]
    s_add_u32 s60, s60, s47
    v_exp_f32 v255, v255
    v_mul_f32 v48, v48, v56
    v_mul_f32 v49, v49, v57
    v_mul_f32 v50, v50, v58
    v_mul_f32 v51, v51, v59
    v_mfma_f32_32x32x16_bf16 v[208:223], v[176:179], a[176:179], v[208:223]
    s_waitcnt lgkmcnt(2)
    ds_read_b128 v[176:179], v8 offset:12288
    buffer_load_dwordx4 v2, s[12:15], s60 offen lds
    v_mul_f32 v52, v52, v60
    v_mul_f32 v53, v53, v61
    v_mul_f32 v54, v54, v62
    v_mfma_f32_32x32x16_bf16 v[192:207], v[180:183], a[36:39], v[192:207]
    v_mul_f32 v55, v55, v63
    v_add_f32 v248, 1.0, v248
    v_add_f32 v249, 1.0, v249
    v_add_f32 v250, 1.0, v250
    v_add_f32 v251, 1.0, v251
    v_add_f32 v252, 1.0, v252
    v_mfma_f32_32x32x16_bf16 v[208:223], v[180:183], a[180:183], v[208:223]
    s_waitcnt lgkmcnt(2)
    ds_read_b128 v[180:183], v9 offset:12288
    s_add_u32 m0, s44, 118848
    v_add_f32 v253, 1.0, v253
    v_add_f32 v254, 1.0, v254
    v_add_f32 v255, 1.0, v255
    v_mfma_f32_32x32x16_bf16 v[192:207], v[184:187], a[40:43], v[192:207]
    s_add_u32 s100, s100, 1
    s_cmp_eq_u32 s100, 9
    s_cselect_b32 s100, 0, s100
    v_rcp_f32 v248, v248
    v_mfma_f32_32x32x16_bf16 v[208:223], v[184:187], a[184:187], v[208:223]
    s_waitcnt lgkmcnt(2)
    ds_read_b128 v[184:187], v10 offset:12288
    v_rcp_f32 v249, v249
    v_rcp_f32 v250, v250
    v_mfma_f32_32x32x16_bf16 v[192:207], v[188:191], a[44:47], v[192:207]
    v_rcp_f32 v251, v251
    v_rcp_f32 v252, v252
    v_rcp_f32 v253, v253
    v_mfma_f32_32x32x16_bf16 v[208:223], v[188:191], a[188:191], v[208:223]
    s_waitcnt lgkmcnt(2)
    ds_read_b128 v[188:191], v11 offset:12288
    buffer_load_dwordx4 v2, s[16:19], s60 offen lds
    v_rcp_f32 v254, v254
    v_mfma_f32_16x16x32_bf16 v[236:239], v[232:235], v[176:179], v[236:239]
    v_rcp_f32 v255, v255
    v_mfma_f32_32x32x16_bf16 v[192:207], v[176:179], a[48:51], v[192:207]
    s_mul_i32 s60, s100, 589824
    s_add_u32 s61, s50, 0
    v_mul_f32 v48, v48, v248
    v_mul_f32 v49, v49, v249
    v_mul_f32 v50, v50, v250
    v_mul_f32 v51, v51, v251
    v_mul_f32 v52, v52, v252
    v_mfma_f32_32x32x16_bf16 v[208:223], v[176:179], a[192:195], v[208:223]
    s_waitcnt lgkmcnt(2)
    ds_read_b128 v[176:179], v8 offset:16384
    s_add_u32 m0, s44, 86048
    v_mul_f32 v53, v53, v253
    v_mul_f32 v54, v54, v254
    v_mul_f32 v55, v55, v255
    v_cvt_pk_bf16_f32 v56, v48, v49
    v_mfma_f32_32x32x16_bf16 v[192:207], v[180:183], a[52:55], v[192:207]
    s_add_u32 s60, s60, s47
    v_cvt_pk_bf16_f32 v57, v50, v51
    v_cvt_pk_bf16_f32 v58, v52, v53
    v_cvt_pk_bf16_f32 v59, v54, v55
    buffer_store_dwordx4 v[56:59], v3, s[20:23], s61 offen sc1
    v_mul_f32 v248, v231, v64
    v_mfma_f32_32x32x16_bf16 v[208:223], v[180:183], a[196:199], v[208:223]
    s_waitcnt lgkmcnt(2)
    ds_read_b128 v[180:183], v9 offset:16384
    buffer_load_dwordx4 v2, s[12:15], s60 offen lds
    v_mul_f32 v249, v231, v65
    v_mul_f32 v250, v231, v66
    v_mul_f32 v251, v231, v67
    v_mfma_f32_32x32x16_bf16 v[192:207], v[184:187], a[56:59], v[192:207]
    s_add_u32 m0, s44, 122944
    v_mul_f32 v252, v231, v68
    v_mul_f32 v253, v231, v69
    v_mul_f32 v254, v231, v70
    v_mul_f32 v255, v231, v71
    v_exp_f32 v248, v248
    v_mfma_f32_32x32x16_bf16 v[208:223], v[184:187], a[200:203], v[208:223]
    s_waitcnt lgkmcnt(2)
    ds_read_b128 v[184:187], v10 offset:16384
    s_add_u32 s100, s100, 1
    s_cmp_eq_u32 s100, 9
    s_cselect_b32 s100, 0, s100
    v_exp_f32 v249, v249
    v_mfma_f32_32x32x16_bf16 v[192:207], v[188:191], a[60:63], v[192:207]
    v_exp_f32 v250, v250
    v_exp_f32 v251, v251
    v_exp_f32 v252, v252
    v_mfma_f32_32x32x16_bf16 v[208:223], v[188:191], a[204:207], v[208:223]
    s_waitcnt lgkmcnt(2)
    ds_read_b128 v[188:191], v11 offset:16384
    v_exp_f32 v253, v253
    v_exp_f32 v254, v254
    v_mfma_f32_16x16x32_bf16 v[236:239], v[232:235], v[176:179], v[236:239]
    buffer_load_dwordx4 v2, s[16:19], s60 offen lds
    v_mfma_f32_32x32x16_bf16 v[192:207], v[176:179], a[64:67], v[192:207]
    v_exp_f32 v255, v255
    v_mul_f32 v64, v64, v72
    v_mul_f32 v65, v65, v73
    v_mul_f32 v66, v66, v74
    v_mul_f32 v67, v67, v75
    v_mfma_f32_32x32x16_bf16 v[208:223], v[176:179], a[208:211], v[208:223]
    s_waitcnt lgkmcnt(2)
    ds_read_b128 v[176:179], v8 offset:20480
    s_mul_i32 s60, s100, 589824
    v_mul_f32 v68, v68, v76
    v_mul_f32 v69, v69, v77
    v_mul_f32 v70, v70, v78
    v_mul_f32 v71, v71, v79
    v_mfma_f32_32x32x16_bf16 v[192:207], v[180:183], a[68:71], v[192:207]
    s_add_u32 m0, s44, 90144
    v_add_f32 v248, 1.0, v248
    v_add_f32 v249, 1.0, v249
    v_add_f32 v250, 1.0, v250
    v_add_f32 v251, 1.0, v251
    v_add_f32 v252, 1.0, v252
    v_add_f32 v253, 1.0, v253
    v_mfma_f32_32x32x16_bf16 v[208:223], v[180:183], a[212:215], v[208:223]
    s_waitcnt lgkmcnt(2)
    ds_read_b128 v[180:183], v9 offset:20480
    s_add_u32 s60, s60, s47
    v_add_f32 v254, 1.0, v254
    v_add_f32 v255, 1.0, v255
    v_rcp_f32 v248, v248
    v_mfma_f32_32x32x16_bf16 v[192:207], v[184:187], a[72:75], v[192:207]
    buffer_load_dwordx4 v2, s[12:15], s60 offen lds
    v_rcp_f32 v249, v249
    v_rcp_f32 v250, v250
    v_mfma_f32_32x32x16_bf16 v[208:223], v[184:187], a[216:219], v[208:223]
    s_waitcnt lgkmcnt(2)
    ds_read_b128 v[184:187], v10 offset:20480
    v_rcp_f32 v251, v251
    v_rcp_f32 v252, v252
    v_mfma_f32_32x32x16_bf16 v[192:207], v[188:191], a[76:79], v[192:207]
    s_add_u32 m0, s44, 127040
    v_rcp_f32 v253, v253
    v_rcp_f32 v254, v254
    v_rcp_f32 v255, v255
    v_mfma_f32_32x32x16_bf16 v[208:223], v[188:191], a[220:223], v[208:223]
    s_waitcnt lgkmcnt(2)
    ds_read_b128 v[188:191], v11 offset:20480
    s_add_u32 s100, s100, 1
    s_cmp_eq_u32 s100, 9
    s_cselect_b32 s100, 0, s100
    s_add_u32 s61, s50, 294912
    v_mul_f32 v64, v64, v248
    v_mfma_f32_16x16x32_bf16 v[236:239], v[232:235], v[176:179], v[236:239]
    v_mul_f32 v65, v65, v249
    v_mul_f32 v66, v66, v250
    v_mfma_f32_32x32x16_bf16 v[192:207], v[176:179], a[80:83], v[192:207]
    v_mul_f32 v67, v67, v251
    v_mul_f32 v68, v68, v252
    v_mul_f32 v69, v69, v253
    v_mul_f32 v70, v70, v254
    v_mul_f32 v71, v71, v255
    v_cvt_pk_bf16_f32 v72, v64, v65
    v_mfma_f32_32x32x16_bf16 v[208:223], v[176:179], a[224:227], v[208:223]
    s_waitcnt lgkmcnt(2)
    ds_read_b128 v[176:179], v8 offset:24576
    buffer_load_dwordx4 v2, s[16:19], s60 offen lds
    v_cvt_pk_bf16_f32 v73, v66, v67
    v_cvt_pk_bf16_f32 v74, v68, v69
    v_cvt_pk_bf16_f32 v75, v70, v71
    v_mfma_f32_32x32x16_bf16 v[192:207], v[180:183], a[84:87], v[192:207]
    buffer_store_dwordx4 v[72:75], v3, s[20:23], s61 offen sc1
    ds_read_b32 v248, v245 offset:1024
    ds_read_b32 v249, v245 offset:1152
    ds_read_b32 v250, v245 offset:1280
    ds_read_b32 v251, v245 offset:1408
    v_mfma_f32_32x32x16_bf16 v[208:223], v[180:183], a[228:231], v[208:223]
    s_waitcnt lgkmcnt(6)
    ds_read_b128 v[180:183], v9 offset:24576
    s_mul_i32 s60, s100, 589824
    v_mfma_f32_32x32x16_bf16 v[192:207], v[184:187], a[88:91], v[192:207]
    s_add_u32 m0, s44, 94240
    s_waitcnt lgkmcnt(3)
    v_add_f32 v248, v248, v249
    s_waitcnt lgkmcnt(1)
    v_add_f32 v250, v250, v251
    v_add_f32 v248, v248, v250
    v_cvt_pk_bf16_f32 v249, v248, v248
    v_lshlrev_b32 v249, 16, v249
    v_sub_f32 v249, v248, v249
    v_cvt_pk_bf16_f32 v224, v248, v249
    s_nop 1
    v_mfma_f32_32x32x8_bf16 v[112:127], v[224:225], v[226:227], v[112:127]
    v_mfma_f32_32x32x8_bf16 v[128:143], v[224:225], v[228:229], v[128:143]
    v_mfma_f32_32x32x16_bf16 v[208:223], v[184:187], a[232:235], v[208:223]
    ds_read_b128 v[184:187], v10 offset:24576
    s_add_u32 s60, s60, s47
    v_mul_f32 v248, v230, v80
    v_mul_f32 v249, v230, v81
    v_mul_f32 v250, v230, v82
    v_mfma_f32_32x32x16_bf16 v[192:207], v[188:191], a[92:95], v[192:207]
    buffer_load_dwordx4 v2, s[12:15], s60 offen lds
    v_mul_f32 v251, v230, v83
    v_mul_f32 v252, v230, v84
    v_mul_f32 v253, v230, v85
    v_mul_f32 v254, v230, v86
    v_mfma_f32_32x32x16_bf16 v[208:223], v[188:191], a[236:239], v[208:223]
    ds_read_b128 v[188:191], v11 offset:24576
    v_mul_f32 v255, v230, v87
    v_exp_f32 v248, v248
    v_exp_f32 v249, v249
    v_mfma_f32_16x16x32_bf16 v[236:239], v[232:235], v[176:179], v[236:239]
    s_add_u32 m0, s44, 131136
    v_exp_f32 v250, v250
    v_mfma_f32_32x32x16_bf16 v[192:207], v[176:179], a[96:99], v[192:207]
    s_add_u32 s100, s100, 1
    s_cmp_eq_u32 s100, 9
    s_cselect_b32 s100, 0, s100
    v_exp_f32 v251, v251
    v_mfma_f32_32x32x16_bf16 v[208:223], v[176:179], a[240:243], v[208:223]
    s_waitcnt lgkmcnt(2)
    ds_read_b128 v[176:179], v8 offset:28672
    v_exp_f32 v252, v252
    v_exp_f32 v253, v253
    v_mfma_f32_32x32x16_bf16 v[192:207], v[180:183], a[100:103], v[192:207]
    buffer_load_dwordx4 v2, s[16:19], s60 offen lds
    v_exp_f32 v254, v254
    v_exp_f32 v255, v255
    v_mfma_f32_32x32x16_bf16 v[208:223], v[180:183], a[244:247], v[208:223]
    s_waitcnt lgkmcnt(2)
    ds_read_b128 v[180:183], v9 offset:28672
    v_mul_f32 v80, v80, v88
    v_mul_f32 v81, v81, v89
    v_mul_f32 v82, v82, v90
    v_mul_f32 v83, v83, v91
    v_mul_f32 v84, v84, v92
    v_mfma_f32_32x32x16_bf16 v[192:207], v[184:187], a[104:107], v[192:207]
    s_mul_i32 s60, s100, 589824
    v_mul_f32 v85, v85, v93
    v_mul_f32 v86, v86, v94
    v_mul_f32 v87, v87, v95
    v_add_f32 v248, 1.0, v248
    v_add_f32 v249, 1.0, v249
    v_add_f32 v250, 1.0, v250
    v_mfma_f32_32x32x16_bf16 v[208:223], v[184:187], a[248:251], v[208:223]
    s_waitcnt lgkmcnt(2)
    ds_read_b128 v[184:187], v10 offset:28672
    s_add_u32 m0, s44, 98336
    v_add_f32 v251, 1.0, v251
    v_add_f32 v252, 1.0, v252
    v_add_f32 v253, 1.0, v253
    v_add_f32 v254, 1.0, v254
    v_mfma_f32_32x32x16_bf16 v[192:207], v[188:191], a[108:111], v[192:207]
    s_add_u32 s60, s60, s47
    v_add_f32 v255, 1.0, v255
    v_rcp_f32 v248, v248
    v_rcp_f32 v249, v249
    v_mfma_f32_32x32x16_bf16 v[208:223], v[188:191], a[252:255], v[208:223]
    s_waitcnt lgkmcnt(2)
    ds_read_b128 v[188:191], v11 offset:28672
    buffer_load_dwordx4 v2, s[12:15], s60 offen lds
    v_rcp_f32 v250, v250
    v_mfma_f32_16x16x32_bf16 v[236:239], v[232:235], v[176:179], v[236:239]
    v_rcp_f32 v251, v251
    v_mfma_f32_32x32x16_bf16 v[192:207], v[176:179], a[112:115], v[192:207]
    s_add_u32 m0, s44, 135232
    v_rcp_f32 v252, v252
    v_rcp_f32 v253, v253
    v_rcp_f32 v254, v254
    v_mfma_f32_32x32x16_bf16 v[208:223], v[176:179], v[16:19], v[208:223]
    s_waitcnt lgkmcnt(2)
    ds_read_b128 v[176:179], v8 offset:32768
    s_add_u32 s100, s100, 1
    s_cmp_eq_u32 s100, 9
    s_cselect_b32 s100, 0, s100
    v_rcp_f32 v255, v255
    v_mfma_f32_32x32x16_bf16 v[192:207], v[180:183], a[116:119], v[192:207]
    s_add_u32 s61, s50, 512
    v_mul_f32 v80, v80, v248
    v_mul_f32 v81, v81, v249
    v_mul_f32 v82, v82, v250
    v_mul_f32 v83, v83, v251
    v_mul_f32 v84, v84, v252
    v_mul_f32 v85, v85, v253
    v_mfma_f32_32x32x16_bf16 v[208:223], v[180:183], v[20:23], v[208:223]
    s_waitcnt lgkmcnt(2)
    ds_read_b128 v[180:183], v9 offset:32768
    v_mul_f32 v86, v86, v254
    v_mul_f32 v87, v87, v255
    v_cvt_pk_bf16_f32 v88, v80, v81
    v_cvt_pk_bf16_f32 v89, v82, v83
    v_cvt_pk_bf16_f32 v90, v84, v85
    v_mfma_f32_32x32x16_bf16 v[192:207], v[184:187], a[120:123], v[192:207]
    buffer_load_dwordx4 v2, s[16:19], s60 offen lds
    v_cvt_pk_bf16_f32 v91, v86, v87
    buffer_store_dwordx4 v[88:91], v3, s[20:23], s61 offen sc1
    v_mul_f32 v248, v231, v96
    v_mfma_f32_32x32x16_bf16 v[208:223], v[184:187], v[24:27], v[208:223]
    s_waitcnt lgkmcnt(2)
    ds_read_b128 v[184:187], v10 offset:32768
    v_mul_f32 v249, v231, v97
    v_mul_f32 v250, v231, v98
    v_mul_f32 v251, v231, v99
    v_mul_f32 v252, v231, v100
    v_mul_f32 v253, v231, v101
    v_mfma_f32_32x32x16_bf16 v[192:207], v[188:191], a[124:127], v[192:207]
    s_mul_i32 s60, s100, 589824
    v_mul_f32 v254, v231, v102
    v_mul_f32 v255, v231, v103
    v_exp_f32 v248, v248
    v_exp_f32 v249, v249
    v_mfma_f32_32x32x16_bf16 v[208:223], v[188:191], v[28:31], v[208:223]
    s_waitcnt lgkmcnt(2)
    ds_read_b128 v[188:191], v11 offset:32768
    s_add_u32 m0, s44, 102432
    v_exp_f32 v250, v250
    v_exp_f32 v251, v251
    v_mfma_f32_16x16x32_bf16 v[236:239], v[232:235], v[176:179], v[236:239]
    s_add_u32 s60, s60, s47
    v_exp_f32 v252, v252
    v_mfma_f32_32x32x16_bf16 v[192:207], v[176:179], a[128:131], v[192:207]
    buffer_load_dwordx4 v2, s[12:15], s60 offen lds
    v_exp_f32 v253, v253
    v_exp_f32 v254, v254
    v_mfma_f32_32x32x16_bf16 v[208:223], v[176:179], v[32:35], v[208:223]
    s_waitcnt lgkmcnt(2)
    v_exp_f32 v255, v255
    v_mul_f32 v96, v96, v104
    v_mul_f32 v97, v97, v105
    v_mul_f32 v98, v98, v106
    v_mul_f32 v99, v99, v107
    v_mfma_f32_32x32x16_bf16 v[192:207], v[180:183], a[132:135], v[192:207]
    s_waitcnt vmcnt(18)
    s_waitcnt lgkmcnt(0)
    s_barrier
    s_add_u32 s57, s66, 36896
    v_add_u32 v8, s57, v6
    ds_read_b128 v[176:179], v8 offset:0
    s_add_u32 m0, s44, 139328
    v_mul_f32 v100, v100, v108
    v_mfma_f32_32x32x16_bf16 v[208:223], v[180:183], v[36:39], v[208:223]
    s_add_u32 s57, s67, 36896
    v_add_u32 v9, s57, v6
    ds_read_b128 v[180:183], v9 offset:0
    s_add_u32 s100, s100, 1
    s_cmp_eq_u32 s100, 9
    s_cselect_b32 s100, 0, s100
    v_mul_f32 v101, v101, v109
    v_mul_f32 v102, v102, v110
    v_mfma_f32_32x32x16_bf16 v[192:207], v[184:187], a[136:139], v[192:207]
    v_mul_f32 v103, v103, v111
    v_add_f32 v248, 1.0, v248
    v_add_f32 v249, 1.0, v249
    v_add_f32 v250, 1.0, v250
    v_add_f32 v251, 1.0, v251
    v_add_f32 v252, 1.0, v252
    v_add_f32 v253, 1.0, v253
    v_mfma_f32_32x32x16_bf16 v[208:223], v[184:187], v[40:43], v[208:223]
    s_add_u32 s57, s68, 36896
    v_add_u32 v10, s57, v6
    ds_read_b128 v[184:187], v10 offset:0
    v_add_f32 v254, 1.0, v254
    v_add_f32 v255, 1.0, v255
    v_rcp_f32 v248, v248
    v_rcp_f32 v249, v249
    v_mfma_f32_32x32x16_bf16 v[192:207], v[188:191], a[140:143], v[192:207]
    buffer_load_dwordx4 v2, s[16:19], s60 offen lds
    v_rcp_f32 v250, v250
    v_rcp_f32 v251, v251
    v_rcp_f32 v252, v252
    v_mfma_f32_32x32x16_bf16 v[208:223], v[188:191], v[44:47], v[208:223]
    s_waitcnt lgkmcnt(2)
    s_add_u32 s57, s69, 36896
    v_add_u32 v11, s57, v6
    ds_read_b128 v[188:191], v11 offset:0
    s_mul_i32 s60, s100, 589824
    v_rcp_f32 v253, v253
    v_rcp_f32 v254, v254
    v_mfma_f32_16x16x32_bf16 v[240:243], v[232:235], v[176:179], 0
    s_add_u32 m0, s44, 106528
    v_rcp_f32 v255, v255
    v_mfma_f32_32x32x16_bf16 v[48:63], v[176:179], a[0:3], 0
    s_add_u32 s60, s60, s47
    s_add_u32 s61, s50, 295424
    v_mul_f32 v96, v96, v248
    v_mul_f32 v97, v97, v249
    v_mul_f32 v98, v98, v250
    v_mul_f32 v99, v99, v251
    v_mul_f32 v100, v100, v252
    v_mul_f32 v101, v101, v253
    v_mul_f32 v102, v102, v254
    v_mfma_f32_32x32x16_bf16 v[64:79], v[176:179], a[144:147], 0
    s_waitcnt lgkmcnt(2)
    ds_read_b128 v[176:179], v8 offset:4096
    buffer_load_dwordx4 v2, s[12:15], s60 offen lds
    v_mul_f32 v103, v103, v255
    v_cvt_pk_bf16_f32 v104, v96, v97
    v_cvt_pk_bf16_f32 v105, v98, v99
    v_cvt_pk_bf16_f32 v106, v100, v101
    v_cvt_pk_bf16_f32 v107, v102, v103
    v_mfma_f32_32x32x16_bf16 v[48:63], v[180:183], a[4:7], v[48:63]
    buffer_store_dwordx4 v[104:107], v3, s[20:23], s61 offen sc1
    ds_read_b32 v248, v245 offset:1536
    ds_read_b32 v249, v245 offset:1664
    ds_read_b32 v250, v245 offset:1792
    ds_read_b32 v251, v245 offset:1920
    v_mfma_f32_32x32x16_bf16 v[64:79], v[180:183], a[148:151], v[64:79]
    s_waitcnt lgkmcnt(6)
    ds_read_b128 v[180:183], v9 offset:4096
    s_add_u32 m0, s44, 143424
    s_waitcnt lgkmcnt(3)
    v_add_f32 v248, v248, v249
    s_waitcnt lgkmcnt(1)
    v_add_f32 v250, v250, v251
    v_add_f32 v248, v248, v250
    v_cvt_pk_bf16_f32 v249, v248, v248
    v_lshlrev_b32 v249, 16, v249
    v_sub_f32 v249, v248, v249
    v_cvt_pk_bf16_f32 v224, v248, v249
    s_nop 1
    v_mfma_f32_32x32x8_bf16 v[144:159], v[224:225], v[226:227], v[144:159]
    v_mfma_f32_32x32x8_bf16 v[160:175], v[224:225], v[228:229], v[160:175]
    v_mfma_f32_32x32x16_bf16 v[48:63], v[184:187], a[8:11], v[48:63]
    s_add_u32 s100, s100, 1
    s_cmp_eq_u32 s100, 9
    s_cselect_b32 s100, 0, s100
    v_mul_f32 v248, v230, v112
    v_mul_f32 v249, v230, v113
    v_mul_f32 v250, v230, v114
    s_mov_b64 exec, 0xffff
    ds_write_b64 v244, v[236:237] offset:2048
    s_mov_b64 exec, -1
    v_mfma_f32_32x32x16_bf16 v[64:79], v[184:187], a[152:155], v[64:79]
    ds_read_b128 v[184:187], v10 offset:4096
    v_mfma_f32_32x32x16_bf16 v[48:63], v[188:191], a[12:15], v[48:63]
    v_mul_f32 v251, v230, v115
    v_mul_f32 v252, v230, v116
    v_mul_f32 v253, v230, v117
    v_mul_f32 v254, v230, v118
    v_mul_f32 v255, v230, v119
    v_mfma_f32_32x32x16_bf16 v[64:79], v[188:191], a[156:159], v[64:79]
    ds_read_b128 v[188:191], v11 offset:4096
    buffer_load_dwordx4 v2, s[16:19], s60 offen lds
    v_exp_f32 v248, v248
    v_mfma_f32_16x16x32_bf16 v[240:243], v[232:235], v[176:179], v[240:243]
    v_exp_f32 v249, v249
    v_mfma_f32_32x32x16_bf16 v[48:63], v[176:179], a[16:19], v[48:63]
    s_lshl_b32 s40, s2, 2
    v_exp_f32 v250, v250
    v_exp_f32 v251, v251
    v_exp_f32 v252, v252
    v_exp_f32 v253, v253
    v_mfma_f32_32x32x16_bf16 v[64:79], v[176:179], a[160:163], v[64:79]
    s_waitcnt lgkmcnt(2)
    s_barrier
    ds_read_b128 v[176:179], v8 offset:8192
    v_exp_f32 v254, v254
    s_add_u32 s40, s40, s36
    v_exp_f32 v255, v255
    v_mfma_f32_32x32x16_bf16 v[48:63], v[180:183], a[20:23], v[48:63]
    v_mul_f32 v112, v112, v120
    v_mul_f32 v113, v113, v121
    v_mul_f32 v114, v114, v122
    v_mul_f32 v115, v115, v123
    v_mul_f32 v116, v116, v124
    v_mul_f32 v117, v117, v125
    v_mul_f32 v118, v118, v126
    v_mfma_f32_32x32x16_bf16 v[64:79], v[180:183], a[164:167], v[64:79]
    s_waitcnt lgkmcnt(2)
    ds_read_b128 v[180:183], v9 offset:8192
    v_mul_f32 v119, v119, v127
    v_add_f32 v248, 1.0, v248
    v_add_f32 v249, 1.0, v249
    v_add_f32 v250, 1.0, v250
    v_add_f32 v251, 1.0, v251
    v_add_f32 v252, 1.0, v252
    v_add_f32 v253, 1.0, v253
    v_mfma_f32_32x32x16_bf16 v[48:63], v[184:187], a[24:27], v[48:63]
    v_add_f32 v254, 1.0, v254
    v_add_f32 v255, 1.0, v255
    v_rcp_f32 v248, v248
    v_rcp_f32 v249, v249
    v_rcp_f32 v250, v250
    v_mfma_f32_32x32x16_bf16 v[64:79], v[184:187], a[168:171], v[64:79]
    s_waitcnt lgkmcnt(2)
    ds_read_b128 v[184:187], v10 offset:8192
    v_rcp_f32 v251, v251
    v_rcp_f32 v252, v252
    v_rcp_f32 v253, v253
    v_rcp_f32 v254, v254
    v_mfma_f32_32x32x16_bf16 v[48:63], v[188:191], a[28:31], v[48:63]
    v_rcp_f32 v255, v255
    s_add_u32 s61, s51, 0
    v_mul_f32 v112, v112, v248
    v_mul_f32 v113, v113, v249
    v_mul_f32 v114, v114, v250
    v_mul_f32 v115, v115, v251
    s_cmp_lt_u32 s40, 648
    s_cselect_b32 s4, s76, s70
    s_cselect_b32 s5, s77, s71
    s_cselect_b32 s41, 0, 648
    v_mfma_f32_32x32x16_bf16 v[64:79], v[188:191], a[172:175], v[64:79]
    s_waitcnt lgkmcnt(2)
    ds_read_b128 v[188:191], v11 offset:8192
    v_mul_f32 v116, v116, v252
    v_mul_f32 v117, v117, v253
    v_mul_f32 v118, v118, v254
    v_mul_f32 v119, v119, v255
    v_cvt_pk_bf16_f32 v120, v112, v113
    v_cvt_pk_bf16_f32 v121, v114, v115
    v_cvt_pk_bf16_f32 v122, v116, v117
    v_mfma_f32_16x16x32_bf16 v[240:243], v[232:235], v[176:179], v[240:243]
    v_cvt_pk_bf16_f32 v123, v118, v119
    v_mfma_f32_32x32x16_bf16 v[48:63], v[176:179], a[32:35], v[48:63]
    s_cmp_lt_u32 s40, 648
    s_mov_b32 s42, 663552
    s_cselect_b32 s6, 5308416, s42
    s_sub_u32 s40, s40, s41
    s_lshl_b32 s80, s40, 13
    v_and_b32 v6, 31, v1
    v_lshlrev_b32 v6, 7, v6
    buffer_load_dword v12, v6, s[4:7], s80 offen
    v_mfma_f32_32x32x16_bf16 v[64:79], v[176:179], a[176:179], v[64:79]
    s_waitcnt lgkmcnt(2)
    ds_read_b128 v[176:179], v8 offset:12288
    buffer_store_dwordx4 v[120:123], v3, s[20:23], s61 offen sc1
    v_mul_f32 v248, v231, v128
    v_mul_f32 v249, v231, v129
    v_mul_f32 v250, v231, v130
    v_mfma_f32_32x32x16_bf16 v[48:63], v[180:183], a[36:39], v[48:63]
    v_mul_f32 v251, v231, v131
    v_mul_f32 v252, v231, v132
    v_mul_f32 v253, v231, v133
    v_mul_f32 v254, v231, v134
    v_mul_f32 v255, v231, v135
    v_mfma_f32_32x32x16_bf16 v[64:79], v[180:183], a[180:183], v[64:79]
    s_waitcnt lgkmcnt(2)
    ds_read_b128 v[180:183], v9 offset:12288
    v_exp_f32 v248, v248
    v_exp_f32 v249, v249
    v_mfma_f32_32x32x16_bf16 v[48:63], v[184:187], a[40:43], v[48:63]
    v_exp_f32 v250, v250
    v_exp_f32 v251, v251
    v_exp_f32 v252, v252
    v_mfma_f32_32x32x16_bf16 v[64:79], v[184:187], a[184:187], v[64:79]
    s_waitcnt lgkmcnt(2)
    ds_read_b128 v[184:187], v10 offset:12288
    v_exp_f32 v253, v253
    v_exp_f32 v254, v254
    v_mfma_f32_32x32x16_bf16 v[48:63], v[188:191], a[44:47], v[48:63]
    v_exp_f32 v255, v255
    v_mul_f32 v128, v128, v136
    v_mul_f32 v129, v129, v137
    v_mul_f32 v130, v130, v138
    v_mul_f32 v131, v131, v139
    v_mfma_f32_32x32x16_bf16 v[64:79], v[188:191], a[188:191], v[64:79]
    s_waitcnt lgkmcnt(2)
    ds_read_b128 v[188:191], v11 offset:12288
    v_mul_f32 v132, v132, v140
    v_mul_f32 v133, v133, v141
    v_mul_f32 v134, v134, v142
    v_mul_f32 v135, v135, v143
    v_add_f32 v248, 1.0, v248
    v_mfma_f32_16x16x32_bf16 v[240:243], v[232:235], v[176:179], v[240:243]
    v_add_f32 v249, 1.0, v249
    v_add_f32 v250, 1.0, v250
    v_mfma_f32_32x32x16_bf16 v[48:63], v[176:179], a[48:51], v[48:63]
    v_add_f32 v251, 1.0, v251
    v_add_f32 v252, 1.0, v252
    v_add_f32 v253, 1.0, v253
    v_add_f32 v254, 1.0, v254
    v_add_f32 v255, 1.0, v255
    v_mfma_f32_32x32x16_bf16 v[64:79], v[176:179], a[192:195], v[64:79]
    s_waitcnt lgkmcnt(2)
    ds_read_b128 v[176:179], v8 offset:16384
    v_rcp_f32 v248, v248
    v_rcp_f32 v249, v249
    v_mfma_f32_32x32x16_bf16 v[48:63], v[180:183], a[52:55], v[48:63]
    v_rcp_f32 v250, v250
    v_rcp_f32 v251, v251
    v_rcp_f32 v252, v252
    v_mfma_f32_32x32x16_bf16 v[64:79], v[180:183], a[196:199], v[64:79]
    s_waitcnt lgkmcnt(2)
    ds_read_b128 v[180:183], v9 offset:16384
    v_rcp_f32 v253, v253
    v_rcp_f32 v254, v254
    v_mfma_f32_32x32x16_bf16 v[48:63], v[184:187], a[56:59], v[48:63]
    v_rcp_f32 v255, v255
    s_add_u32 s61, s51, 294912
    v_mul_f32 v128, v128, v248
    v_mul_f32 v129, v129, v249
    v_mul_f32 v130, v130, v250
    v_mfma_f32_32x32x16_bf16 v[64:79], v[184:187], a[200:203], v[64:79]
    s_waitcnt lgkmcnt(2)
    ds_read_b128 v[184:187], v10 offset:16384
    v_mul_f32 v131, v131, v251
    v_mul_f32 v132, v132, v252
    v_mul_f32 v133, v133, v253
    v_mul_f32 v134, v134, v254
    v_mul_f32 v135, v135, v255
    v_mfma_f32_32x32x16_bf16 v[48:63], v[188:191], a[60:63], v[48:63]
    v_cvt_pk_bf16_f32 v136, v128, v129
    v_cvt_pk_bf16_f32 v137, v130, v131
    v_cvt_pk_bf16_f32 v138, v132, v133
    v_cvt_pk_bf16_f32 v139, v134, v135
    buffer_store_dwordx4 v[136:139], v3, s[20:23], s61 offen sc1
    v_mfma_f32_32x32x16_bf16 v[64:79], v[188:191], a[204:207], v[64:79]
    s_waitcnt lgkmcnt(2)
    ds_read_b128 v[188:191], v11 offset:16384
    ds_read_b32 v248, v245 offset:2048
    ds_read_b32 v249, v245 offset:2176
    ds_read_b32 v250, v245 offset:2304
    ds_read_b32 v251, v245 offset:2432
    v_mfma_f32_16x16x32_bf16 v[240:243], v[232:235], v[176:179], v[240:243]
    v_mfma_f32_32x32x16_bf16 v[48:63], v[176:179], a[64:67], v[48:63]
    v_mfma_f32_32x32x16_bf16 v[64:79], v[176:179], a[208:211], v[64:79]
    s_waitcnt lgkmcnt(6)
    ds_read_b128 v[176:179], v8 offset:20480
    v_mfma_f32_32x32x16_bf16 v[48:63], v[180:183], a[68:71], v[48:63]
    s_waitcnt lgkmcnt(3)
    v_add_f32 v248, v248, v249
    s_waitcnt lgkmcnt(1)
    v_add_f32 v250, v250, v251
    v_add_f32 v248, v248, v250
    v_cvt_pk_bf16_f32 v249, v248, v248
    v_lshlrev_b32 v249, 16, v249
    v_sub_f32 v249, v248, v249
    v_mfma_f32_32x32x16_bf16 v[64:79], v[180:183], a[212:215], v[64:79]
    ds_read_b128 v[180:183], v9 offset:20480
    v_cvt_pk_bf16_f32 v224, v248, v249
    v_mfma_f32_32x32x16_bf16 v[48:63], v[184:187], a[72:75], v[48:63]
    v_mfma_f32_32x32x16_bf16 v[64:79], v[184:187], a[216:219], v[64:79]
    ds_read_b128 v[184:187], v10 offset:20480
    v_mfma_f32_32x32x8_bf16 v[192:207], v[224:225], v[226:227], v[192:207]
    v_mfma_f32_32x32x8_bf16 v[208:223], v[224:225], v[228:229], v[208:223]
    v_mul_f32 v248, v230, v144
    v_mfma_f32_32x32x16_bf16 v[48:63], v[188:191], a[76:79], v[48:63]
    v_mul_f32 v249, v230, v145
    v_mul_f32 v250, v230, v146
    v_mul_f32 v251, v230, v147
    v_mul_f32 v252, v230, v148
    v_mul_f32 v253, v230, v149
    v_mul_f32 v254, v230, v150
    v_mfma_f32_32x32x16_bf16 v[64:79], v[188:191], a[220:223], v[64:79]
    s_waitcnt lgkmcnt(2)
    ds_read_b128 v[188:191], v11 offset:20480
    v_mul_f32 v255, v230, v151
    v_exp_f32 v248, v248
    v_exp_f32 v249, v249
    v_mfma_f32_16x16x32_bf16 v[240:243], v[232:235], v[176:179], v[240:243]
    v_exp_f32 v250, v250
    v_mfma_f32_32x32x16_bf16 v[48:63], v[176:179], a[80:83], v[48:63]
    v_exp_f32 v251, v251
    v_exp_f32 v252, v252
    v_exp_f32 v253, v253
    v_mfma_f32_32x32x16_bf16 v[64:79], v[176:179], a[224:227], v[64:79]
    s_waitcnt lgkmcnt(2)
    ds_read_b128 v[176:179], v8 offset:24576
    v_exp_f32 v254, v254
    v_exp_f32 v255, v255
    v_mul_f32 v144, v144, v152
    v_mfma_f32_32x32x16_bf16 v[48:63], v[180:183], a[84:87], v[48:63]
    v_mul_f32 v145, v145, v153
    v_mul_f32 v146, v146, v154
    v_mul_f32 v147, v147, v155
    v_mul_f32 v148, v148, v156
    v_mul_f32 v149, v149, v157
    v_mul_f32 v150, v150, v158
    v_mfma_f32_32x32x16_bf16 v[64:79], v[180:183], a[228:231], v[64:79]
    s_waitcnt lgkmcnt(2)
    ds_read_b128 v[180:183], v9 offset:24576
    v_mul_f32 v151, v151, v159
    v_add_f32 v248, 1.0, v248
    v_add_f32 v249, 1.0, v249
    v_add_f32 v250, 1.0, v250
    v_add_f32 v251, 1.0, v251
    v_mfma_f32_32x32x16_bf16 v[48:63], v[184:187], a[88:91], v[48:63]
    v_add_f32 v252, 1.0, v252
    v_add_f32 v253, 1.0, v253
    v_add_f32 v254, 1.0, v254
    v_add_f32 v255, 1.0, v255
    v_rcp_f32 v248, v248
    v_mfma_f32_32x32x16_bf16 v[64:79], v[184:187], a[232:235], v[64:79]
    s_waitcnt lgkmcnt(2)
    ds_read_b128 v[184:187], v10 offset:24576
    v_rcp_f32 v249, v249
    v_rcp_f32 v250, v250
    v_mfma_f32_32x32x16_bf16 v[48:63], v[188:191], a[92:95], v[48:63]
    v_rcp_f32 v251, v251
    v_rcp_f32 v252, v252
    v_rcp_f32 v253, v253
    v_mfma_f32_32x32x16_bf16 v[64:79], v[188:191], a[236:239], v[64:79]
    s_waitcnt lgkmcnt(2)
    ds_read_b128 v[188:191], v11 offset:24576
    v_rcp_f32 v254, v254
    v_rcp_f32 v255, v255
    s_add_u32 s61, s51, 512
    v_mfma_f32_16x16x32_bf16 v[240:243], v[232:235], v[176:179], v[240:243]
    v_mul_f32 v144, v144, v248
    v_mul_f32 v145, v145, v249
    v_mfma_f32_32x32x16_bf16 v[48:63], v[176:179], a[96:99], v[48:63]
    v_mul_f32 v146, v146, v250
    v_mul_f32 v147, v147, v251
    v_mul_f32 v148, v148, v252
    v_mul_f32 v149, v149, v253
    v_mul_f32 v150, v150, v254
    v_mul_f32 v151, v151, v255
    v_mfma_f32_32x32x16_bf16 v[64:79], v[176:179], a[240:243], v[64:79]
    s_waitcnt lgkmcnt(2)
    ds_read_b128 v[176:179], v8 offset:28672
    v_cvt_pk_bf16_f32 v152, v144, v145
    v_cvt_pk_bf16_f32 v153, v146, v147
    v_cvt_pk_bf16_f32 v154, v148, v149
    v_cvt_pk_bf16_f32 v155, v150, v151
    v_mfma_f32_32x32x16_bf16 v[48:63], v[180:183], a[100:103], v[48:63]
    buffer_store_dwordx4 v[152:155], v3, s[20:23], s61 offen sc1
    v_mul_f32 v248, v231, v160
    v_mul_f32 v249, v231, v161
    v_mul_f32 v250, v231, v162
    v_mul_f32 v251, v231, v163
    v_mfma_f32_32x32x16_bf16 v[64:79], v[180:183], a[244:247], v[64:79]
    s_waitcnt lgkmcnt(2)
    ds_read_b128 v[180:183], v9 offset:28672
    v_mul_f32 v252, v231, v164
    v_mul_f32 v253, v231, v165
    v_mul_f32 v254, v231, v166
    v_mul_f32 v255, v231, v167
    v_mfma_f32_32x32x16_bf16 v[48:63], v[184:187], a[104:107], v[48:63]
    v_exp_f32 v248, v248
    v_exp_f32 v249, v249
    v_exp_f32 v250, v250
    v_mfma_f32_32x32x16_bf16 v[64:79], v[184:187], a[248:251], v[64:79]
    s_waitcnt lgkmcnt(2)
    ds_read_b128 v[184:187], v10 offset:28672
    v_exp_f32 v251, v251
    v_exp_f32 v252, v252
    v_mfma_f32_32x32x16_bf16 v[48:63], v[188:191], a[108:111], v[48:63]
    v_exp_f32 v253, v253
    v_exp_f32 v254, v254
    v_exp_f32 v255, v255
    v_mfma_f32_32x32x16_bf16 v[64:79], v[188:191], a[252:255], v[64:79]
    s_waitcnt lgkmcnt(2)
    ds_read_b128 v[188:191], v11 offset:28672
    v_mul_f32 v160, v160, v168
    v_mul_f32 v161, v161, v169
    v_mul_f32 v162, v162, v170
    v_mul_f32 v163, v163, v171
    v_mul_f32 v164, v164, v172
    v_mfma_f32_16x16x32_bf16 v[240:243], v[232:235], v[176:179], v[240:243]
    v_mul_f32 v165, v165, v173
    v_mul_f32 v166, v166, v174
    v_mfma_f32_32x32x16_bf16 v[48:63], v[176:179], a[112:115], v[48:63]
    v_mul_f32 v167, v167, v175
    v_add_f32 v248, 1.0, v248
    v_add_f32 v249, 1.0, v249
    v_add_f32 v250, 1.0, v250
    v_add_f32 v251, 1.0, v251
    v_add_f32 v252, 1.0, v252
    v_mfma_f32_32x32x16_bf16 v[64:79], v[176:179], v[16:19], v[64:79]
    s_waitcnt lgkmcnt(2)
    ds_read_b128 v[176:179], v8 offset:32768
    v_add_f32 v253, 1.0, v253
    v_add_f32 v254, 1.0, v254
    v_add_f32 v255, 1.0, v255
    v_rcp_f32 v248, v248
    v_mfma_f32_32x32x16_bf16 v[48:63], v[180:183], a[116:119], v[48:63]
    v_rcp_f32 v249, v249
    v_rcp_f32 v250, v250
    v_rcp_f32 v251, v251
    v_mfma_f32_32x32x16_bf16 v[64:79], v[180:183], v[20:23], v[64:79]
    s_waitcnt lgkmcnt(2)
    ds_read_b128 v[180:183], v9 offset:32768
    v_rcp_f32 v252, v252
    v_rcp_f32 v253, v253
    v_mfma_f32_32x32x16_bf16 v[48:63], v[184:187], a[120:123], v[48:63]
    v_rcp_f32 v254, v254
    v_rcp_f32 v255, v255
    s_add_u32 s61, s51, 295424
    v_mul_f32 v160, v160, v248
    v_mfma_f32_32x32x16_bf16 v[64:79], v[184:187], v[24:27], v[64:79]
    s_waitcnt lgkmcnt(2)
    ds_read_b128 v[184:187], v10 offset:32768
    v_mul_f32 v161, v161, v249
    v_mul_f32 v162, v162, v250
    v_mul_f32 v163, v163, v251
    v_mul_f32 v164, v164, v252
    v_mul_f32 v165, v165, v253
    v_mfma_f32_32x32x16_bf16 v[48:63], v[188:191], a[124:127], v[48:63]
    v_mul_f32 v166, v166, v254
    v_mul_f32 v167, v167, v255
    v_cvt_pk_bf16_f32 v168, v160, v161
    v_cvt_pk_bf16_f32 v169, v162, v163
    v_cvt_pk_bf16_f32 v170, v164, v165
    v_cvt_pk_bf16_f32 v171, v166, v167
    v_mfma_f32_32x32x16_bf16 v[64:79], v[188:191], v[28:31], v[64:79]
    s_waitcnt lgkmcnt(2)
    ds_read_b128 v[188:191], v11 offset:32768
    buffer_store_dwordx4 v[168:171], v3, s[20:23], s61 offen sc1
    v_mfma_f32_16x16x32_bf16 v[240:243], v[232:235], v[176:179], v[240:243]
    v_mfma_f32_32x32x16_bf16 v[48:63], v[176:179], a[128:131], v[48:63]
    v_mfma_f32_32x32x16_bf16 v[64:79], v[176:179], v[32:35], v[64:79]
    s_waitcnt lgkmcnt(2)
    v_mfma_f32_32x32x16_bf16 v[48:63], v[180:183], a[132:135], v[48:63]
    s_waitcnt vmcnt(5)
    s_waitcnt lgkmcnt(0)
    s_barrier
    s_add_u32 s57, s66, 73760
    v_add_u32 v8, s57, v7
    ds_read_b64_tr_b16 v[176:177], v8 offset:0
    ds_read_b64_tr_b16 v[178:179], v8 offset:256
    v_mfma_f32_32x32x16_bf16 v[64:79], v[180:183], v[36:39], v[64:79]
    s_add_u32 s57, s67, 73760
    v_add_u32 v9, s57, v7
    ds_read_b64_tr_b16 v[180:181], v9 offset:0
    ds_read_b64_tr_b16 v[182:183], v9 offset:256
    v_mfma_f32_32x32x16_bf16 v[48:63], v[184:187], a[136:139], v[48:63]
    s_mul_i32 s60, s100, 589824
    v_mfma_f32_32x32x16_bf16 v[64:79], v[184:187], v[40:43], v[64:79]
    s_add_u32 s57, s68, 73760
    v_add_u32 v10, s57, v7
    ds_read_b64_tr_b16 v[184:185], v10 offset:0
    ds_read_b64_tr_b16 v[186:187], v10 offset:256
    s_add_u32 m0, s44, 0
    v_mfma_f32_32x32x16_bf16 v[48:63], v[188:191], a[140:143], v[48:63]
    s_add_u32 s60, s60, s48
    s_mov_b64 exec, 0xffff
    ds_write_b64 v244, v[240:241] offset:14400
    s_mov_b64 exec, -1
    v_mfma_f32_32x32x16_bf16 v[64:79], v[188:191], v[44:47], v[64:79]
    s_waitcnt lgkmcnt(5)
    s_add_u32 s57, s69, 73760
    v_add_u32 v11, s57, v7
    ds_read_b64_tr_b16 v[188:189], v11 offset:0
    ds_read_b64_tr_b16 v[190:191], v11 offset:256
    buffer_load_dwordx4 v2, s[12:15], s60 offen lds
    v_mfma_f32_16x16x32_bf16 v[236:239], v[232:235], v[176:179], 0
    v_mfma_f32_32x32x16_bf16 v[112:127], v[176:179], a[0:3], 0
    s_add_u32 m0, s44, 36896
    v_mfma_f32_32x32x16_bf16 v[128:143], v[176:179], a[144:147], 0
    s_waitcnt lgkmcnt(5)
    ds_read_b64_tr_b16 v[176:177], v8 offset:4096
    ds_read_b64_tr_b16 v[178:179], v8 offset:4352
    s_add_u32 s100, s100, 1
    s_cmp_eq_u32 s100, 9
    s_cselect_b32 s100, 0, s100
    v_mfma_f32_32x32x16_bf16 v[112:127], v[180:183], a[4:7], v[112:127]
    v_mfma_f32_32x32x16_bf16 v[128:143], v[180:183], a[148:151], v[128:143]
    s_waitcnt lgkmcnt(5)
    ds_read_b64_tr_b16 v[180:181], v9 offset:4096
    ds_read_b64_tr_b16 v[182:183], v9 offset:4352
    v_mfma_f32_32x32x16_bf16 v[112:127], v[184:187], a[8:11], v[112:127]
    buffer_load_dwordx4 v2, s[16:19], s60 offen lds
    v_mfma_f32_32x32x16_bf16 v[128:143], v[184:187], a[152:155], v[128:143]
    s_waitcnt lgkmcnt(4)
    ds_read_b64_tr_b16 v[184:185], v10 offset:4096
    ds_read_b64_tr_b16 v[186:187], v10 offset:4352
    v_mfma_f32_32x32x16_bf16 v[112:127], v[188:191], a[12:15], v[112:127]
    s_mul_i32 s60, s100, 589824
    v_mfma_f32_32x32x16_bf16 v[128:143], v[188:191], a[156:159], v[128:143]
    s_waitcnt lgkmcnt(4)
    ds_read_b64_tr_b16 v[188:189], v11 offset:4096
    ds_read_b64_tr_b16 v[190:191], v11 offset:4352
    s_add_u32 m0, s44, 4096
    s_add_u32 s60, s60, s48
    v_mfma_f32_16x16x32_bf16 v[236:239], v[232:235], v[176:179], v[236:239]
    buffer_load_dwordx4 v2, s[12:15], s60 offen lds
    v_mfma_f32_32x32x16_bf16 v[112:127], v[176:179], a[16:19], v[112:127]
    v_mfma_f32_32x32x16_bf16 v[128:143], v[176:179], a[160:163], v[128:143]
    s_barrier
    s_waitcnt lgkmcnt(4)
    ds_read_b64_tr_b16 v[176:177], v8 offset:8192
    ds_read_b64_tr_b16 v[178:179], v8 offset:8448
    s_add_u32 m0, s44, 40992
    v_mfma_f32_32x32x16_bf16 v[112:127], v[180:183], a[20:23], v[112:127]
    s_add_u32 s100, s100, 1
    s_cmp_eq_u32 s100, 9
    s_cselect_b32 s100, 0, s100
    ds_read_b32 v248, v245 offset:14400
    ds_read_b32 v249, v245 offset:14528
    ds_read_b32 v250, v245 offset:14656
    v_mfma_f32_32x32x16_bf16 v[128:143], v[180:183], a[164:167], v[128:143]
    s_waitcnt lgkmcnt(7)
    ds_read_b64_tr_b16 v[180:181], v9 offset:8192
    ds_read_b64_tr_b16 v[182:183], v9 offset:8448
    ds_read_b32 v251, v245 offset:14784
    v_mfma_f32_32x32x16_bf16 v[112:127], v[184:187], a[24:27], v[112:127]
    v_mfma_f32_32x32x16_bf16 v[128:143], v[184:187], a[168:171], v[128:143]
    s_waitcnt lgkmcnt(8)
    ds_read_b64_tr_b16 v[184:185], v10 offset:8192
    ds_read_b64_tr_b16 v[186:187], v10 offset:8448
    buffer_load_dwordx4 v2, s[16:19], s60 offen lds
    v_mfma_f32_32x32x16_bf16 v[112:127], v[188:191], a[28:31], v[112:127]
    s_waitcnt lgkmcnt(6)
    v_add_f32 v248, v248, v249
    v_mfma_f32_32x32x16_bf16 v[128:143], v[188:191], a[172:175], v[128:143]
    ds_read_b64_tr_b16 v[188:189], v11 offset:8192
    ds_read_b64_tr_b16 v[190:191], v11 offset:8448
    s_mul_i32 s60, s100, 589824
    s_waitcnt lgkmcnt(4)
    v_add_f32 v250, v250, v251
    v_add_f32 v248, v248, v250
    v_cvt_pk_bf16_f32 v249, v248, v248
    v_mfma_f32_16x16x32_bf16 v[236:239], v[232:235], v[176:179], v[236:239]
    s_add_u32 m0, s44, 8192
    v_lshlrev_b32 v249, 16, v249
    v_sub_f32 v249, v248, v249
    v_mfma_f32_32x32x16_bf16 v[112:127], v[176:179], a[32:35], v[112:127]
    s_add_u32 s60, s60, s48
    v_cvt_pk_bf16_f32 v224, v248, v249
    v_mfma_f32_32x32x16_bf16 v[128:143], v[176:179], a[176:179], v[128:143]
    ds_read_b64_tr_b16 v[176:177], v8 offset:12288
    ds_read_b64_tr_b16 v[178:179], v8 offset:12544
    buffer_load_dwordx4 v2, s[12:15], s60 offen lds
    v_mfma_f32_32x32x8_bf16 v[48:63], v[224:225], v[226:227], v[48:63]
    v_mfma_f32_32x32x16_bf16 v[112:127], v[180:183], a[36:39], v[112:127]
    v_mfma_f32_32x32x8_bf16 v[64:79], v[224:225], v[228:229], v[64:79]
    v_mul_f32 v106, 0xbf317218, v230
    v_mul_f32 v107, 0xbf317218, v231
    v_lshrrev_b32 v108, 5, v1
    v_cvt_f32_u32 v108, v108
    v_mfma_f32_32x32x16_bf16 v[128:143], v[180:183], a[180:183], v[128:143]
    s_waitcnt lgkmcnt(4)
    ds_read_b64_tr_b16 v[180:181], v9 offset:12288
    ds_read_b64_tr_b16 v[182:183], v9 offset:12544
    s_add_u32 m0, s44, 45088
    v_mfma_f32_32x32x16_bf16 v[112:127], v[184:187], a[40:43], v[112:127]
    s_add_u32 s100, s100, 1
    s_cmp_eq_u32 s100, 9
    s_cselect_b32 s100, 0, s100
    v_mov_b32 v86, v48
    v_mov_b32 v87, v49
    v_mul_f32 v50, v50, v106
    v_mfma_f32_32x32x16_bf16 v[128:143], v[184:187], a[184:187], v[128:143]
    s_waitcnt lgkmcnt(4)
    ds_read_b64_tr_b16 v[184:185], v10 offset:12288
    ds_read_b64_tr_b16 v[186:187], v10 offset:12544
    v_mul_f32 v51, v51, v106
    v_mul_f32 v52, v52, v106
    v_mul_f32 v53, v53, v106
    v_mul_f32 v54, v54, v106
    v_mfma_f32_32x32x16_bf16 v[112:127], v[188:191], a[44:47], v[112:127]
    v_mul_f32 v55, v55, v106
    v_mul_f32 v56, v56, v106
    v_mul_f32 v57, v57, v106
    v_fma_f32 v58, v58, v106, v108
    v_mul_f32 v59, v59, v106
    v_cvt_pk_bf16_f32 v80, v50, v51
    v_mfma_f32_32x32x16_bf16 v[128:143], v[188:191], a[188:191], v[128:143]
    s_waitcnt lgkmcnt(4)
    ds_read_b64_tr_b16 v[188:189], v11 offset:12288
    ds_read_b64_tr_b16 v[190:191], v11 offset:12544
    buffer_load_dwordx4 v2, s[16:19], s60 offen lds
    v_cvt_pk_bf16_f32 v81, v52, v53
    v_cvt_pk_bf16_f32 v82, v54, v55
    v_mfma_f32_16x16x32_bf16 v[236:239], v[232:235], v[176:179], v[236:239]
    v_cvt_pk_bf16_f32 v83, v56, v57
    v_cvt_pk_bf16_f32 v84, v58, v59
    v_mfma_f32_32x32x16_bf16 v[112:127], v[176:179], a[48:51], v[112:127]
    s_mul_i32 s60, s100, 589824
    v_mov_b32 v94, v64
    v_mov_b32 v95, v65
    v_mul_f32 v66, v66, v107
    v_mul_f32 v67, v67, v107
    v_mul_f32 v68, v68, v107
    v_mul_f32 v69, v69, v107
    v_mfma_f32_32x32x16_bf16 v[128:143], v[176:179], a[192:195], v[128:143]
    s_waitcnt lgkmcnt(4)
    ds_read_b64_tr_b16 v[176:177], v8 offset:16384
    ds_read_b64_tr_b16 v[178:179], v8 offset:16640
    s_add_u32 m0, s44, 12288
    v_mul_f32 v70, v70, v107
    v_mul_f32 v71, v71, v107
    v_mul_f32 v72, v72, v107
    v_mfma_f32_32x32x16_bf16 v[112:127], v[180:183], a[52:55], v[112:127]
    s_add_u32 s60, s60, s48
    v_mul_f32 v73, v73, v107
    v_fma_f32 v74, v74, v107, v108
    v_mul_f32 v75, v75, v107
    v_cvt_pk_bf16_f32 v88, v66, v67
    v_cvt_pk_bf16_f32 v89, v68, v69
    v_cvt_pk_bf16_f32 v90, v70, v71
    v_mfma_f32_32x32x16_bf16 v[128:143], v[180:183], a[196:199], v[128:143]
    s_waitcnt lgkmcnt(4)
    ds_read_b64_tr_b16 v[180:181], v9 offset:16384
    ds_read_b64_tr_b16 v[182:183], v9 offset:16640
    buffer_load_dwordx4 v2, s[12:15], s60 offen lds
    v_cvt_pk_bf16_f32 v91, v72, v73
    v_cvt_pk_bf16_f32 v92, v74, v75
    v_mfma_f32_32x32x16_bf16 v[112:127], v[184:187], a[56:59], v[112:127]
    s_add_u32 m0, s44, 49184
    v_max3_f32 v106, v201, v202, v203
    v_max3_f32 v107, -v201, -v202, -v203
    v_max3_f32 v109, v204, v205, v206
    v_max3_f32 v110, -v204, -v205, -v206
    v_mfma_f32_32x32x16_bf16 v[128:143], v[184:187], a[200:203], v[128:143]
    s_waitcnt lgkmcnt(4)
    ds_read_b64_tr_b16 v[184:185], v10 offset:16384
    ds_read_b64_tr_b16 v[186:187], v10 offset:16640
    s_add_u32 s100, s100, 1
    s_cmp_eq_u32 s100, 9
    s_cselect_b32 s100, 0, s100
    v_max3_f32 v108, v207, v86, v87
    v_mfma_f32_32x32x16_bf16 v[112:127], v[188:191], a[60:63], v[112:127]
    v_max3_f32 v111, -v207, -v86, -v87
    v_max3_f32 v106, v106, v109, v108
    v_max3_f32 v107, v107, v110, v111
    v_mfma_f32_32x32x16_bf16 v[128:143], v[188:191], a[204:207], v[128:143]
    s_waitcnt lgkmcnt(4)
    ds_read_b64_tr_b16 v[188:189], v11 offset:16384
    ds_read_b64_tr_b16 v[190:191], v11 offset:16640
    v_permlane32_swap_b32 v106, v107
    v_max_f32 v106, v106, v107
    v_mul_f32 v106, v230, v106
    v_mfma_f32_16x16x32_bf16 v[236:239], v[232:235], v[176:179], v[236:239]
    buffer_load_dwordx4 v2, s[16:19], s60 offen lds
    v_mfma_f32_32x32x16_bf16 v[112:127], v[176:179], a[64:67], v[112:127]
    v_mov_b32 v107, v106
    v_mfma_f32_32x32x16_bf16 v[128:143], v[176:179], a[208:211], v[128:143]
    s_waitcnt lgkmcnt(4)
    ds_read_b64_tr_b16 v[176:177], v8 offset:20480
    ds_read_b64_tr_b16 v[178:179], v8 offset:20736
    s_mul_i32 s60, s100, 589824
    v_permlane32_swap_b32 v106, v107
    v_fma_f32 v96, v201, v230, v107
    v_mfma_f32_32x32x16_bf16 v[112:127], v[180:183], a[68:71], v[112:127]
    s_add_u32 m0, s44, 16384
    v_fma_f32 v97, v202, v230, v107
    v_fma_f32 v98, v203, v230, v107
    v_fma_f32 v99, v204, v230, v107
    v_fma_f32 v100, v205, v230, v107
    v_fma_f32 v101, v206, v230, v107
    v_mfma_f32_32x32x16_bf16 v[128:143], v[180:183], a[212:215], v[128:143]
    s_waitcnt lgkmcnt(4)
    ds_read_b64_tr_b16 v[180:181], v9 offset:20480
    ds_read_b64_tr_b16 v[182:183], v9 offset:20736
    s_add_u32 s60, s60, s48
    v_fma_f32 v102, v207, v230, v107
    v_fma_f32 v103, v86, v230, v107
    v_mfma_f32_32x32x16_bf16 v[112:127], v[184:187], a[72:75], v[112:127]
    buffer_load_dwordx4 v2, s[12:15], s60 offen lds
    v_fma_f32 v104, v87, v230, v107
    v_fma_f32 v201, -v201, v230, v106
    v_fma_f32 v202, -v202, v230, v106
    v_fma_f32 v203, -v203, v230, v106
    v_mfma_f32_32x32x16_bf16 v[128:143], v[184:187], a[216:219], v[128:143]
    s_waitcnt lgkmcnt(4)
    ds_read_b64_tr_b16 v[184:185], v10 offset:20480
    ds_read_b64_tr_b16 v[186:187], v10 offset:20736
    v_fma_f32 v204, -v204, v230, v106
    v_fma_f32 v205, -v205, v230, v106
    v_mfma_f32_32x32x16_bf16 v[112:127], v[188:191], a[76:79], v[112:127]
    s_add_u32 m0, s44, 53280
    v_fma_f32 v206, -v206, v230, v106
    v_fma_f32 v207, -v207, v230, v106
    v_fma_f32 v86, -v86, v230, v106
    v_fma_f32 v87, -v87, v230, v106
    v_exp_f32 v96, v96
    v_mfma_f32_32x32x16_bf16 v[128:143], v[188:191], a[220:223], v[128:143]
    s_waitcnt lgkmcnt(4)
    ds_read_b64_tr_b16 v[188:189], v11 offset:20480
    ds_read_b64_tr_b16 v[190:191], v11 offset:20736
    s_add_u32 s100, s100, 1
    s_cmp_eq_u32 s100, 9
    s_cselect_b32 s100, 0, s100
    v_mfma_f32_16x16x32_bf16 v[236:239], v[232:235], v[176:179], v[236:239]
    v_exp_f32 v97, v97
    v_mfma_f32_32x32x16_bf16 v[112:127], v[176:179], a[80:83], v[112:127]
    v_exp_f32 v98, v98
    v_exp_f32 v99, v99
    v_exp_f32 v100, v100
    v_mfma_f32_32x32x16_bf16 v[128:143], v[176:179], a[224:227], v[128:143]
    s_waitcnt lgkmcnt(4)
    ds_read_b64_tr_b16 v[176:177], v8 offset:24576
    ds_read_b64_tr_b16 v[178:179], v8 offset:24832
    buffer_load_dwordx4 v2, s[16:19], s60 offen lds
    v_exp_f32 v101, v101
    v_mfma_f32_32x32x16_bf16 v[112:127], v[180:183], a[84:87], v[112:127]
    v_exp_f32 v102, v102
    v_exp_f32 v103, v103
    v_exp_f32 v104, v104
    v_mfma_f32_32x32x16_bf16 v[128:143], v[180:183], a[228:231], v[128:143]
    s_waitcnt lgkmcnt(4)
    ds_read_b64_tr_b16 v[180:181], v9 offset:24576
    ds_read_b64_tr_b16 v[182:183], v9 offset:24832
    s_mul_i32 s60, s100, 589824
    v_exp_f32 v201, v201
    v_mfma_f32_32x32x16_bf16 v[112:127], v[184:187], a[88:91], v[112:127]
    s_add_u32 m0, s44, 20480
    v_exp_f32 v202, v202
    v_exp_f32 v203, v203
    v_exp_f32 v204, v204
    v_mfma_f32_32x32x16_bf16 v[128:143], v[184:187], a[232:235], v[128:143]
    s_waitcnt lgkmcnt(4)
    ds_read_b64_tr_b16 v[184:185], v10 offset:24576
    ds_read_b64_tr_b16 v[186:187], v10 offset:24832
    s_add_u32 s60, s60, s48
    v_exp_f32 v205, v205
    v_mfma_f32_32x32x16_bf16 v[112:127], v[188:191], a[92:95], v[112:127]
    buffer_load_dwordx4 v2, s[12:15], s60 offen lds
    v_exp_f32 v206, v206
    v_exp_f32 v207, v207
    v_mfma_f32_32x32x16_bf16 v[128:143], v[188:191], a[236:239], v[128:143]
    s_waitcnt lgkmcnt(4)
    ds_read_b64_tr_b16 v[188:189], v11 offset:24576
    ds_read_b64_tr_b16 v[190:191], v11 offset:24832
    v_exp_f32 v86, v86
    v_exp_f32 v87, v87
    v_mfma_f32_16x16x32_bf16 v[236:239], v[232:235], v[176:179], v[236:239]
    s_add_u32 m0, s44, 57376
    v_add_f32 v107, v96, v97
    v_add_f32 v110, v98, v99
    v_mfma_f32_32x32x16_bf16 v[112:127], v[176:179], a[96:99], v[112:127]
    s_add_u32 s100, s100, 1
    s_cmp_eq_u32 s100, 9
    s_cselect_b32 s100, 0, s100
    v_add_f32 v106, v201, v202
    v_add_f32 v109, v203, v204
    v_add_f32 v107, v107, v100
    v_mfma_f32_32x32x16_bf16 v[128:143], v[176:179], a[240:243], v[128:143]
    s_waitcnt lgkmcnt(4)
    ds_read_b64_tr_b16 v[176:177], v8 offset:28672
    ds_read_b64_tr_b16 v[178:179], v8 offset:28928
    v_add_f32 v110, v110, v101
    v_add_f32 v106, v106, v205
    v_add_f32 v109, v109, v206
    v_add_f32 v107, v107, v102
    v_mfma_f32_32x32x16_bf16 v[112:127], v[180:183], a[100:103], v[112:127]
    buffer_load_dwordx4 v2, s[16:19], s60 offen lds
    v_add_f32 v110, v110, v103
    v_add_f32 v106, v106, v207
    v_add_f32 v109, v109, v86
    v_add_f32 v107, v107, v104
    v_mfma_f32_32x32x16_bf16 v[128:143], v[180:183], a[244:247], v[128:143]
    s_waitcnt lgkmcnt(4)
    ds_read_b64_tr_b16 v[180:181], v9 offset:28672
    ds_read_b64_tr_b16 v[182:183], v9 offset:28928
    v_add_f32 v106, v106, v87
    v_add_f32 v107, v107, v110
    v_add_f32 v106, v106, v109
    v_mfma_f32_32x32x16_bf16 v[112:127], v[184:187], a[104:107], v[112:127]
    s_mul_i32 s60, s100, 589824
    v_permlane32_swap_b32 v106, v107
    v_add_f32 v106, v106, v107
    v_rcp_f32 v106, v106
    v_mfma_f32_32x32x16_bf16 v[128:143], v[184:187], a[248:251], v[128:143]
    s_waitcnt lgkmcnt(4)
    ds_read_b64_tr_b16 v[184:185], v10 offset:28672
    ds_read_b64_tr_b16 v[186:187], v10 offset:28928
    s_add_u32 m0, s44, 24576
    v_mov_b32 v107, v106
    v_mfma_f32_32x32x16_bf16 v[112:127], v[188:191], a[108:111], v[112:127]
    s_add_u32 s60, s60, s48
    v_permlane32_swap_b32 v106, v107
    v_mul_f32 v201, v201, v106
    v_mul_f32 v202, v202, v106
    v_mul_f32 v203, v203, v106
    v_mul_f32 v204, v204, v106
    v_mfma_f32_32x32x16_bf16 v[128:143], v[188:191], a[252:255], v[128:143]
    s_waitcnt lgkmcnt(4)
    ds_read_b64_tr_b16 v[188:189], v11 offset:28672
    ds_read_b64_tr_b16 v[190:191], v11 offset:28928
    buffer_load_dwordx4 v2, s[12:15], s60 offen lds
    v_mul_f32 v205, v205, v106
    v_mul_f32 v206, v206, v106
    v_mfma_f32_16x16x32_bf16 v[236:239], v[232:235], v[176:179], v[236:239]
    v_mul_f32 v207, v207, v106
    v_mul_f32 v86, v86, v106
    v_mfma_f32_32x32x16_bf16 v[112:127], v[176:179], a[112:115], v[112:127]
    s_add_u32 m0, s44, 61472
    v_mul_f32 v87, v87, v106
    v_mul_f32 v96, v96, v107
    v_mul_f32 v97, v97, v107
    v_mul_f32 v98, v98, v107
    v_mul_f32 v99, v99, v107
    v_mul_f32 v100, v100, v107
    v_mfma_f32_32x32x16_bf16 v[128:143], v[176:179], v[16:19], v[128:143]
    s_waitcnt lgkmcnt(4)
    ds_read_b64_tr_b16 v[176:177], v8 offset:32768
    ds_read_b64_tr_b16 v[178:179], v8 offset:33024
    s_add_u32 s100, s100, 1
    s_cmp_eq_u32 s100, 9
    s_cselect_b32 s100, 0, s100
    v_mul_f32 v101, v101, v107
    v_mfma_f32_32x32x16_bf16 v[112:127], v[180:183], a[116:119], v[112:127]
    v_mul_f32 v102, v102, v107
    v_mul_f32 v103, v103, v107
    v_mul_f32 v104, v104, v107
    v_cvt_pk_bf16_f32 v202, v201, v202
    v_cvt_pk_bf16_f32 v203, v203, v204
    v_cvt_pk_bf16_f32 v204, v205, v206
    v_mfma_f32_32x32x16_bf16 v[128:143], v[180:183], v[20:23], v[128:143]
    s_waitcnt lgkmcnt(4)
    ds_read_b64_tr_b16 v[180:181], v9 offset:32768
    ds_read_b64_tr_b16 v[182:183], v9 offset:33024
    v_cvt_pk_bf16_f32 v205, v207, v86
    v_cvt_pk_bf16_f32 v206, v87, v96
    v_cvt_pk_bf16_f32 v207, v97, v98
    v_mfma_f32_32x32x16_bf16 v[112:127], v[184:187], a[120:123], v[112:127]
    buffer_load_dwordx4 v2, s[16:19], s60 offen lds
    v_cvt_pk_bf16_f32 v96, v99, v100
    v_cvt_pk_bf16_f32 v97, v101, v102
    v_cvt_pk_bf16_f32 v85, v103, v104
    ds_write_b64 v4, v[202:203] offset:0
    v_mfma_f32_32x32x16_bf16 v[128:143], v[184:187], v[24:27], v[128:143]
    s_waitcnt lgkmcnt(5)
    ds_read_b64_tr_b16 v[184:185], v10 offset:32768
    ds_read_b64_tr_b16 v[186:187], v10 offset:33024
    ds_write_b64 v4, v[204:205] offset:16
    ds_write_b64 v4, v[206:207] offset:32
    ds_write_b64 v4, v[96:97] offset:48
    v_mfma_f32_32x32x16_bf16 v[112:127], v[188:191], a[124:127], v[112:127]
    s_mul_i32 s60, s100, 589824
    ds_write_b64 v4, v[80:81] offset:64
    ds_write_b64 v4, v[82:83] offset:80
    ds_write_b64 v4, v[84:85] offset:96
    ds_read_b64_tr_b16 v[96:97], v5 offset:0
    v_mfma_f32_32x32x16_bf16 v[128:143], v[188:191], v[28:31], v[128:143]
    s_waitcnt lgkmcnt(12)
    ds_read_b64_tr_b16 v[188:189], v11 offset:32768
    ds_read_b64_tr_b16 v[190:191], v11 offset:33024
    s_add_u32 m0, s44, 28672
    ds_read_b64_tr_b16 v[98:99], v5 offset:448
    v_mfma_f32_16x16x32_bf16 v[236:239], v[232:235], v[176:179], v[236:239]
    s_add_u32 s60, s60, s48
    s_waitcnt lgkmcnt(14)
    ds_read_b64_tr_b16 v[100:101], v5 offset:32
    s_waitcnt lgkmcnt(14)
    ds_read_b64_tr_b16 v[102:103], v5 offset:480
    v_mfma_f32_32x32x16_bf16 v[112:127], v[176:179], a[128:131], v[112:127]
    buffer_load_dwordx4 v2, s[12:15], s60 offen lds
    s_waitcnt lgkmcnt(14)
    ds_read_b64_tr_b16 v[104:105], v5 offset:64
    s_waitcnt lgkmcnt(14)
    ds_read_b64_tr_b16 v[106:107], v5 offset:512
    s_waitcnt lgkmcnt(14)
    ds_read_b64_tr_b16 v[108:109], v5 offset:96
    s_waitcnt lgkmcnt(14)
    ds_read_b64_tr_b16 v[110:111], v5 offset:544
    v_mfma_f32_32x32x16_bf16 v[128:143], v[176:179], v[32:35], v[128:143]
    s_waitcnt lgkmcnt(14)
    ds_read_b64_tr_b16 v[176:177], v8 offset:32
    s_waitcnt lgkmcnt(14)
    ds_read_b64_tr_b16 v[178:179], v8 offset:288
    s_mul_i32 s40, s36, 3600
    s_add_u32 s40, s40, 147552
    v_mfma_f32_32x32x16_bf16 v[112:127], v[180:183], a[132:135], v[112:127]
    s_add_u32 m0, s44, 65568
    v_lshl_add_u32 v72, v1, 4, s40
    v_lshrrev_b32 v246, 4, v1
    v_and_b32 v247, 15, v1
    v_lshl_add_u32 v246, v246, 3, v247
    v_lshl_add_u32 v73, v246, 4, s40
    v_mfma_f32_32x32x16_bf16 v[128:143], v[180:183], v[36:39], v[128:143]
    s_waitcnt lgkmcnt(14)
    ds_read_b64_tr_b16 v[180:181], v9 offset:32
    s_waitcnt lgkmcnt(14)
    ds_read_b64_tr_b16 v[182:183], v9 offset:288
    s_add_u32 s100, s100, 1
    s_cmp_eq_u32 s100, 9
    s_cselect_b32 s100, 0, s100
    v_lshl_add_u32 v74, v1, 3, s40
    v_mfma_f32_32x32x16_bf16 v[112:127], v[184:187], a[136:139], v[112:127]
    v_lshl_add_u32 v75, v246, 3, s40
    s_waitcnt lgkmcnt(6)
    v_mfma_f32_16x16x32_bf16 v[48:51], v[96:99], v[104:107], 0
    s_waitcnt lgkmcnt(4)
    v_mfma_f32_16x16x32_bf16 v[52:55], v[96:99], v[108:111], 0
    v_mfma_f32_32x32x16_bf16 v[128:143], v[184:187], v[40:43], v[128:143]
    ds_read_b64_tr_b16 v[184:185], v10 offset:32
    ds_read_b64_tr_b16 v[186:187], v10 offset:288
    v_mfma_f32_16x16x32_bf16 v[56:59], v[100:103], v[104:107], 0
    v_mfma_f32_16x16x32_bf16 v[60:63], v[100:103], v[108:111], 0
    v_mfma_f32_32x32x16_bf16 v[112:127], v[188:191], a[140:143], v[112:127]
    buffer_load_dwordx4 v2, s[16:19], s60 offen lds
    v_mfma_f32_16x16x32_bf16 v[64:67], v[108:111], v[104:107], 0
    v_mfma_f32_16x16x32_bf16 v[68:71], v[108:111], v[108:111], 0
    v_mfma_f32_32x32x16_bf16 v[128:143], v[188:191], v[44:47], v[128:143]
    s_waitcnt lgkmcnt(4)
    ds_read_b64_tr_b16 v[188:189], v11 offset:32
    ds_read_b64_tr_b16 v[190:191], v11 offset:288
    s_mul_i32 s60, s100, 589824
    v_max3_f32 v106, v217, v218, v219
    v_max3_f32 v107, -v217, -v218, -v219
    v_mfma_f32_16x16x32_bf16 v[240:243], v[232:235], v[176:179], 0
    s_add_u32 m0, s44, 32768
    v_max3_f32 v109, v220, v221, v222
    v_mfma_f32_32x32x16_bf16 v[144:159], v[176:179], a[0:3], 0
    s_add_u32 s60, s60, s48
    v_max3_f32 v110, -v220, -v221, -v222
    v_max3_f32 v108, v223, v94, v95
    v_max3_f32 v111, -v223, -v94, -v95
    v_max3_f32 v106, v106, v109, v108
    v_max3_f32 v107, v107, v110, v111
    v_mfma_f32_32x32x16_bf16 v[160:175], v[176:179], a[144:147], 0
    s_waitcnt lgkmcnt(4)
    ds_read_b64_tr_b16 v[176:177], v8 offset:4128
    ds_read_b64_tr_b16 v[178:179], v8 offset:4384
    buffer_load_dwordx4 v2, s[12:15], s60 offen lds
    v_permlane32_swap_b32 v106, v107
    v_mfma_f32_32x32x16_bf16 v[144:159], v[180:183], a[4:7], v[144:159]
    v_max_f32 v106, v106, v107
    v_mul_f32 v106, v231, v106
    v_mov_b32 v107, v106
    s_mov_b64 exec, 0xffff
    ds_write_b64 v244, v[236:237] offset:14912
    s_mov_b64 exec, -1
    v_mfma_f32_32x32x16_bf16 v[160:175], v[180:183], a[148:151], v[160:175]
    s_waitcnt lgkmcnt(5)
    ds_read_b64_tr_b16 v[180:181], v9 offset:4128
    ds_read_b64_tr_b16 v[182:183], v9 offset:4384
    s_add_u32 m0, s44, 69664
    v_permlane32_swap_b32 v106, v107
    v_fma_f32 v96, v217, v231, v107
    v_mfma_f32_32x32x16_bf16 v[144:159], v[184:187], a[8:11], v[144:159]
    s_add_u32 s100, s100, 1
    s_cmp_eq_u32 s100, 9
    s_cselect_b32 s100, 0, s100
    v_fma_f32 v97, v218, v231, v107
    v_fma_f32 v98, v219, v231, v107
    v_fma_f32 v99, v220, v231, v107
    v_mfma_f32_32x32x16_bf16 v[160:175], v[184:187], a[152:155], v[160:175]
    s_waitcnt lgkmcnt(5)
    ds_read_b64_tr_b16 v[184:185], v10 offset:4128
    ds_read_b64_tr_b16 v[186:187], v10 offset:4384
    v_fma_f32 v100, v221, v231, v107
    v_fma_f32 v101, v222, v231, v107
    v_fma_f32 v102, v223, v231, v107
    v_mfma_f32_32x32x16_bf16 v[144:159], v[188:191], a[12:15], v[144:159]
    v_fma_f32 v103, v94, v231, v107
    v_fma_f32 v104, v95, v231, v107
    v_fma_f32 v217, -v217, v231, v106
    v_fma_f32 v218, -v218, v231, v106
    v_fma_f32 v219, -v219, v231, v106
    v_mfma_f32_32x32x16_bf16 v[160:175], v[188:191], a[156:159], v[160:175]
    s_waitcnt lgkmcnt(5)
    ds_read_b64_tr_b16 v[188:189], v11 offset:4128
    ds_read_b64_tr_b16 v[190:191], v11 offset:4384
    buffer_load_dwordx4 v2, s[16:19], s60 offen lds
    v_fma_f32 v220, -v220, v231, v106
    v_fma_f32 v221, -v221, v231, v106
    v_mfma_f32_16x16x32_bf16 v[240:243], v[232:235], v[176:179], v[240:243]
    v_fma_f32 v222, -v222, v231, v106
    v_fma_f32 v223, -v223, v231, v106
    v_mfma_f32_32x32x16_bf16 v[144:159], v[176:179], a[16:19], v[144:159]
    v_fma_f32 v94, -v94, v231, v106
    v_fma_f32 v95, -v95, v231, v106
    v_exp_f32 v96, v96
    v_exp_f32 v97, v97
    v_mfma_f32_32x32x16_bf16 v[160:175], v[176:179], a[160:163], v[160:175]
    s_waitcnt lgkmcnt(4)
    ds_read_b64_tr_b16 v[176:177], v8 offset:8224
    ds_read_b64_tr_b16 v[178:179], v8 offset:8480
    v_exp_f32 v98, v98
    v_exp_f32 v99, v99
    v_mfma_f32_32x32x16_bf16 v[144:159], v[180:183], a[20:23], v[144:159]
    v_exp_f32 v100, v100
    v_exp_f32 v101, v101
    v_exp_f32 v102, v102
    v_mfma_f32_32x32x16_bf16 v[160:175], v[180:183], a[164:167], v[160:175]
    s_waitcnt lgkmcnt(4)
    ds_read_b64_tr_b16 v[180:181], v9 offset:8224
    ds_read_b64_tr_b16 v[182:183], v9 offset:8480
    v_exp_f32 v103, v103
    v_add_u32 v6, 4096, v6
    buffer_load_dword v13, v6, s[4:7], s80 offen
    v_mfma_f32_32x32x16_bf16 v[144:159], v[184:187], a[24:27], v[144:159]
    v_exp_f32 v104, v104
    v_exp_f32 v217, v217
    v_exp_f32 v218, v218
    v_mfma_f32_32x32x16_bf16 v[160:175], v[184:187], a[168:171], v[160:175]
    s_waitcnt lgkmcnt(4)
    ds_read_b64_tr_b16 v[184:185], v10 offset:8224
    ds_read_b64_tr_b16 v[186:187], v10 offset:8480
    v_exp_f32 v219, v219
    v_exp_f32 v220, v220
    v_mfma_f32_32x32x16_bf16 v[144:159], v[188:191], a[28:31], v[144:159]
    v_exp_f32 v221, v221
    v_exp_f32 v222, v222
    v_exp_f32 v223, v223
    v_mfma_f32_32x32x16_bf16 v[160:175], v[188:191], a[172:175], v[160:175]
    s_waitcnt lgkmcnt(4)
    ds_read_b64_tr_b16 v[188:189], v11 offset:8224
    ds_read_b64_tr_b16 v[190:191], v11 offset:8480
    v_exp_f32 v94, v94
    v_exp_f32 v95, v95
    v_mfma_f32_16x16x32_bf16 v[240:243], v[232:235], v[176:179], v[240:243]
    v_add_f32 v107, v96, v97
    v_add_f32 v110, v98, v99
    v_mfma_f32_32x32x16_bf16 v[144:159], v[176:179], a[32:35], v[144:159]
    v_add_f32 v106, v217, v218
    v_add_f32 v109, v219, v220
    v_add_f32 v107, v107, v100
    v_add_f32 v110, v110, v101
    v_add_f32 v106, v106, v221
    v_add_f32 v109, v109, v222
    v_mfma_f32_32x32x16_bf16 v[160:175], v[176:179], a[176:179], v[160:175]
    s_waitcnt lgkmcnt(4)
    ds_read_b64_tr_b16 v[176:177], v8 offset:12320
    ds_read_b64_tr_b16 v[178:179], v8 offset:12576
    v_add_f32 v107, v107, v102
    v_add_f32 v110, v110, v103
    v_add_f32 v106, v106, v223
    v_add_f32 v109, v109, v94
    v_mfma_f32_32x32x16_bf16 v[144:159], v[180:183], a[36:39], v[144:159]
    v_add_f32 v107, v107, v104
    v_add_f32 v106, v106, v95
    v_add_f32 v107, v107, v110
    v_add_f32 v106, v106, v109
    v_mfma_f32_32x32x16_bf16 v[160:175], v[180:183], a[180:183], v[160:175]
    s_waitcnt lgkmcnt(4)
    ds_read_b64_tr_b16 v[180:181], v9 offset:12320
    ds_read_b64_tr_b16 v[182:183], v9 offset:12576
    v_permlane32_swap_b32 v106, v107
    v_add_f32 v106, v106, v107
    v_mfma_f32_32x32x16_bf16 v[144:159], v[184:187], a[40:43], v[144:159]
    v_rcp_f32 v106, v106
    v_mfma_f32_32x32x16_bf16 v[160:175], v[184:187], a[184:187], v[160:175]
    s_waitcnt lgkmcnt(4)
    ds_read_b64_tr_b16 v[184:185], v10 offset:12320
    ds_read_b64_tr_b16 v[186:187], v10 offset:12576
    v_mov_b32 v107, v106
    v_mfma_f32_32x32x16_bf16 v[144:159], v[188:191], a[44:47], v[144:159]
    v_mfma_f32_32x32x16_bf16 v[160:175], v[188:191], a[188:191], v[160:175]
    s_waitcnt lgkmcnt(4)
    ds_read_b64_tr_b16 v[188:189], v11 offset:12320
    ds_read_b64_tr_b16 v[190:191], v11 offset:12576
    v_permlane32_swap_b32 v106, v107
    v_mul_f32 v217, v217, v106
    v_mul_f32 v218, v218, v106
    v_mfma_f32_16x16x32_bf16 v[240:243], v[232:235], v[176:179], v[240:243]
    v_mul_f32 v219, v219, v106
    v_mul_f32 v220, v220, v106
    v_mfma_f32_32x32x16_bf16 v[144:159], v[176:179], a[48:51], v[144:159]
    v_mul_f32 v221, v221, v106
    v_mul_f32 v222, v222, v106
    v_mul_f32 v223, v223, v106
    v_mul_f32 v94, v94, v106
    v_mul_f32 v95, v95, v106
    v_mul_f32 v96, v96, v107
    v_mfma_f32_32x32x16_bf16 v[160:175], v[176:179], a[192:195], v[160:175]
    s_waitcnt lgkmcnt(4)
    ds_read_b64_tr_b16 v[176:177], v8 offset:16416
    ds_read_b64_tr_b16 v[178:179], v8 offset:16672
    v_mul_f32 v97, v97, v107
    v_mul_f32 v98, v98, v107
    v_mul_f32 v99, v99, v107
    v_mul_f32 v100, v100, v107
    v_mfma_f32_32x32x16_bf16 v[144:159], v[180:183], a[52:55], v[144:159]
    v_mul_f32 v101, v101, v107
    v_mul_f32 v102, v102, v107
    v_mul_f32 v103, v103, v107
    v_mul_f32 v104, v104, v107
    v_cvt_pk_bf16_f32 v218, v217, v218
    v_cvt_pk_bf16_f32 v219, v219, v220
    v_mfma_f32_32x32x16_bf16 v[160:175], v[180:183], a[196:199], v[160:175]
    s_waitcnt lgkmcnt(4)
    ds_read_b64_tr_b16 v[180:181], v9 offset:16416
    ds_read_b64_tr_b16 v[182:183], v9 offset:16672
    v_cvt_pk_bf16_f32 v220, v221, v222
    v_cvt_pk_bf16_f32 v221, v223, v94
    v_cvt_pk_bf16_f32 v222, v95, v96
    v_mfma_f32_32x32x16_bf16 v[144:159], v[184:187], a[56:59], v[144:159]
    v_cvt_pk_bf16_f32 v223, v97, v98
    v_cvt_pk_bf16_f32 v96, v99, v100
    v_cvt_pk_bf16_f32 v97, v101, v102
    v_cvt_pk_bf16_f32 v93, v103, v104
    ds_write_b64 v4, v[218:219] offset:0
    v_mfma_f32_32x32x16_bf16 v[160:175], v[184:187], a[200:203], v[160:175]
    s_waitcnt lgkmcnt(5)
    ds_read_b64_tr_b16 v[184:185], v10 offset:16416
    ds_read_b64_tr_b16 v[186:187], v10 offset:16672
    ds_write_b64 v4, v[220:221] offset:16
    ds_write_b64 v4, v[222:223] offset:32
    ds_write_b64 v4, v[96:97] offset:48
    v_mfma_f32_32x32x16_bf16 v[144:159], v[188:191], a[60:63], v[144:159]
    ds_write_b64 v4, v[88:89] offset:64
    ds_write_b64 v4, v[90:91] offset:80
    ds_write_b64 v4, v[92:93] offset:96
    ds_read_b64_tr_b16 v[96:97], v5 offset:0
    ds_read_b64_tr_b16 v[98:99], v5 offset:448
    v_mfma_f32_32x32x16_bf16 v[160:175], v[188:191], a[204:207], v[160:175]
    s_waitcnt lgkmcnt(13)
    ds_read_b64_tr_b16 v[188:189], v11 offset:16416
    ds_read_b64_tr_b16 v[190:191], v11 offset:16672
    s_waitcnt lgkmcnt(14)
    ds_read_b64_tr_b16 v[100:101], v5 offset:32
    s_waitcnt lgkmcnt(14)
    ds_read_b64_tr_b16 v[102:103], v5 offset:480
    v_mfma_f32_16x16x32_bf16 v[240:243], v[232:235], v[176:179], v[240:243]
    s_waitcnt lgkmcnt(14)
    ds_read_b64_tr_b16 v[104:105], v5 offset:64
    s_waitcnt lgkmcnt(14)
    ds_read_b64_tr_b16 v[106:107], v5 offset:512
    v_mfma_f32_32x32x16_bf16 v[144:159], v[176:179], a[64:67], v[144:159]
    s_waitcnt lgkmcnt(14)
    ds_read_b64_tr_b16 v[108:109], v5 offset:96
    s_waitcnt lgkmcnt(14)
    ds_read_b64_tr_b16 v[110:111], v5 offset:544
    v_mfma_f32_32x32x16_bf16 v[160:175], v[176:179], a[208:211], v[160:175]
    s_waitcnt lgkmcnt(14)
    ds_read_b64_tr_b16 v[176:177], v8 offset:20512
    s_waitcnt lgkmcnt(14)
    ds_read_b64_tr_b16 v[178:179], v8 offset:20768
    v_mfma_f32_32x32x16_bf16 v[144:159], v[180:183], a[68:71], v[144:159]
    v_mfma_f32_32x32x16_bf16 v[160:175], v[180:183], a[212:215], v[160:175]
    s_waitcnt lgkmcnt(14)
    ds_read_b64_tr_b16 v[180:181], v9 offset:20512
    s_waitcnt lgkmcnt(14)
    ds_read_b64_tr_b16 v[182:183], v9 offset:20768
    s_waitcnt lgkmcnt(6)
    v_mfma_f32_16x16x32_bf16 v[48:51], v[96:99], v[104:107], v[48:51]
    v_mfma_f32_32x32x16_bf16 v[144:159], v[184:187], a[72:75], v[144:159]
    s_waitcnt lgkmcnt(4)
    v_mfma_f32_16x16x32_bf16 v[52:55], v[96:99], v[108:111], v[52:55]
    v_mfma_f32_16x16x32_bf16 v[56:59], v[100:103], v[104:107], v[56:59]
    v_mfma_f32_16x16x32_bf16 v[60:63], v[100:103], v[108:111], v[60:63]
    v_mfma_f32_32x32x16_bf16 v[160:175], v[184:187], a[216:219], v[160:175]
    ds_read_b64_tr_b16 v[184:185], v10 offset:20512
    ds_read_b64_tr_b16 v[186:187], v10 offset:20768
    v_mfma_f32_16x16x32_bf16 v[64:67], v[108:111], v[104:107], v[64:67]
    v_mfma_f32_16x16x32_bf16 v[68:71], v[108:111], v[108:111], v[68:71]
    v_mfma_f32_32x32x16_bf16 v[144:159], v[188:191], a[76:79], v[144:159]
    ds_write_b128 v72, v[48:51]
    ds_write_b128 v72, v[56:59] offset:1024
    v_mfma_f32_32x32x16_bf16 v[160:175], v[188:191], a[220:223], v[160:175]
    s_waitcnt lgkmcnt(6)
    ds_read_b64_tr_b16 v[188:189], v11 offset:20512
    ds_read_b64_tr_b16 v[190:191], v11 offset:20768
    v_mfma_f32_16x16x32_bf16 v[240:243], v[232:235], v[176:179], v[240:243]
    v_mfma_f32_32x32x16_bf16 v[144:159], v[176:179], a[80:83], v[144:159]
    v_mfma_f32_32x32x16_bf16 v[160:175], v[176:179], a[224:227], v[160:175]
    s_waitcnt lgkmcnt(6)
    ds_read_b64_tr_b16 v[176:177], v8 offset:24608
    ds_read_b64_tr_b16 v[178:179], v8 offset:24864
    v_mfma_f32_32x32x16_bf16 v[144:159], v[180:183], a[84:87], v[144:159]
    v_mfma_f32_32x32x16_bf16 v[160:175], v[180:183], a[228:231], v[160:175]
    s_waitcnt lgkmcnt(6)
    ds_read_b64_tr_b16 v[180:181], v9 offset:24608
    ds_read_b64_tr_b16 v[182:183], v9 offset:24864
    s_mov_b32 exec_lo, 0xff00ff
    s_mov_b32 exec_hi, 0xff00ff
    ds_write_b128 v73, v[52:55] offset:2048
    ds_write_b128 v73, v[60:63] offset:2560
    s_mov_b32 exec_hi, 0
    ds_write_b64 v75, v[70:71] offset:3328
    s_mov_b32 exec_lo, -1
    ds_write_b64 v74, v[66:67] offset:3072
    s_mov_b32 exec_hi, -1
    v_mfma_f32_32x32x16_bf16 v[144:159], v[184:187], a[88:91], v[144:159]
    v_max3_f32 v106, v192, v193, v194
    v_max3_f32 v107, -v192, -v193, -v194
    v_max3_f32 v109, v195, v196, v197
    v_max3_f32 v110, -v195, -v196, -v197
    v_max3_f32 v108, v198, v199, v200
    v_mfma_f32_32x32x16_bf16 v[160:175], v[184:187], a[232:235], v[160:175]
    s_waitcnt lgkmcnt(8)
    ds_read_b64_tr_b16 v[184:185], v10 offset:24608
    ds_read_b64_tr_b16 v[186:187], v10 offset:24864
    v_max3_f32 v111, -v198, -v199, -v200
    v_max3_f32 v106, v106, v109, v108
    v_mfma_f32_32x32x16_bf16 v[144:159], v[188:191], a[92:95], v[144:159]
    v_max3_f32 v107, v107, v110, v111
    v_mfma_f32_32x32x16_bf16 v[160:175], v[188:191], a[236:239], v[160:175]
    s_waitcnt lgkmcnt(8)
    ds_read_b64_tr_b16 v[188:189], v11 offset:24608
    ds_read_b64_tr_b16 v[190:191], v11 offset:24864
    v_permlane32_swap_b32 v106, v107
    v_max_f32 v106, v106, v107
    v_mul_f32 v106, v230, v106
    v_mfma_f32_16x16x32_bf16 v[240:243], v[232:235], v[176:179], v[240:243]
    v_mov_b32 v107, v106
    v_mfma_f32_32x32x16_bf16 v[144:159], v[176:179], a[96:99], v[144:159]
    v_mfma_f32_32x32x16_bf16 v[160:175], v[176:179], a[240:243], v[160:175]
    s_waitcnt lgkmcnt(8)
    ds_read_b64_tr_b16 v[176:177], v8 offset:28704
    ds_read_b64_tr_b16 v[178:179], v8 offset:28960
    v_permlane32_swap_b32 v106, v107
    v_fma_f32 v96, v192, v230, v107
    v_fma_f32 v97, v193, v230, v107
    v_mfma_f32_32x32x16_bf16 v[144:159], v[180:183], a[100:103], v[144:159]
    v_fma_f32 v98, v194, v230, v107
    v_fma_f32 v99, v195, v230, v107
    v_fma_f32 v100, v196, v230, v107
    v_fma_f32 v101, v197, v230, v107
    v_fma_f32 v102, v198, v230, v107
    v_fma_f32 v103, v199, v230, v107
    v_mfma_f32_32x32x16_bf16 v[160:175], v[180:183], a[244:247], v[160:175]
    s_waitcnt lgkmcnt(4)
    ds_read_b64_tr_b16 v[180:181], v9 offset:28704
    ds_read_b64_tr_b16 v[182:183], v9 offset:28960
    v_fma_f32 v104, v200, v230, v107
    v_fma_f32 v192, -v192, v230, v106
    v_mfma_f32_32x32x16_bf16 v[144:159], v[184:187], a[104:107], v[144:159]
    v_fma_f32 v193, -v193, v230, v106
    v_fma_f32 v194, -v194, v230, v106
    v_fma_f32 v195, -v195, v230, v106
    v_fma_f32 v196, -v196, v230, v106
    v_fma_f32 v197, -v197, v230, v106
    v_mfma_f32_32x32x16_bf16 v[160:175], v[184:187], a[248:251], v[160:175]
    s_waitcnt lgkmcnt(4)
    ds_read_b64_tr_b16 v[184:185], v10 offset:28704
    ds_read_b64_tr_b16 v[186:187], v10 offset:28960
    v_fma_f32 v198, -v198, v230, v106
    v_fma_f32 v199, -v199, v230, v106
    v_fma_f32 v200, -v200, v230, v106
    v_mfma_f32_32x32x16_bf16 v[144:159], v[188:191], a[108:111], v[144:159]
    v_exp_f32 v96, v96
    v_exp_f32 v97, v97
    v_exp_f32 v98, v98
    v_mfma_f32_32x32x16_bf16 v[160:175], v[188:191], a[252:255], v[160:175]
    s_waitcnt lgkmcnt(4)
    ds_read_b64_tr_b16 v[188:189], v11 offset:28704
    ds_read_b64_tr_b16 v[190:191], v11 offset:28960
    v_exp_f32 v99, v99
    v_exp_f32 v100, v100
    v_mfma_f32_16x16x32_bf16 v[240:243], v[232:235], v[176:179], v[240:243]
    v_exp_f32 v101, v101
    v_mfma_f32_32x32x16_bf16 v[144:159], v[176:179], a[112:115], v[144:159]
    v_exp_f32 v102, v102
    v_exp_f32 v103, v103
    v_exp_f32 v104, v104
    v_mfma_f32_32x32x16_bf16 v[160:175], v[176:179], v[16:19], v[160:175]
    s_waitcnt lgkmcnt(4)
    ds_read_b64_tr_b16 v[176:177], v8 offset:32800
    ds_read_b64_tr_b16 v[178:179], v8 offset:33056
    v_exp_f32 v192, v192
    v_exp_f32 v193, v193
    v_mfma_f32_32x32x16_bf16 v[144:159], v[180:183], a[116:119], v[144:159]
    v_exp_f32 v194, v194
    v_exp_f32 v195, v195
    v_exp_f32 v196, v196
    v_mfma_f32_32x32x16_bf16 v[160:175], v[180:183], v[20:23], v[160:175]
    s_waitcnt lgkmcnt(4)
    ds_read_b64_tr_b16 v[180:181], v9 offset:32800
    ds_read_b64_tr_b16 v[182:183], v9 offset:33056
    v_exp_f32 v197, v197
    v_exp_f32 v198, v198
    v_mfma_f32_32x32x16_bf16 v[144:159], v[184:187], a[120:123], v[144:159]
    v_exp_f32 v199, v199
    v_exp_f32 v200, v200
    v_add_f32 v107, v96, v97
    v_add_f32 v110, v98, v99
    v_mfma_f32_32x32x16_bf16 v[160:175], v[184:187], v[24:27], v[160:175]
    s_waitcnt lgkmcnt(4)
    ds_read_b64_tr_b16 v[184:185], v10 offset:32800
    ds_read_b64_tr_b16 v[186:187], v10 offset:33056
    v_add_f32 v106, v192, v193
    v_add_f32 v109, v194, v195
    v_add_f32 v107, v107, v100
    v_add_f32 v110, v110, v101
    v_mfma_f32_32x32x16_bf16 v[144:159], v[188:191], a[124:127], v[144:159]
    v_add_f32 v106, v106, v196
    v_add_f32 v109, v109, v197
    v_add_f32 v107, v107, v102
    v_add_f32 v110, v110, v103
    v_add_f32 v106, v106, v198
    v_add_f32 v109, v109, v199
    v_mfma_f32_32x32x16_bf16 v[160:175], v[188:191], v[28:31], v[160:175]
    s_waitcnt lgkmcnt(4)
    ds_read_b64_tr_b16 v[188:189], v11 offset:32800
    ds_read_b64_tr_b16 v[190:191], v11 offset:33056
    v_add_f32 v107, v107, v104
    v_add_f32 v106, v106, v200
    v_add_f32 v107, v107, v110
    v_add_f32 v106, v106, v109
    v_mfma_f32_16x16x32_bf16 v[240:243], v[232:235], v[176:179], v[240:243]
    v_mfma_f32_32x32x16_bf16 v[144:159], v[176:179], a[128:131], v[144:159]
    v_permlane32_swap_b32 v106, v107
    v_add_f32 v106, v106, v107
    v_rcp_f32 v106, v106
    v_mfma_f32_32x32x16_bf16 v[160:175], v[176:179], v[32:35], v[160:175]
    s_waitcnt lgkmcnt(4)
    v_mov_b32 v107, v106
    v_mfma_f32_32x32x16_bf16 v[144:159], v[180:183], a[132:135], v[144:159]
    s_waitcnt vmcnt(1)
    s_waitcnt lgkmcnt(0)
    s_barrier
    s_add_u32 s57, s66, 0
    v_add_u32 v8, s57, v7
    ds_read_b64_tr_b16 v[176:177], v8 offset:0
    ds_read_b64_tr_b16 v[178:179], v8 offset:256
    v_mfma_f32_32x32x16_bf16 v[160:175], v[180:183], v[36:39], v[160:175]
    s_add_u32 s57, s67, 0
    v_add_u32 v9, s57, v7
    ds_read_b64_tr_b16 v[180:181], v9 offset:0
    ds_read_b64_tr_b16 v[182:183], v9 offset:256
    v_permlane32_swap_b32 v106, v107
    v_mfma_f32_32x32x16_bf16 v[144:159], v[184:187], a[136:139], v[144:159]
    s_mul_i32 s60, s100, 589824
    v_mul_f32 v192, v192, v106
    v_mul_f32 v193, v193, v106
    v_mul_f32 v194, v194, v106
    v_mul_f32 v195, v195, v106
    v_mul_f32 v196, v196, v106
    v_mul_f32 v197, v197, v106
    v_mfma_f32_32x32x16_bf16 v[160:175], v[184:187], v[40:43], v[160:175]
    s_add_u32 s57, s68, 0
    v_add_u32 v10, s57, v7
    ds_read_b64_tr_b16 v[184:185], v10 offset:0
    ds_read_b64_tr_b16 v[186:187], v10 offset:256
    s_add_u32 m0, s44, 73760
    v_mul_f32 v198, v198, v106
    v_mfma_f32_32x32x16_bf16 v[144:159], v[188:191], a[140:143], v[144:159]
    s_add_u32 s60, s60, s49
    s_and_b32 s40, s36, 1
    s_lshr_b32 s41, s36, 1
    s_cmp_eq_u32 s41, 0
    s_cselect_b64 vcc, -1, 0
    v_cndmask_b32 v12, v246, v1, vcc
    s_lshl_b32 s42, s40, 10
    v_mfma_f32_32x32x16_bf16 v[160:175], v[188:191], v[44:47], v[160:175]
    s_waitcnt lgkmcnt(4)
    s_add_u32 s57, s69, 0
    v_add_u32 v11, s57, v7
    ds_read_b64_tr_b16 v[188:189], v11 offset:0
    ds_read_b64_tr_b16 v[190:191], v11 offset:256
    buffer_load_dwordx4 v2, s[12:15], s60 offen lds
    v_mfma_f32_16x16x32_bf16 v[236:239], v[232:235], v[176:179], 0
    s_lshl_b32 s43, s40, 9
    s_add_u32 s43, s43, 2048
    ds_read_b32 v248, v245 offset:14912
    v_mfma_f32_32x32x16_bf16 v[48:63], v[176:179], a[0:3], 0
    s_add_u32 m0, s44, 110656
    s_cmp_eq_u32 s41, 0
    s_cselect_b32 s42, s42, s43
    s_add_u32 s42, s42, 147552
    v_lshl_add_u32 v12, v12, 4, s42
    ds_read_b128 v[80:83], v12 offset:0
    v_mul_f32 v199, v199, v106
    ds_read_b128 v[84:87], v12 offset:3600
    ds_read_b128 v[88:91], v12 offset:7200
    v_mfma_f32_32x32x16_bf16 v[64:79], v[176:179], a[144:147], 0
    s_waitcnt lgkmcnt(8)
    ds_read_b64_tr_b16 v[176:177], v8 offset:4096
    ds_read_b64_tr_b16 v[178:179], v8 offset:4352
    s_add_u32 s100, s100, 1
    s_cmp_eq_u32 s100, 9
    s_cselect_b32 s100, 0, s100
    ds_read_b128 v[92:95], v12 offset:10800
    s_cmp_eq_u32 s40, 0
    s_cselect_b64 vcc, -1, 0
    v_mfma_f32_32x32x16_bf16 v[48:63], v[180:183], a[4:7], v[48:63]
    s_waitcnt vmcnt(1)
    v_cndmask_b32 v13, v246, v1, vcc
    s_lshl_b32 s42, s40, 8
    s_add_u32 s42, s42, 150624
    v_lshl_add_u32 v13, v13, 3, s42
    ds_read_b64 v[204:205], v13 offset:0
    ds_read_b64 v[206:207], v13 offset:3600
    ds_read_b64 v[220:221], v13 offset:7200
    ds_read_b64 v[222:223], v13 offset:10800
    v_mfma_f32_32x32x16_bf16 v[64:79], v[180:183], a[148:151], v[64:79]
    s_waitcnt lgkmcnt(13)
    ds_read_b64_tr_b16 v[180:181], v9 offset:4096
    ds_read_b64_tr_b16 v[182:183], v9 offset:4352
    v_lshrrev_b32 v14, 5, v1
    v_lshlrev_b32 v14, 10, v14
    s_waitcnt lgkmcnt(14)
    ds_read_b32 v249, v245 offset:15040
    v_mul_f32 v200, v200, v106
    s_waitcnt lgkmcnt(14)
    ds_read_b32 v250, v245 offset:15168
    v_bfe_u32 v15, v1, 4, 1
    s_waitcnt lgkmcnt(14)
    ds_read_b32 v251, v245 offset:15296
    v_mfma_f32_32x32x16_bf16 v[48:63], v[184:187], a[8:11], v[48:63]
    buffer_load_dwordx4 v2, s[16:19], s60 offen lds
    s_mov_b64 exec, 0xffff
    s_waitcnt lgkmcnt(14)
    ds_write_b64 v244, v[240:241] offset:15424
    s_mov_b64 exec, -1
    v_lshlrev_b32 v15, 7, v15
    v_mfma_f32_32x32x16_bf16 v[64:79], v[184:187], a[152:155], v[64:79]
    s_waitcnt lgkmcnt(14)
    ds_read_b64_tr_b16 v[184:185], v10 offset:4096
    s_waitcnt lgkmcnt(14)
    ds_read_b64_tr_b16 v[186:187], v10 offset:4352
    v_lshl_add_u32 v15, v247, 2, v15
    s_lshl_b32 s42, s40, 11
    s_lshl_b32 s43, s41, 6
    s_add_u32 s42, s42, s43
    v_mfma_f32_32x32x16_bf16 v[48:63], v[188:191], a[12:15], v[48:63]
    s_mul_i32 s60, s100, 589824
    v_add3_u32 v14, v14, v15, s42
    s_lshl_b32 s43, s41, 3
    s_sub_u32 s43, 16, s43
    v_cmp_gt_u32 vcc, s43, v247
    v_mov_b32 v12, 2146435072
    v_mul_f32 v96, v96, v107
    v_mfma_f32_32x32x16_bf16 v[64:79], v[188:191], a[156:159], v[64:79]
    s_waitcnt lgkmcnt(13)
    ds_read_b64_tr_b16 v[188:189], v11 offset:4096
    ds_read_b64_tr_b16 v[190:191], v11 offset:4352
    s_add_u32 m0, s44, 77856
    s_add_u32 s60, s60, s49
    s_waitcnt lgkmcnt(7)
    v_add_f32 v248, v248, v249
    s_waitcnt lgkmcnt(5)
    v_add_f32 v250, v250, v251
    v_add_f32 v248, v248, v250
    v_mfma_f32_16x16x32_bf16 v[236:239], v[232:235], v[176:179], v[236:239]
    buffer_load_dwordx4 v2, s[12:15], s60 offen lds
    v_mfma_f32_32x32x16_bf16 v[48:63], v[176:179], a[16:19], v[48:63]
    v_cvt_pk_bf16_f32 v249, v248, v248
    v_lshlrev_b32 v249, 16, v249
    v_sub_f32 v249, v248, v249
    v_cvt_pk_bf16_f32 v224, v248, v249
    v_cndmask_b32 v14, v12, v14, vcc
    s_lshl_b32 s42, s40, 6
    v_mfma_f32_32x32x8_bf16 v[112:127], v[224:225], v[226:227], v[112:127]
    v_mfma_f32_32x32x16_bf16 v[64:79], v[176:179], a[160:163], v[64:79]
    s_waitcnt lgkmcnt(4)
    s_barrier
    ds_read_b64_tr_b16 v[176:177], v8 offset:8192
    ds_read_b64_tr_b16 v[178:179], v8 offset:8448
    s_add_u32 m0, s44, 114752
    s_add_u32 s42, s42, 4096
    v_mfma_f32_32x32x8_bf16 v[128:143], v[224:225], v[228:229], v[128:143]
    v_mfma_f32_32x32x16_bf16 v[48:63], v[180:183], a[20:23], v[48:63]
    s_add_u32 s100, s100, 1
    s_cmp_eq_u32 s100, 9
    s_cselect_b32 s100, 0, s100
    v_add_u32 v15, s42, v15
    s_lshl_b32 s43, s40, 3
    s_sub_u32 s43, 16, s43
    v_mfma_f32_32x32x16_bf16 v[64:79], v[180:183], a[164:167], v[64:79]
    s_waitcnt lgkmcnt(4)
    ds_read_b64_tr_b16 v[180:181], v9 offset:8192
    ds_read_b64_tr_b16 v[182:183], v9 offset:8448
    v_mul_f32 v248, v230, v112
    s_cmp_eq_u32 s41, 0
    s_cselect_b32 s43, s43, 0
    v_mul_f32 v249, v230, v113
    v_mul_f32 v250, v230, v114
    v_mul_f32 v251, v230, v115
    v_mfma_f32_32x32x16_bf16 v[48:63], v[184:187], a[24:27], v[48:63]
    v_cmp_gt_u32 vcc, s43, v247
    v_mul_f32 v252, v230, v116
    v_mul_f32 v253, v230, v117
    v_cmp_gt_u32 s[42:43], 32, v1
    v_mul_f32 v254, v230, v118
    v_mul_f32 v255, v230, v119
    v_exp_f32 v248, v248
    v_mfma_f32_32x32x16_bf16 v[64:79], v[184:187], a[168:171], v[64:79]
    s_waitcnt lgkmcnt(4)
    ds_read_b64_tr_b16 v[184:185], v10 offset:8192
    ds_read_b64_tr_b16 v[186:187], v10 offset:8448
    buffer_load_dwordx4 v2, s[16:19], s60 offen lds
    s_and_b64 vcc, vcc, s[42:43]
    v_cndmask_b32 v15, v12, v15, vcc
    v_exp_f32 v249, v249
    v_mfma_f32_32x32x16_bf16 v[48:63], v[188:191], a[28:31], v[48:63]
    v_add_f32 v80, v80, v84
    v_add_f32 v88, v88, v92
    v_exp_f32 v250, v250
    v_exp_f32 v251, v251
    v_add_f32 v81, v81, v85
    v_mfma_f32_32x32x16_bf16 v[64:79], v[188:191], a[172:175], v[64:79]
    s_waitcnt lgkmcnt(4)
    ds_read_b64_tr_b16 v[188:189], v11 offset:8192
    ds_read_b64_tr_b16 v[190:191], v11 offset:8448
    s_mul_i32 s60, s100, 589824
    v_add_f32 v89, v89, v93
    v_exp_f32 v252, v252
    v_add_f32 v82, v82, v86
    v_mfma_f32_16x16x32_bf16 v[236:239], v[232:235], v[176:179], v[236:239]
    s_add_u32 m0, s44, 81952
    v_add_f32 v90, v90, v94
    v_add_f32 v83, v83, v87
    v_mfma_f32_32x32x16_bf16 v[48:63], v[176:179], a[32:35], v[48:63]
    s_add_u32 s60, s60, s49
    v_add_f32 v91, v91, v95
    v_exp_f32 v253, v253
    v_exp_f32 v254, v254
    v_add_f32 v204, v204, v206
    v_exp_f32 v255, v255
    v_mfma_f32_32x32x16_bf16 v[64:79], v[176:179], a[176:179], v[64:79]
    s_waitcnt lgkmcnt(4)
    ds_read_b64_tr_b16 v[176:177], v8 offset:12288
    ds_read_b64_tr_b16 v[178:179], v8 offset:12544
    buffer_load_dwordx4 v2, s[12:15], s60 offen lds
    v_add_f32 v220, v220, v222
    v_add_f32 v205, v205, v207
    v_mul_f32 v112, v112, v120
    v_mfma_f32_32x32x16_bf16 v[48:63], v[180:183], a[36:39], v[48:63]
    v_add_f32 v221, v221, v223
    v_add_f32 v80, v80, v88
    v_mul_f32 v113, v113, v121
    v_mul_f32 v114, v114, v122
    v_mul_f32 v115, v115, v123
    v_mul_f32 v116, v116, v124
    v_mul_f32 v117, v117, v125
    v_mfma_f32_32x32x16_bf16 v[64:79], v[180:183], a[180:183], v[64:79]
    s_waitcnt lgkmcnt(4)
    ds_read_b64_tr_b16 v[180:181], v9 offset:12288
    ds_read_b64_tr_b16 v[182:183], v9 offset:12544
    s_add_u32 m0, s44, 118848
    v_add_f32 v81, v81, v89
    v_add_f32 v82, v82, v90
    v_mul_f32 v118, v118, v126
    v_mul_f32 v119, v119, v127
    v_mfma_f32_32x32x16_bf16 v[48:63], v[184:187], a[40:43], v[48:63]
    s_add_u32 s100, s100, 1
    s_cmp_eq_u32 s100, 9
    s_cselect_b32 s100, 0, s100
    v_add_f32 v83, v83, v91
    v_add_f32 v204, v204, v220
    v_add_f32 v248, 1.0, v248
    v_add_f32 v249, 1.0, v249
    v_mfma_f32_32x32x16_bf16 v[64:79], v[184:187], a[184:187], v[64:79]
    s_waitcnt lgkmcnt(4)
    ds_read_b64_tr_b16 v[184:185], v10 offset:12288
    ds_read_b64_tr_b16 v[186:187], v10 offset:12544
    v_add_f32 v205, v205, v221
    buffer_atomic_add_f32 v80, v14, s[24:27], s62 offen offset:0
    v_add_f32 v250, 1.0, v250
    v_add_f32 v251, 1.0, v251
    v_mfma_f32_32x32x16_bf16 v[48:63], v[188:191], a[44:47], v[48:63]
    buffer_atomic_add_f32 v81, v14, s[24:27], s62 offen offset:256
    v_add_f32 v252, 1.0, v252
    v_add_f32 v253, 1.0, v253
    v_add_f32 v254, 1.0, v254
    v_add_f32 v255, 1.0, v255
    v_rcp_f32 v248, v248
    v_mfma_f32_32x32x16_bf16 v[64:79], v[188:191], a[188:191], v[64:79]
    s_waitcnt lgkmcnt(4)
    ds_read_b64_tr_b16 v[188:189], v11 offset:12288
    ds_read_b64_tr_b16 v[190:191], v11 offset:12544
    buffer_load_dwordx4 v2, s[16:19], s60 offen lds
    buffer_atomic_add_f32 v82, v14, s[24:27], s62 offen offset:512
    v_rcp_f32 v249, v249
    v_mfma_f32_16x16x32_bf16 v[236:239], v[232:235], v[176:179], v[236:239]
    buffer_atomic_add_f32 v83, v14, s[24:27], s62 offen offset:768
    v_mfma_f32_32x32x16_bf16 v[48:63], v[176:179], a[48:51], v[48:63]
    s_mul_i32 s60, s100, 589824
    buffer_atomic_add_f32 v204, v15, s[24:27], s62 offen offset:0
    v_rcp_f32 v250, v250
    v_rcp_f32 v251, v251
    v_mfma_f32_32x32x16_bf16 v[64:79], v[176:179], a[192:195], v[64:79]
    s_waitcnt lgkmcnt(4)
    ds_read_b64_tr_b16 v[176:177], v8 offset:16384
    ds_read_b64_tr_b16 v[178:179], v8 offset:16640
    s_add_u32 m0, s44, 86048
    buffer_atomic_add_f32 v205, v15, s[24:27], s62 offen offset:256
    v_mul_f32 v97, v97, v107
    v_mfma_f32_32x32x16_bf16 v[48:63], v[180:183], a[52:55], v[48:63]
    s_add_u32 s60, s60, s49
    v_rcp_f32 v252, v252
    v_rcp_f32 v253, v253
    v_rcp_f32 v254, v254
    v_rcp_f32 v255, v255
    v_mfma_f32_32x32x16_bf16 v[64:79], v[180:183], a[196:199], v[64:79]
    s_waitcnt lgkmcnt(4)
    ds_read_b64_tr_b16 v[180:181], v9 offset:16384
    ds_read_b64_tr_b16 v[182:183], v9 offset:16640
    buffer_load_dwordx4 v2, s[12:15], s60 offen lds
    s_add_u32 s40, s39, s81
    v_mul_f32 v98, v98, v107
    v_mul_f32 v99, v99, v107
    v_mfma_f32_32x32x16_bf16 v[48:63], v[184:187], a[56:59], v[48:63]
    s_add_u32 m0, s44, 122944
    s_add_u32 s40, s40, 16384
    v_mov_b32 v12, s58
    s_add_u32 s61, s52, 0
    v_mul_f32 v100, v100, v107
    v_mul_f32 v112, v112, v248
    v_mul_f32 v101, v101, v107
    v_mfma_f32_32x32x16_bf16 v[64:79], v[184:187], a[200:203], v[64:79]
    s_waitcnt lgkmcnt(4)
    ds_read_b64_tr_b16 v[184:185], v10 offset:16384
    ds_read_b64_tr_b16 v[186:187], v10 offset:16640
    s_add_u32 s100, s100, 1
    s_cmp_eq_u32 s100, 9
    s_cselect_b32 s100, 0, s100
    v_mov_b32 v13, s59
    buffer_store_dwordx2 v[12:13], v0, s[32:35], s40 offen sc1
    v_mfma_f32_32x32x16_bf16 v[48:63], v[188:191], a[60:63], v[48:63]
    v_mul_f32 v113, v113, v249
    v_mul_f32 v114, v114, v250
    v_mul_f32 v102, v102, v107
    v_mul_f32 v115, v115, v251
    v_mul_f32 v103, v103, v107
    v_mul_f32 v104, v104, v107
    v_mfma_f32_32x32x16_bf16 v[64:79], v[188:191], a[204:207], v[64:79]
    s_waitcnt lgkmcnt(4)
    ds_read_b64_tr_b16 v[188:189], v11 offset:16384
    ds_read_b64_tr_b16 v[190:191], v11 offset:16640
    v_mul_f32 v116, v116, v252
    v_mul_f32 v117, v117, v253
    v_cvt_pk_bf16_f32 v192, v192, v193
    v_cvt_pk_bf16_f32 v193, v194, v195
    v_mfma_f32_16x16x32_bf16 v[236:239], v[232:235], v[176:179], v[236:239]
    buffer_load_dwordx4 v2, s[16:19], s60 offen lds
    v_mfma_f32_32x32x16_bf16 v[48:63], v[176:179], a[64:67], v[48:63]
    v_mul_f32 v118, v118, v254
    v_mul_f32 v119, v119, v255
    v_cvt_pk_bf16_f32 v194, v196, v197
    v_cvt_pk_bf16_f32 v120, v112, v113
    v_cvt_pk_bf16_f32 v195, v198, v199
    v_cvt_pk_bf16_f32 v196, v200, v96
    v_mfma_f32_32x32x16_bf16 v[64:79], v[176:179], a[208:211], v[64:79]
    s_waitcnt lgkmcnt(4)
    ds_read_b64_tr_b16 v[176:177], v8 offset:20480
    ds_read_b64_tr_b16 v[178:179], v8 offset:20736
    s_mul_i32 s60, s100, 589824
    v_cvt_pk_bf16_f32 v121, v114, v115
    v_cvt_pk_bf16_f32 v122, v116, v117
    v_mfma_f32_32x32x16_bf16 v[48:63], v[180:183], a[68:71], v[48:63]
    s_add_u32 m0, s44, 90144
    v_cvt_pk_bf16_f32 v197, v97, v98
    v_cvt_pk_bf16_f32 v123, v118, v119
    v_cvt_pk_bf16_f32 v198, v99, v100
    buffer_store_dwordx4 v[120:123], v3, s[20:23], s61 offen sc1
    v_mul_f32 v248, v231, v128
    v_mfma_f32_32x32x16_bf16 v[64:79], v[180:183], a[212:215], v[64:79]
    s_waitcnt lgkmcnt(4)
    ds_read_b64_tr_b16 v[180:181], v9 offset:20480
    ds_read_b64_tr_b16 v[182:183], v9 offset:20736
    s_add_u32 s60, s60, s49
    v_cvt_pk_bf16_f32 v199, v101, v102
    v_cvt_pk_bf16_f32 v200, v103, v104
    v_mfma_f32_32x32x16_bf16 v[48:63], v[184:187], a[72:75], v[48:63]
    buffer_load_dwordx4 v2, s[12:15], s60 offen lds
    v_mov_b32 v201, 0
    v_mul_f32 v249, v231, v129
    v_mov_b32 v202, 0
    v_mov_b32 v203, 0
    v_mfma_f32_32x32x16_bf16 v[64:79], v[184:187], a[216:219], v[64:79]
    s_waitcnt lgkmcnt(4)
    ds_read_b64_tr_b16 v[184:185], v10 offset:20480
    ds_read_b64_tr_b16 v[186:187], v10 offset:20736
    v_mul_f32 v250, v231, v130
    v_mul_f32 v251, v231, v131
    v_max3_f32 v106, v208, v209, v210
    v_max3_f32 v107, -v208, -v209, -v210
    v_mfma_f32_32x32x16_bf16 v[48:63], v[188:191], a[76:79], v[48:63]
    s_add_u32 m0, s44, 127040
    v_mul_f32 v252, v231, v132
    v_mul_f32 v253, v231, v133
    v_max3_f32 v109, v211, v212, v213
    v_max3_f32 v110, -v211, -v212, -v213
    v_mul_f32 v254, v231, v134
    v_max3_f32 v108, v214, v215, v216
    v_mfma_f32_32x32x16_bf16 v[64:79], v[188:191], a[220:223], v[64:79]
    s_waitcnt lgkmcnt(4)
    ds_read_b64_tr_b16 v[188:189], v11 offset:20480
    ds_read_b64_tr_b16 v[190:191], v11 offset:20736
    s_add_u32 s100, s100, 1
    s_cmp_eq_u32 s100, 9
    s_cselect_b32 s100, 0, s100
    v_mul_f32 v255, v231, v135
    v_mfma_f32_16x16x32_bf16 v[236:239], v[232:235], v[176:179], v[236:239]
    v_exp_f32 v248, v248
    v_mfma_f32_32x32x16_bf16 v[48:63], v[176:179], a[80:83], v[48:63]
    v_max3_f32 v111, -v214, -v215, -v216
    v_max3_f32 v106, v106, v109, v108
    v_exp_f32 v249, v249
    v_max3_f32 v107, v107, v110, v111
    v_mfma_f32_32x32x16_bf16 v[64:79], v[176:179], a[224:227], v[64:79]
    s_waitcnt lgkmcnt(4)
    ds_read_b64_tr_b16 v[176:177], v8 offset:24576
    ds_read_b64_tr_b16 v[178:179], v8 offset:24832
    buffer_load_dwordx4 v2, s[16:19], s60 offen lds
    v_permlane32_swap_b32 v106, v107
    v_mfma_f32_32x32x16_bf16 v[48:63], v[180:183], a[84:87], v[48:63]
    v_exp_f32 v250, v250
    v_max_f32 v106, v106, v107
    v_exp_f32 v251, v251
    v_mul_f32 v106, v231, v106
    v_mfma_f32_32x32x16_bf16 v[64:79], v[180:183], a[228:231], v[64:79]
    s_waitcnt lgkmcnt(4)
    ds_read_b64_tr_b16 v[180:181], v9 offset:24576
    ds_read_b64_tr_b16 v[182:183], v9 offset:24832
    s_mul_i32 s60, s100, 589824
    v_mov_b32 v107, v106
    v_exp_f32 v252, v252
    v_mfma_f32_32x32x16_bf16 v[48:63], v[184:187], a[88:91], v[48:63]
    s_add_u32 m0, s44, 94240
    v_permlane32_swap_b32 v106, v107
    v_fma_f32 v96, v208, v231, v107
    v_exp_f32 v253, v253
    v_fma_f32 v97, v209, v231, v107
    v_mfma_f32_32x32x16_bf16 v[64:79], v[184:187], a[232:235], v[64:79]
    s_waitcnt lgkmcnt(4)
    ds_read_b64_tr_b16 v[184:185], v10 offset:24576
    ds_read_b64_tr_b16 v[186:187], v10 offset:24832
    s_add_u32 s60, s60, s49
    v_fma_f32 v98, v210, v231, v107
    v_exp_f32 v254, v254
    v_mfma_f32_32x32x16_bf16 v[48:63], v[188:191], a[92:95], v[48:63]
    buffer_load_dwordx4 v2, s[12:15], s60 offen lds
    v_fma_f32 v99, v211, v231, v107
    v_fma_f32 v100, v212, v231, v107
    v_exp_f32 v255, v255
    v_mfma_f32_32x32x16_bf16 v[64:79], v[188:191], a[236:239], v[64:79]
    s_waitcnt lgkmcnt(4)
    ds_read_b64_tr_b16 v[188:189], v11 offset:24576
    ds_read_b64_tr_b16 v[190:191], v11 offset:24832
    v_fma_f32 v101, v213, v231, v107
    v_fma_f32 v102, v214, v231, v107
    v_fma_f32 v103, v215, v231, v107
    v_mul_f32 v128, v128, v136
    v_mfma_f32_16x16x32_bf16 v[236:239], v[232:235], v[176:179], v[236:239]
    s_add_u32 m0, s44, 131136
    v_mul_f32 v129, v129, v137
    v_mul_f32 v130, v130, v138
    v_mfma_f32_32x32x16_bf16 v[48:63], v[176:179], a[96:99], v[48:63]
    s_add_u32 s100, s100, 1
    s_cmp_eq_u32 s100, 9
    s_cselect_b32 s100, 0, s100
    v_fma_f32 v104, v216, v231, v107
    v_fma_f32 v208, -v208, v231, v106
    v_mul_f32 v131, v131, v139
    v_mfma_f32_32x32x16_bf16 v[64:79], v[176:179], a[240:243], v[64:79]
    s_waitcnt lgkmcnt(4)
    ds_read_b64_tr_b16 v[176:177], v8 offset:28672
    ds_read_b64_tr_b16 v[178:179], v8 offset:28928
    v_mul_f32 v132, v132, v140
    v_fma_f32 v209, -v209, v231, v106
    v_fma_f32 v210, -v210, v231, v106
    v_mul_f32 v133, v133, v141
    v_mfma_f32_32x32x16_bf16 v[48:63], v[180:183], a[100:103], v[48:63]
    buffer_load_dwordx4 v2, s[16:19], s60 offen lds
    v_mul_f32 v134, v134, v142
    v_fma_f32 v211, -v211, v231, v106
    v_fma_f32 v212, -v212, v231, v106
    v_fma_f32 v213, -v213, v231, v106
    v_mfma_f32_32x32x16_bf16 v[64:79], v[180:183], a[244:247], v[64:79]
    s_waitcnt lgkmcnt(4)
    ds_read_b64_tr_b16 v[180:181], v9 offset:28672
    ds_read_b64_tr_b16 v[182:183], v9 offset:28928
    v_mul_f32 v135, v135, v143
    v_add_f32 v248, 1.0, v248
    v_fma_f32 v214, -v214, v231, v106
    v_fma_f32 v215, -v215, v231, v106
    v_mfma_f32_32x32x16_bf16 v[48:63], v[184:187], a[104:107], v[48:63]
    s_mul_i32 s60, s100, 589824
    v_add_f32 v249, 1.0, v249
    v_add_f32 v250, 1.0, v250
    v_fma_f32 v216, -v216, v231, v106
    v_exp_f32 v96, v96
    v_add_f32 v251, 1.0, v251
    v_mfma_f32_32x32x16_bf16 v[64:79], v[184:187], a[248:251], v[64:79]
    s_waitcnt lgkmcnt(4)
    ds_read_b64_tr_b16 v[184:185], v10 offset:28672
    ds_read_b64_tr_b16 v[186:187], v10 offset:28928
    s_add_u32 m0, s44, 98336
    v_add_f32 v252, 1.0, v252
    v_exp_f32 v97, v97
    v_mfma_f32_32x32x16_bf16 v[48:63], v[188:191], a[108:111], v[48:63]
    s_add_u32 s60, s60, s49
    v_add_f32 v253, 1.0, v253
    v_add_f32 v254, 1.0, v254
    v_exp_f32 v98, v98
    v_add_f32 v255, 1.0, v255
    v_mfma_f32_32x32x16_bf16 v[64:79], v[188:191], a[252:255], v[64:79]
    s_waitcnt lgkmcnt(4)
    ds_read_b64_tr_b16 v[188:189], v11 offset:28672
    ds_read_b64_tr_b16 v[190:191], v11 offset:28928
    buffer_load_dwordx4 v2, s[12:15], s60 offen lds
    v_rcp_f32 v248, v248
    v_mfma_f32_16x16x32_bf16 v[236:239], v[232:235], v[176:179], v[236:239]
    s_lshl_b32 s40, s38, 5
    v_exp_f32 v99, v99
    v_mfma_f32_32x32x16_bf16 v[48:63], v[176:179], a[112:115], v[48:63]
    s_add_u32 m0, s44, 135232
    v_rcp_f32 v249, v249
    v_exp_f32 v100, v100
    v_exp_f32 v101, v101
    v_mfma_f32_32x32x16_bf16 v[64:79], v[176:179], v[16:19], v[64:79]
    s_waitcnt lgkmcnt(4)
    ds_read_b64_tr_b16 v[176:177], v8 offset:32768
    ds_read_b64_tr_b16 v[178:179], v8 offset:33024
    s_add_u32 s100, s100, 1
    s_cmp_eq_u32 s100, 9
    s_cselect_b32 s100, 0, s100
    s_add_u32 s40, s40, s63
    v_mfma_f32_32x32x16_bf16 v[48:63], v[180:183], a[116:119], v[48:63]
    s_lshl_b32 s40, s40, 3
    v_rcp_f32 v250, v250
    v_rcp_f32 v251, v251
    v_exp_f32 v102, v102
    v_mfma_f32_32x32x16_bf16 v[64:79], v[180:183], v[20:23], v[64:79]
    s_waitcnt lgkmcnt(4)
    ds_read_b64_tr_b16 v[180:181], v9 offset:32768
    ds_read_b64_tr_b16 v[182:183], v9 offset:33024
    v_rcp_f32 v252, v252
    v_exp_f32 v103, v103
    v_mfma_f32_32x32x16_bf16 v[48:63], v[184:187], a[120:123], v[48:63]
    s_add_u32 s40, s40, 8192
    buffer_load_dwordx4 v2, s[16:19], s60 offen lds
    v_rcp_f32 v253, v253
    v_exp_f32 v104, v104
    v_mfma_f32_32x32x16_bf16 v[64:79], v[184:187], v[24:27], v[64:79]
    s_waitcnt lgkmcnt(4)
    ds_read_b64_tr_b16 v[184:185], v10 offset:32768
    ds_read_b64_tr_b16 v[186:187], v10 offset:33024
    v_rcp_f32 v254, v254
    v_exp_f32 v208, v208
    v_mfma_f32_32x32x16_bf16 v[48:63], v[188:191], a[124:127], v[48:63]
    s_mul_i32 s60, s100, 589824
    v_exp_f32 v209, v209
    v_rcp_f32 v255, v255
    v_exp_f32 v210, v210
    v_mfma_f32_32x32x16_bf16 v[64:79], v[188:191], v[28:31], v[64:79]
    s_waitcnt lgkmcnt(4)
    ds_read_b64_tr_b16 v[188:189], v11 offset:32768
    ds_read_b64_tr_b16 v[190:191], v11 offset:33024
    s_add_u32 m0, s44, 102432
    s_add_u32 s61, s52, 294912
    v_exp_f32 v211, v211
    v_mfma_f32_16x16x32_bf16 v[236:239], v[232:235], v[176:179], v[236:239]
    s_add_u32 s60, s60, s49
    v_mul_f32 v128, v128, v248
    v_mul_f32 v129, v129, v249
    v_mfma_f32_32x32x16_bf16 v[48:63], v[176:179], a[128:131], v[48:63]
    s_waitcnt vmcnt(10)
    buffer_load_dwordx4 v2, s[12:15], s60 offen lds
    v_mul_f32 v130, v130, v250
    v_exp_f32 v212, v212
    v_mul_f32 v131, v131, v251
    v_mfma_f32_32x32x16_bf16 v[64:79], v[176:179], v[32:35], v[64:79]
    s_waitcnt lgkmcnt(4)
    ds_read_b64_tr_b16 v[176:177], v8 offset:32
    ds_read_b64_tr_b16 v[178:179], v8 offset:288
    v_exp_f32 v213, v213
    v_mul_f32 v132, v132, v252
    v_mul_f32 v133, v133, v253
    v_mfma_f32_32x32x16_bf16 v[48:63], v[180:183], a[132:135], v[48:63]
    s_add_u32 m0, s44, 139328
    v_exp_f32 v214, v214
    v_exp_f32 v215, v215
    v_mul_f32 v134, v134, v254
    v_mov_b32 v12, s58
    v_mfma_f32_32x32x16_bf16 v[64:79], v[180:183], v[36:39], v[64:79]
    s_waitcnt lgkmcnt(4)
    ds_read_b64_tr_b16 v[180:181], v9 offset:32
    ds_read_b64_tr_b16 v[182:183], v9 offset:288
    s_add_u32 s100, s100, 1
    s_cmp_eq_u32 s100, 9
    s_cselect_b32 s100, 0, s100
    v_mul_f32 v135, v135, v255
    v_mfma_f32_32x32x16_bf16 v[48:63], v[184:187], a[136:139], v[48:63]
    v_cvt_pk_bf16_f32 v136, v128, v129
    v_mov_b32 v13, s59
    buffer_store_dwordx2 v[12:13], v0, s[32:35], s40 offen sc1
    v_cvt_pk_bf16_f32 v137, v130, v131
    v_cvt_pk_bf16_f32 v138, v132, v133
    v_mfma_f32_32x32x16_bf16 v[64:79], v[184:187], v[40:43], v[64:79]
    s_waitcnt lgkmcnt(4)
    ds_read_b64_tr_b16 v[184:185], v10 offset:32
    ds_read_b64_tr_b16 v[186:187], v10 offset:288
    v_exp_f32 v216, v216
    s_lshl_b32 s40, s38, 8
    v_add_f32 v107, v96, v97
    v_mfma_f32_32x32x16_bf16 v[48:63], v[188:191], a[140:143], v[48:63]
    s_add_u32 s40, s40, 8192
    buffer_load_dwordx4 v2, s[16:19], s60 offen lds
    v_cvt_pk_bf16_f32 v139, v134, v135
    buffer_store_dwordx4 v[136:139], v3, s[20:23], s61 offen sc1
    ds_read_b32 v248, v245 offset:15424
    ds_read_b32 v249, v245 offset:15552
    ds_read_b32 v250, v245 offset:15680
    ds_read_b32 v251, v245 offset:15808
    v_mfma_f32_32x32x16_bf16 v[64:79], v[188:191], v[44:47], v[64:79]
    s_waitcnt lgkmcnt(8)
    ds_read_b64_tr_b16 v[188:189], v11 offset:32
    ds_read_b64_tr_b16 v[190:191], v11 offset:288
    s_mul_i32 s60, s100, 589824
    v_and_b32 v14, 31, v1
    v_lshl_add_u32 v14, v14, 3, s40
    v_lshlrev_b32 v15, 2, v1
    v_mfma_f32_16x16x32_bf16 v[240:243], v[232:235], v[176:179], 0
    s_add_u32 m0, s44, 106528
    v_add_f32 v110, v98, v99
    v_add_f32 v106, v208, v209
    v_mfma_f32_32x32x16_bf16 v[112:127], v[176:179], a[0:3], 0
    s_add_u32 s60, s60, s49
    v_add_f32 v109, v210, v211
    v_add_f32 v107, v107, v100
    v_add_f32 v110, v110, v101
    v_add_f32 v106, v106, v212
    v_add_f32 v109, v109, v213
    v_add_f32 v107, v107, v102
    v_mfma_f32_32x32x16_bf16 v[128:143], v[176:179], a[144:147], 0
    s_waitcnt lgkmcnt(8)
    ds_read_b64_tr_b16 v[176:177], v8 offset:4128
    ds_read_b64_tr_b16 v[178:179], v8 offset:4384
    buffer_load_dwordx4 v2, s[12:15], s60 offen lds
    s_waitcnt lgkmcnt(6)
    v_add_f32 v248, v248, v249
    s_waitcnt lgkmcnt(4)
    v_add_f32 v250, v250, v251
    v_add_f32 v248, v248, v250
    v_cvt_pk_bf16_f32 v249, v248, v248
    v_mfma_f32_32x32x16_bf16 v[112:127], v[180:183], a[4:7], v[112:127]
    v_lshlrev_b32 v249, 16, v249
    v_sub_f32 v249, v248, v249
    v_cvt_pk_bf16_f32 v224, v248, v249
    v_add_f32 v110, v110, v103
    v_add_f32 v106, v106, v214
    v_add_f32 v109, v109, v215
    v_mfma_f32_32x32x8_bf16 v[144:159], v[224:225], v[226:227], v[144:159]
    v_mfma_f32_32x32x16_bf16 v[128:143], v[180:183], a[148:151], v[128:143]
    ds_read_b64_tr_b16 v[180:181], v9 offset:4128
    ds_read_b64_tr_b16 v[182:183], v9 offset:4384
    s_add_u32 m0, s44, 143424
    v_mfma_f32_32x32x8_bf16 v[160:175], v[224:225], v[228:229], v[160:175]
    v_add_f32 v107, v107, v104
    v_mfma_f32_32x32x16_bf16 v[112:127], v[184:187], a[8:11], v[112:127]
    s_add_u32 s100, s100, 1
    s_cmp_eq_u32 s100, 9
    s_cselect_b32 s100, 0, s100
    s_mov_b64 exec, 0xffff
    ds_write_b64 v244, v[236:237] offset:14400
    s_mov_b64 exec, -1
    v_mfma_f32_32x32x16_bf16 v[128:143], v[184:187], a[152:155], v[128:143]
    s_waitcnt lgkmcnt(5)
    ds_read_b64_tr_b16 v[184:185], v10 offset:4128
    ds_read_b64_tr_b16 v[186:187], v10 offset:4384
    v_mul_f32 v248, v230, v144
    v_mul_f32 v249, v230, v145
    v_mul_f32 v250, v230, v146
    v_mul_f32 v251, v230, v147
    v_mul_f32 v252, v230, v148
    v_mfma_f32_32x32x16_bf16 v[112:127], v[188:191], a[12:15], v[112:127]
    v_mul_f32 v253, v230, v149
    v_mul_f32 v254, v230, v150
    v_mul_f32 v255, v230, v151
    v_exp_f32 v248, v248
    v_add_f32 v106, v106, v216
    v_exp_f32 v249, v249
    v_mfma_f32_32x32x16_bf16 v[128:143], v[188:191], a[156:159], v[128:143]
    s_waitcnt lgkmcnt(5)
    ds_read_b64_tr_b16 v[188:189], v11 offset:4128
    ds_read_b64_tr_b16 v[190:191], v11 offset:4384
    buffer_load_dwordx4 v2, s[16:19], s60 offen lds
    v_exp_f32 v250, v250
    v_exp_f32 v251, v251
    v_mfma_f32_16x16x32_bf16 v[240:243], v[232:235], v[176:179], v[240:243]
    v_exp_f32 v252, v252
    v_mfma_f32_32x32x16_bf16 v[112:127], v[176:179], a[16:19], v[112:127]
    v_exp_f32 v253, v253
    v_exp_f32 v254, v254
    v_exp_f32 v255, v255
    v_mul_f32 v144, v144, v152
    v_mfma_f32_32x32x16_bf16 v[128:143], v[176:179], a[160:163], v[128:143]
    s_waitcnt lgkmcnt(4)
    s_barrier
    ds_read_b64_tr_b16 v[176:177], v8 offset:8224
    ds_read_b64_tr_b16 v[178:179], v8 offset:8480
    v_mul_f32 v145, v145, v153
    v_mul_f32 v146, v146, v154
    v_mul_f32 v147, v147, v155
    v_mfma_f32_32x32x16_bf16 v[112:127], v[180:183], a[20:23], v[112:127]
    v_mul_f32 v148, v148, v156
    v_mul_f32 v149, v149, v157
    v_mul_f32 v150, v150, v158
    v_mul_f32 v151, v151, v159
    v_add_f32 v248, 1.0, v248
    v_add_f32 v249, 1.0, v249
    v_add_f32 v250, 1.0, v250
    v_mfma_f32_32x32x16_bf16 v[128:143], v[180:183], a[164:167], v[128:143]
    s_waitcnt lgkmcnt(4)
    ds_read_b64_tr_b16 v[180:181], v9 offset:8224
    ds_read_b64_tr_b16 v[182:183], v9 offset:8480
    v_add_f32 v251, 1.0, v251
    v_add_f32 v252, 1.0, v252
    v_add_f32 v253, 1.0, v253
    v_add_f32 v254, 1.0, v254
    v_add_f32 v255, 1.0, v255
    v_rcp_f32 v248, v248
    v_mfma_f32_32x32x16_bf16 v[112:127], v[184:187], a[24:27], v[112:127]
    v_rcp_f32 v249, v249
    v_rcp_f32 v250, v250
    v_rcp_f32 v251, v251
    v_rcp_f32 v252, v252
    v_mfma_f32_32x32x16_bf16 v[128:143], v[184:187], a[168:171], v[128:143]
    s_waitcnt lgkmcnt(4)
    ds_read_b64_tr_b16 v[184:185], v10 offset:8224
    ds_read_b64_tr_b16 v[186:187], v10 offset:8480
    v_rcp_f32 v253, v253
    v_rcp_f32 v254, v254
    v_rcp_f32 v255, v255
    v_mfma_f32_32x32x16_bf16 v[112:127], v[188:191], a[28:31], v[112:127]
    s_add_u32 s61, s52, 512
    v_mul_f32 v144, v144, v248
    v_mul_f32 v145, v145, v249
    v_mul_f32 v146, v146, v250
    v_add_f32 v107, v107, v110
    v_mul_f32 v147, v147, v251
    v_mul_f32 v148, v148, v252
    v_add_f32 v106, v106, v109
    v_mfma_f32_32x32x16_bf16 v[128:143], v[188:191], a[172:175], v[128:143]
    s_waitcnt lgkmcnt(4)
    ds_read_b64_tr_b16 v[188:189], v11 offset:8224
    ds_read_b64_tr_b16 v[190:191], v11 offset:8480
    v_permlane32_swap_b32 v106, v107
    v_mul_f32 v149, v149, v253
    v_mul_f32 v150, v150, v254
    v_mul_f32 v151, v151, v255
    v_add_f32 v106, v106, v107
    v_mfma_f32_16x16x32_bf16 v[240:243], v[232:235], v[176:179], v[240:243]
    v_rcp_f32 v106, v106
    v_mfma_f32_32x32x16_bf16 v[112:127], v[176:179], a[32:35], v[112:127]
    v_mov_b32 v107, v106
    v_cvt_pk_bf16_f32 v152, v144, v145
    v_cvt_pk_bf16_f32 v153, v146, v147
    v_permlane32_swap_b32 v106, v107
    v_cvt_pk_bf16_f32 v154, v148, v149
    v_cvt_pk_bf16_f32 v155, v150, v151
    buffer_store_dwordx4 v[152:155], v3, s[20:23], s61 offen sc1
    v_mfma_f32_32x32x16_bf16 v[128:143], v[176:179], a[176:179], v[128:143]
    s_waitcnt lgkmcnt(4)
    ds_read_b64_tr_b16 v[176:177], v8 offset:12320
    ds_read_b64_tr_b16 v[178:179], v8 offset:12576
    v_mul_f32 v208, v208, v106
    v_mul_f32 v209, v209, v106
    v_mul_f32 v248, v231, v160
    v_mul_f32 v249, v231, v161
    v_mul_f32 v210, v210, v106
    v_mfma_f32_32x32x16_bf16 v[112:127], v[180:183], a[36:39], v[112:127]
    v_mul_f32 v211, v211, v106
    v_mul_f32 v212, v212, v106
    v_mul_f32 v250, v231, v162
    v_mul_f32 v251, v231, v163
    v_mul_f32 v252, v231, v164
    v_mul_f32 v213, v213, v106
    v_mul_f32 v253, v231, v165
    v_mfma_f32_32x32x16_bf16 v[128:143], v[180:183], a[180:183], v[128:143]
    s_waitcnt lgkmcnt(4)
    ds_read_b64_tr_b16 v[180:181], v9 offset:12320
    ds_read_b64_tr_b16 v[182:183], v9 offset:12576
    v_mul_f32 v214, v214, v106
    v_mul_f32 v215, v215, v106
    v_mul_f32 v254, v231, v166
    v_mul_f32 v255, v231, v167
    v_mul_f32 v216, v216, v106
    v_mfma_f32_32x32x16_bf16 v[112:127], v[184:187], a[40:43], v[112:127]
    v_mul_f32 v96, v96, v107
    v_exp_f32 v248, v248
    v_mul_f32 v97, v97, v107
    v_exp_f32 v249, v249
    v_mul_f32 v98, v98, v107
    v_mfma_f32_32x32x16_bf16 v[128:143], v[184:187], a[184:187], v[128:143]
    s_waitcnt lgkmcnt(4)
    ds_read_b64_tr_b16 v[184:185], v10 offset:12320
    ds_read_b64_tr_b16 v[186:187], v10 offset:12576
    v_mul_f32 v99, v99, v107
    v_mul_f32 v100, v100, v107
    v_exp_f32 v250, v250
    v_exp_f32 v251, v251
    v_mfma_f32_32x32x16_bf16 v[112:127], v[188:191], a[44:47], v[112:127]
    v_mul_f32 v101, v101, v107
    v_mul_f32 v102, v102, v107
    v_mul_f32 v103, v103, v107
    v_exp_f32 v252, v252
    v_mul_f32 v104, v104, v107
    v_exp_f32 v253, v253
    v_mfma_f32_32x32x16_bf16 v[128:143], v[188:191], a[188:191], v[128:143]
    s_waitcnt lgkmcnt(4)
    ds_read_b64_tr_b16 v[188:189], v11 offset:12320
    ds_read_b64_tr_b16 v[190:191], v11 offset:12576
    v_cvt_pk_bf16_f32 v208, v208, v209
    v_cvt_pk_bf16_f32 v209, v210, v211
    v_exp_f32 v254, v254
    v_exp_f32 v255, v255
    v_mfma_f32_16x16x32_bf16 v[240:243], v[232:235], v[176:179], v[240:243]
    v_cvt_pk_bf16_f32 v210, v212, v213
    v_cvt_pk_bf16_f32 v211, v214, v215
    v_mfma_f32_32x32x16_bf16 v[112:127], v[176:179], a[48:51], v[112:127]
    v_cvt_pk_bf16_f32 v212, v216, v96
    v_cvt_pk_bf16_f32 v213, v97, v98
    v_cvt_pk_bf16_f32 v214, v99, v100
    v_mul_f32 v160, v160, v168
    v_mul_f32 v161, v161, v169
    v_mul_f32 v162, v162, v170
    v_mul_f32 v163, v163, v171
    v_mfma_f32_32x32x16_bf16 v[128:143], v[176:179], a[192:195], v[128:143]
    s_waitcnt lgkmcnt(4)
    ds_read_b64_tr_b16 v[176:177], v8 offset:16416
    ds_read_b64_tr_b16 v[178:179], v8 offset:16672
    v_cvt_pk_bf16_f32 v215, v101, v102
    v_cvt_pk_bf16_f32 v216, v103, v104
    v_mov_b32 v217, 0
    v_mul_f32 v164, v164, v172
    v_mov_b32 v218, 0
    v_mov_b32 v219, 0
    v_mfma_f32_32x32x16_bf16 v[112:127], v[180:183], a[52:55], v[112:127]
    v_mul_f32 v165, v165, v173
    v_mul_f32 v166, v166, v174
    v_mul_f32 v167, v167, v175
    v_add_f32 v248, 1.0, v248
    v_add_f32 v249, 1.0, v249
    v_add_f32 v250, 1.0, v250
    v_mfma_f32_32x32x16_bf16 v[128:143], v[180:183], a[196:199], v[128:143]
    s_waitcnt lgkmcnt(4)
    ds_read_b64_tr_b16 v[180:181], v9 offset:16416
    ds_read_b64_tr_b16 v[182:183], v9 offset:16672
    v_add_f32 v251, 1.0, v251
    v_add_f32 v252, 1.0, v252
    v_add_f32 v253, 1.0, v253
    v_add_f32 v254, 1.0, v254
    v_mfma_f32_32x32x16_bf16 v[112:127], v[184:187], a[56:59], v[112:127]
    v_add_f32 v255, 1.0, v255
    v_rcp_f32 v248, v248
    v_rcp_f32 v249, v249
    v_mfma_f32_32x32x16_bf16 v[128:143], v[184:187], a[200:203], v[128:143]
    s_waitcnt lgkmcnt(4)
    ds_read_b64_tr_b16 v[184:185], v10 offset:16416
    ds_read_b64_tr_b16 v[186:187], v10 offset:16672
    v_rcp_f32 v250, v250
    v_rcp_f32 v251, v251
    v_mfma_f32_32x32x16_bf16 v[112:127], v[188:191], a[60:63], v[112:127]
    v_rcp_f32 v252, v252
    v_rcp_f32 v253, v253
    v_rcp_f32 v254, v254
    v_mfma_f32_32x32x16_bf16 v[128:143], v[188:191], a[204:207], v[128:143]
    s_waitcnt lgkmcnt(4)
    ds_read_b64_tr_b16 v[188:189], v11 offset:16416
    ds_read_b64_tr_b16 v[190:191], v11 offset:16672
    v_rcp_f32 v255, v255
    s_add_u32 s61, s52, 295424
    v_mul_f32 v160, v160, v248
    v_mfma_f32_16x16x32_bf16 v[240:243], v[232:235], v[176:179], v[240:243]
    v_mul_f32 v161, v161, v249
    v_mul_f32 v162, v162, v250
    v_mfma_f32_32x32x16_bf16 v[112:127], v[176:179], a[64:67], v[112:127]
    v_mul_f32 v163, v163, v251
    v_mul_f32 v164, v164, v252
    v_mul_f32 v165, v165, v253
    v_mul_f32 v166, v166, v254
    v_mul_f32 v167, v167, v255
    v_cvt_pk_bf16_f32 v168, v160, v161
    v_mfma_f32_32x32x16_bf16 v[128:143], v[176:179], a[208:211], v[128:143]
    s_waitcnt lgkmcnt(4)
    ds_read_b64_tr_b16 v[176:177], v8 offset:20512
    ds_read_b64_tr_b16 v[178:179], v8 offset:20768
    v_cvt_pk_bf16_f32 v169, v162, v163
    v_cvt_pk_bf16_f32 v170, v164, v165
    v_cvt_pk_bf16_f32 v171, v166, v167
    v_mfma_f32_32x32x16_bf16 v[112:127], v[180:183], a[68:71], v[112:127]
    buffer_store_dwordx4 v[168:171], v3, s[20:23], s61 offen sc1
    ds_read_b32 v248, v245 offset:14400
    ds_read_b32 v249, v245 offset:14528
    ds_read_b32 v250, v245 offset:14656
    ds_read_b32 v251, v245 offset:14784
    v_mfma_f32_32x32x16_bf16 v[128:143], v[180:183], a[212:215], v[128:143]
    s_waitcnt lgkmcnt(8)
    ds_read_b64_tr_b16 v[180:181], v9 offset:20512
    ds_read_b64_tr_b16 v[182:183], v9 offset:20768
    buffer_load_dwordx2 v[12:13], v14, s[32:35], 0 offen sc1
    v_mfma_f32_32x32x16_bf16 v[112:127], v[184:187], a[72:75], v[112:127]
    v_mfma_f32_32x32x16_bf16 v[128:143], v[184:187], a[216:219], v[128:143]
    s_waitcnt lgkmcnt(8)
    ds_read_b64_tr_b16 v[184:185], v10 offset:20512
    ds_read_b64_tr_b16 v[186:187], v10 offset:20768
    v_mfma_f32_32x32x16_bf16 v[112:127], v[188:191], a[76:79], v[112:127]
    s_waitcnt lgkmcnt(6)
    v_add_f32 v248, v248, v249
    s_waitcnt lgkmcnt(4)
    v_add_f32 v250, v250, v251
    v_add_f32 v248, v248, v250
    v_cvt_pk_bf16_f32 v249, v248, v248
    v_lshlrev_b32 v249, 16, v249
    v_sub_f32 v249, v248, v249
    v_mfma_f32_32x32x16_bf16 v[128:143], v[188:191], a[220:223], v[128:143]
    ds_read_b64_tr_b16 v[188:189], v11 offset:20512
    ds_read_b64_tr_b16 v[190:191], v11 offset:20768
    v_cvt_pk_bf16_f32 v224, v248, v249
    v_mfma_f32_16x16x32_bf16 v[240:243], v[232:235], v[176:179], v[240:243]
    v_mfma_f32_32x32x16_bf16 v[112:127], v[176:179], a[80:83], v[112:127]
    v_mfma_f32_32x32x8_bf16 v[48:63], v[224:225], v[226:227], v[48:63]
    v_mfma_f32_32x32x8_bf16 v[64:79], v[224:225], v[228:229], v[64:79]
    v_mfma_f32_32x32x16_bf16 v[128:143], v[176:179], a[224:227], v[128:143]
    s_waitcnt lgkmcnt(4)
    ds_read_b64_tr_b16 v[176:177], v8 offset:24608
    ds_read_b64_tr_b16 v[178:179], v8 offset:24864
    v_mfma_f32_32x32x16_bf16 v[112:127], v[180:183], a[84:87], v[112:127]
    v_mfma_f32_32x32x16_bf16 v[128:143], v[180:183], a[228:231], v[128:143]
    s_waitcnt lgkmcnt(4)
    ds_read_b64_tr_b16 v[180:181], v9 offset:24608
    ds_read_b64_tr_b16 v[182:183], v9 offset:24864
    v_mfma_f32_32x32x16_bf16 v[112:127], v[184:187], a[88:91], v[112:127]
    v_mfma_f32_32x32x16_bf16 v[128:143], v[184:187], a[232:235], v[128:143]
    s_waitcnt lgkmcnt(4)
    ds_read_b64_tr_b16 v[184:185], v10 offset:24608
    ds_read_b64_tr_b16 v[186:187], v10 offset:24864
    v_mul_f32 v248, v230, v48
    v_mul_f32 v249, v230, v49
    v_mul_f32 v250, v230, v50
    v_mul_f32 v251, v230, v51
    v_mfma_f32_32x32x16_bf16 v[112:127], v[188:191], a[92:95], v[112:127]
    v_mul_f32 v252, v230, v52
    v_mul_f32 v253, v230, v53
    v_mul_f32 v254, v230, v54
    v_mul_f32 v255, v230, v55
    v_exp_f32 v248, v248
    v_mfma_f32_32x32x16_bf16 v[128:143], v[188:191], a[236:239], v[128:143]
    s_waitcnt lgkmcnt(4)
    ds_read_b64_tr_b16 v[188:189], v11 offset:24608
    ds_read_b64_tr_b16 v[190:191], v11 offset:24864
    v_exp_f32 v249, v249
    v_exp_f32 v250, v250
    v_mfma_f32_16x16x32_bf16 v[240:243], v[232:235], v[176:179], v[240:243]
    v_exp_f32 v251, v251
    v_mfma_f32_32x32x16_bf16 v[112:127], v[176:179], a[96:99], v[112:127]
    v_exp_f32 v252, v252
    v_exp_f32 v253, v253
    v_exp_f32 v254, v254
    v_mfma_f32_32x32x16_bf16 v[128:143], v[176:179], a[240:243], v[128:143]
    s_waitcnt lgkmcnt(4)
    ds_read_b64_tr_b16 v[176:177], v8 offset:28704
    ds_read_b64_tr_b16 v[178:179], v8 offset:28960
    v_exp_f32 v255, v255
    v_mul_f32 v48, v48, v56
    v_mul_f32 v49, v49, v57
    v_mfma_f32_32x32x16_bf16 v[112:127], v[180:183], a[100:103], v[112:127]
    v_mul_f32 v50, v50, v58
    v_mul_f32 v51, v51, v59
    v_mul_f32 v52, v52, v60
    v_mul_f32 v53, v53, v61
    v_mul_f32 v54, v54, v62
    v_mul_f32 v55, v55, v63
    v_mfma_f32_32x32x16_bf16 v[128:143], v[180:183], a[244:247], v[128:143]
    s_waitcnt lgkmcnt(4)
    ds_read_b64_tr_b16 v[180:181], v9 offset:28704
    ds_read_b64_tr_b16 v[182:183], v9 offset:28960
    v_add_f32 v248, 1.0, v248
    v_add_f32 v249, 1.0, v249
    v_add_f32 v250, 1.0, v250
    v_add_f32 v251, 1.0, v251
    v_mfma_f32_32x32x16_bf16 v[112:127], v[184:187], a[104:107], v[112:127]
    v_add_f32 v252, 1.0, v252
    v_add_f32 v253, 1.0, v253
    v_add_f32 v254, 1.0, v254
    v_add_f32 v255, 1.0, v255
    v_rcp_f32 v248, v248
    v_mfma_f32_32x32x16_bf16 v[128:143], v[184:187], a[248:251], v[128:143]
    s_waitcnt lgkmcnt(4)
    ds_read_b64_tr_b16 v[184:185], v10 offset:28704
    ds_read_b64_tr_b16 v[186:187], v10 offset:28960
    v_rcp_f32 v249, v249
    v_rcp_f32 v250, v250
    v_mfma_f32_32x32x16_bf16 v[112:127], v[188:191], a[108:111], v[112:127]
    v_rcp_f32 v251, v251
    v_rcp_f32 v252, v252
    v_rcp_f32 v253, v253
    v_mfma_f32_32x32x16_bf16 v[128:143], v[188:191], a[252:255], v[128:143]
    s_waitcnt lgkmcnt(4)
    ds_read_b64_tr_b16 v[188:189], v11 offset:28704
    ds_read_b64_tr_b16 v[190:191], v11 offset:28960
    v_rcp_f32 v254, v254
    v_rcp_f32 v255, v255
    v_mfma_f32_16x16x32_bf16 v[240:243], v[232:235], v[176:179], v[240:243]
    s_add_u32 s61, s53, 0
    v_mul_f32 v48, v48, v248
    v_mul_f32 v49, v49, v249
    v_mfma_f32_32x32x16_bf16 v[112:127], v[176:179], a[112:115], v[112:127]
    v_mul_f32 v50, v50, v250
    v_mul_f32 v51, v51, v251
    v_mul_f32 v52, v52, v252
    v_mul_f32 v53, v53, v253
    v_mul_f32 v54, v54, v254
    v_mul_f32 v55, v55, v255
    v_mfma_f32_32x32x16_bf16 v[128:143], v[176:179], v[16:19], v[128:143]
    s_waitcnt lgkmcnt(4)
    ds_read_b64_tr_b16 v[176:177], v8 offset:32800
    ds_read_b64_tr_b16 v[178:179], v8 offset:33056
    v_cvt_pk_bf16_f32 v56, v48, v49
    v_cvt_pk_bf16_f32 v57, v50, v51
    v_cvt_pk_bf16_f32 v58, v52, v53
    v_mfma_f32_32x32x16_bf16 v[112:127], v[180:183], a[116:119], v[112:127]
    v_cvt_pk_bf16_f32 v59, v54, v55
    buffer_store_dwordx4 v[56:59], v3, s[20:23], s61 offen sc1
    v_mul_f32 v248, v231, v64
    v_mul_f32 v249, v231, v65
    v_mul_f32 v250, v231, v66
    v_mfma_f32_32x32x16_bf16 v[128:143], v[180:183], v[20:23], v[128:143]
    s_waitcnt lgkmcnt(4)
    ds_read_b64_tr_b16 v[180:181], v9 offset:32800
    ds_read_b64_tr_b16 v[182:183], v9 offset:33056
    v_mul_f32 v251, v231, v67
    v_mul_f32 v252, v231, v68
    v_mul_f32 v253, v231, v69
    v_mul_f32 v254, v231, v70
    v_mfma_f32_32x32x16_bf16 v[112:127], v[184:187], a[120:123], v[112:127]
    v_mul_f32 v255, v231, v71
    v_exp_f32 v248, v248
    v_exp_f32 v249, v249
    v_mfma_f32_32x32x16_bf16 v[128:143], v[184:187], v[24:27], v[128:143]
    s_waitcnt lgkmcnt(4)
    ds_read_b64_tr_b16 v[184:185], v10 offset:32800
    ds_read_b64_tr_b16 v[186:187], v10 offset:33056
    v_exp_f32 v250, v250
    v_exp_f32 v251, v251
    v_mfma_f32_32x32x16_bf16 v[112:127], v[188:191], a[124:127], v[112:127]
    v_exp_f32 v252, v252
    v_exp_f32 v253, v253
    v_exp_f32 v254, v254
    v_mfma_f32_32x32x16_bf16 v[128:143], v[188:191], v[28:31], v[128:143]
    s_waitcnt lgkmcnt(4)
    ds_read_b64_tr_b16 v[188:189], v11 offset:32800
    ds_read_b64_tr_b16 v[190:191], v11 offset:33056
    v_exp_f32 v255, v255
    v_mul_f32 v64, v64, v72
    v_mul_f32 v65, v65, v73
    v_mfma_f32_16x16x32_bf16 v[240:243], v[232:235], v[176:179], v[240:243]
    v_mul_f32 v66, v66, v74
    v_mul_f32 v67, v67, v75
    v_mfma_f32_32x32x16_bf16 v[112:127], v[176:179], a[128:131], v[112:127]
    v_mul_f32 v68, v68, v76
    v_mul_f32 v69, v69, v77
    v_mul_f32 v70, v70, v78
    v_mul_f32 v71, v71, v79
    v_add_f32 v248, 1.0, v248
    v_add_f32 v249, 1.0, v249
    v_mfma_f32_32x32x16_bf16 v[128:143], v[176:179], v[32:35], v[128:143]
    s_waitcnt lgkmcnt(4)
    v_add_f32 v250, 1.0, v250
    v_add_f32 v251, 1.0, v251
    v_add_f32 v252, 1.0, v252
    v_add_f32 v253, 1.0, v253
    v_add_f32 v254, 1.0, v254
    v_add_f32 v255, 1.0, v255
    v_mfma_f32_32x32x16_bf16 v[112:127], v[180:183], a[132:135], v[112:127]
    s_waitcnt vmcnt(2)
    s_waitcnt lgkmcnt(0)
    s_barrier
    s_add_u32 s57, s66, 73760
    v_add_u32 v8, s57, v7
    ds_read_b64_tr_b16 v[176:177], v8 offset:0
    ds_read_b64_tr_b16 v[178:179], v8 offset:256
    v_mfma_f32_32x32x16_bf16 v[128:143], v[180:183], v[36:39], v[128:143]
    s_add_u32 s57, s67, 73760
    v_add_u32 v9, s57, v7
    ds_read_b64_tr_b16 v[180:181], v9 offset:0
    ds_read_b64_tr_b16 v[182:183], v9 offset:256
    v_rcp_f32 v248, v248
    v_mfma_f32_32x32x16_bf16 v[112:127], v[184:187], a[136:139], v[112:127]
    v_rcp_f32 v249, v249
    v_rcp_f32 v250, v250
    v_rcp_f32 v251, v251
    v_mfma_f32_32x32x16_bf16 v[128:143], v[184:187], v[40:43], v[128:143]
    s_add_u32 s57, s68, 73760
    v_add_u32 v10, s57, v7
    ds_read_b64_tr_b16 v[184:185], v10 offset:0
    ds_read_b64_tr_b16 v[186:187], v10 offset:256
    v_rcp_f32 v252, v252
    v_mfma_f32_32x32x16_bf16 v[112:127], v[188:191], a[140:143], v[112:127]
    s_add_u32 s40, s39, s81
    v_rcp_f32 v253, v253
    v_rcp_f32 v254, v254
    v_rcp_f32 v255, v255
    v_mfma_f32_32x32x16_bf16 v[128:143], v[188:191], v[44:47], v[128:143]
    s_waitcnt lgkmcnt(4)
    s_add_u32 s57, s69, 73760
    v_add_u32 v11, s57, v7
    ds_read_b64_tr_b16 v[188:189], v11 offset:0
    ds_read_b64_tr_b16 v[190:191], v11 offset:256
    s_add_u32 s40, s40, 18432
    s_add_u32 s61, s53, 294912
    v_mfma_f32_16x16x32_bf16 v[236:239], v[232:235], v[176:179], 0
    v_mov_b32 v246, s58
    v_mov_b32 v247, s59
    v_mfma_f32_32x32x16_bf16 v[144:159], v[176:179], a[0:3], 0
    buffer_store_dwordx2 v[246:247], v0, s[32:35], s40 offen sc1
    v_mul_f32 v64, v64, v248
    v_mul_f32 v65, v65, v249
    v_mul_f32 v66, v66, v250
    v_mul_f32 v67, v67, v251
    v_mfma_f32_32x32x16_bf16 v[160:175], v[176:179], a[144:147], 0
    s_waitcnt lgkmcnt(4)
    ds_read_b64_tr_b16 v[176:177], v8 offset:4096
    ds_read_b64_tr_b16 v[178:179], v8 offset:4352
    v_mul_f32 v68, v68, v252
    v_mul_f32 v69, v69, v253
    v_mul_f32 v70, v70, v254
    v_mul_f32 v71, v71, v255
    v_mfma_f32_32x32x16_bf16 v[144:159], v[180:183], a[4:7], v[144:159]
    s_waitcnt vmcnt(2)
    v_cmp_eq_u64 vcc, s[58:59], v[12:13]
    s_nop 1
    s_cmp_eq_u64 vcc, -1
    s_cbranch_scc0 LK_slow
LK_ok:
    v_cvt_pk_bf16_f32 v72, v64, v65
    v_mfma_f32_32x32x16_bf16 v[160:175], v[180:183], a[148:151], v[160:175]
    s_waitcnt lgkmcnt(4)
    ds_read_b64_tr_b16 v[180:181], v9 offset:4096
    ds_read_b64_tr_b16 v[182:183], v9 offset:4352
    s_mov_b64 exec, 0xffff
    ds_write_b64 v244, v[240:241] offset:14912
    s_mov_b64 exec, -1
    v_cvt_pk_bf16_f32 v73, v66, v67
    v_mfma_f32_32x32x16_bf16 v[144:159], v[184:187], a[8:11], v[144:159]
    v_cvt_pk_bf16_f32 v74, v68, v69
    v_cvt_pk_bf16_f32 v75, v70, v71
    buffer_store_dwordx4 v[72:75], v3, s[20:23], s61 offen sc1
    v_mfma_f32_32x32x16_bf16 v[160:175], v[184:187], a[152:155], v[160:175]
    s_waitcnt lgkmcnt(5)
    ds_read_b64_tr_b16 v[184:185], v10 offset:4096
    ds_read_b64_tr_b16 v[186:187], v10 offset:4352
    v_mfma_f32_32x32x16_bf16 v[144:159], v[188:191], a[12:15], v[144:159]
    s_add_u32 s40, s62, 4096
    buffer_load_dword v80, v15, s[24:27], s62 offen offset:0 sc1
    v_mfma_f32_32x32x16_bf16 v[160:175], v[188:191], a[156:159], v[160:175]
    s_waitcnt lgkmcnt(5)
    ds_read_b64_tr_b16 v[188:189], v11 offset:4096
    ds_read_b64_tr_b16 v[190:191], v11 offset:4352
    v_mfma_f32_16x16x32_bf16 v[236:239], v[232:235], v[176:179], v[236:239]
    buffer_load_dword v81, v15, s[24:27], s62 offen offset:256 sc1
    v_mfma_f32_32x32x16_bf16 v[144:159], v[176:179], a[16:19], v[144:159]
    v_mfma_f32_32x32x16_bf16 v[160:175], v[176:179], a[160:163], v[160:175]
    s_waitcnt lgkmcnt(4)
    s_barrier
    ds_read_b64_tr_b16 v[176:177], v8 offset:8192
    ds_read_b64_tr_b16 v[178:179], v8 offset:8448
    buffer_load_dword v82, v15, s[24:27], s62 offen offset:512 sc1
    v_mfma_f32_32x32x16_bf16 v[144:159], v[180:183], a[20:23], v[144:159]
    ds_read_b32 v248, v245 offset:14912
    ds_read_b32 v249, v245 offset:15040
    ds_read_b32 v250, v245 offset:15168
    ds_read_b32 v251, v245 offset:15296
    v_mfma_f32_32x32x16_bf16 v[160:175], v[180:183], a[164:167], v[160:175]
    s_waitcnt lgkmcnt(8)
    ds_read_b64_tr_b16 v[180:181], v9 offset:8192
    ds_read_b64_tr_b16 v[182:183], v9 offset:8448
    buffer_load_dword v83, v15, s[24:27], s62 offen offset:768 sc1
    v_mfma_f32_32x32x16_bf16 v[144:159], v[184:187], a[24:27], v[144:159]
    v_mfma_f32_32x32x16_bf16 v[160:175], v[184:187], a[168:171], v[160:175]
    s_waitcnt lgkmcnt(8)
    ds_read_b64_tr_b16 v[184:185], v10 offset:8192
    ds_read_b64_tr_b16 v[186:187], v10 offset:8448
    buffer_load_dword v84, v15, s[24:27], s62 offen offset:1024 sc1
    v_mfma_f32_32x32x16_bf16 v[144:159], v[188:191], a[28:31], v[144:159]
    buffer_load_dword v85, v15, s[24:27], s62 offen offset:1280 sc1
    s_waitcnt lgkmcnt(6)
    v_add_f32 v248, v248, v249
    s_waitcnt lgkmcnt(4)
    v_add_f32 v250, v250, v251
    v_add_f32 v248, v248, v250
    v_cvt_pk_bf16_f32 v249, v248, v248
    v_mfma_f32_32x32x16_bf16 v[160:175], v[188:191], a[172:175], v[160:175]
    ds_read_b64_tr_b16 v[188:189], v11 offset:8192
    ds_read_b64_tr_b16 v[190:191], v11 offset:8448
    v_lshlrev_b32 v249, 16, v249
    v_sub_f32 v249, v248, v249
    v_cvt_pk_bf16_f32 v224, v248, v249
    v_mfma_f32_16x16x32_bf16 v[236:239], v[232:235], v[176:179], v[236:239]
    buffer_load_dword v86, v15, s[24:27], s62 offen offset:1536 sc1
    v_mfma_f32_32x32x16_bf16 v[144:159], v[176:179], a[32:35], v[144:159]
    v_mfma_f32_32x32x8_bf16 v[112:127], v[224:225], v[226:227], v[112:127]
    v_mfma_f32_32x32x8_bf16 v[128:143], v[224:225], v[228:229], v[128:143]
    v_mfma_f32_32x32x16_bf16 v[160:175], v[176:179], a[176:179], v[160:175]
    s_waitcnt lgkmcnt(4)
    ds_read_b64_tr_b16 v[176:177], v8 offset:12288
    ds_read_b64_tr_b16 v[178:179], v8 offset:12544
    buffer_load_dword v87, v15, s[24:27], s62 offen offset:1792 sc1
    v_mfma_f32_32x32x16_bf16 v[144:159], v[180:183], a[36:39], v[144:159]
    v_mfma_f32_32x32x16_bf16 v[160:175], v[180:183], a[180:183], v[160:175]
    s_waitcnt lgkmcnt(4)
    ds_read_b64_tr_b16 v[180:181], v9 offset:12288
    ds_read_b64_tr_b16 v[182:183], v9 offset:12544
    buffer_load_dword v88, v15, s[24:27], s62 offen offset:2048 sc1
    v_mul_f32 v248, v230, v112
    v_mul_f32 v249, v230, v113
    v_mfma_f32_32x32x16_bf16 v[144:159], v[184:187], a[40:43], v[144:159]
    v_mul_f32 v250, v230, v114
    v_mul_f32 v251, v230, v115
    v_mul_f32 v252, v230, v116
    v_mul_f32 v253, v230, v117
    v_mul_f32 v254, v230, v118
    v_mul_f32 v255, v230, v119
    v_mfma_f32_32x32x16_bf16 v[160:175], v[184:187], a[184:187], v[160:175]
    s_waitcnt lgkmcnt(4)
    ds_read_b64_tr_b16 v[184:185], v10 offset:12288
    ds_read_b64_tr_b16 v[186:187], v10 offset:12544
    buffer_load_dword v89, v15, s[24:27], s62 offen offset:2304 sc1
    v_exp_f32 v248, v248
    v_mfma_f32_32x32x16_bf16 v[144:159], v[188:191], a[44:47], v[144:159]
    v_exp_f32 v249, v249
    v_exp_f32 v250, v250
    v_exp_f32 v251, v251
    v_mfma_f32_32x32x16_bf16 v[160:175], v[188:191], a[188:191], v[160:175]
    s_waitcnt lgkmcnt(4)
    ds_read_b64_tr_b16 v[188:189], v11 offset:12288
    ds_read_b64_tr_b16 v[190:191], v11 offset:12544
    buffer_load_dword v90, v15, s[24:27], s62 offen offset:2560 sc1
    v_exp_f32 v252, v252
    v_mfma_f32_16x16x32_bf16 v[236:239], v[232:235], v[176:179], v[236:239]
    buffer_load_dword v91, v15, s[24:27], s62 offen offset:2816 sc1
    v_mfma_f32_32x32x16_bf16 v[144:159], v[176:179], a[48:51], v[144:159]
    v_exp_f32 v253, v253
    v_exp_f32 v254, v254
    v_exp_f32 v255, v255
    v_mfma_f32_32x32x16_bf16 v[160:175], v[176:179], a[192:195], v[160:175]
    s_waitcnt lgkmcnt(4)
    ds_read_b64_tr_b16 v[176:177], v8 offset:16384
    ds_read_b64_tr_b16 v[178:179], v8 offset:16640
    buffer_load_dword v92, v15, s[24:27], s62 offen offset:3072 sc1
    v_mul_f32 v112, v112, v120
    v_mul_f32 v113, v113, v121
    v_mfma_f32_32x32x16_bf16 v[144:159], v[180:183], a[52:55], v[144:159]
    v_mul_f32 v114, v114, v122
    v_mul_f32 v115, v115, v123
    v_mul_f32 v116, v116, v124
    v_mul_f32 v117, v117, v125
    v_mul_f32 v118, v118, v126
    v_mul_f32 v119, v119, v127
    v_mfma_f32_32x32x16_bf16 v[160:175], v[180:183], a[196:199], v[160:175]
    s_waitcnt lgkmcnt(4)
    ds_read_b64_tr_b16 v[180:181], v9 offset:16384
    ds_read_b64_tr_b16 v[182:183], v9 offset:16640
    buffer_load_dword v93, v15, s[24:27], s62 offen offset:3328 sc1
    v_add_f32 v248, 1.0, v248
    v_add_f32 v249, 1.0, v249
    v_mfma_f32_32x32x16_bf16 v[144:159], v[184:187], a[56:59], v[144:159]
    v_add_f32 v250, 1.0, v250
    v_add_f32 v251, 1.0, v251
    v_add_f32 v252, 1.0, v252
    v_add_f32 v253, 1.0, v253
    v_add_f32 v254, 1.0, v254
    v_add_f32 v255, 1.0, v255
    v_mfma_f32_32x32x16_bf16 v[160:175], v[184:187], a[200:203], v[160:175]
    s_waitcnt lgkmcnt(4)
    ds_read_b64_tr_b16 v[184:185], v10 offset:16384
    ds_read_b64_tr_b16 v[186:187], v10 offset:16640
    buffer_load_dword v94, v15, s[24:27], s62 offen offset:3584 sc1
    v_rcp_f32 v248, v248
    v_mfma_f32_32x32x16_bf16 v[144:159], v[188:191], a[60:63], v[144:159]
    v_rcp_f32 v249, v249
    v_rcp_f32 v250, v250
    v_rcp_f32 v251, v251
    v_mfma_f32_32x32x16_bf16 v[160:175], v[188:191], a[204:207], v[160:175]
    s_waitcnt lgkmcnt(4)
    ds_read_b64_tr_b16 v[188:189], v11 offset:16384
    ds_read_b64_tr_b16 v[190:191], v11 offset:16640
    buffer_load_dword v95, v15, s[24:27], s62 offen offset:3840 sc1
    v_rcp_f32 v252, v252
    v_mfma_f32_16x16x32_bf16 v[236:239], v[232:235], v[176:179], v[236:239]
    buffer_load_dword v96, v15, s[24:27], s40 offen offset:0 sc1
    v_mfma_f32_32x32x16_bf16 v[144:159], v[176:179], a[64:67], v[144:159]
    v_rcp_f32 v253, v253
    v_rcp_f32 v254, v254
    v_rcp_f32 v255, v255
    v_mfma_f32_32x32x16_bf16 v[160:175], v[176:179], a[208:211], v[160:175]
    s_waitcnt lgkmcnt(4)
    ds_read_b64_tr_b16 v[176:177], v8 offset:20480
    ds_read_b64_tr_b16 v[178:179], v8 offset:20736
    buffer_load_dword v97, v15, s[24:27], s40 offen offset:256 sc1
    s_add_u32 s61, s53, 512
    v_mul_f32 v112, v112, v248
    v_mfma_f32_32x32x16_bf16 v[144:159], v[180:183], a[68:71], v[144:159]
    v_mul_f32 v113, v113, v249
    v_mul_f32 v114, v114, v250
    v_mul_f32 v115, v115, v251
    v_mul_f32 v116, v116, v252
    v_mul_f32 v117, v117, v253
    v_mul_f32 v118, v118, v254
    v_mfma_f32_32x32x16_bf16 v[160:175], v[180:183], a[212:215], v[160:175]
    s_waitcnt lgkmcnt(4)
    ds_read_b64_tr_b16 v[180:181], v9 offset:20480
    ds_read_b64_tr_b16 v[182:183], v9 offset:20736
    s_waitcnt vmcnt(16)
    v_cvt_pk_bf16_f32 v100, v80, v81
    s_waitcnt vmcnt(14)
    v_cvt_pk_bf16_f32 v101, v82, v83
    s_waitcnt vmcnt(12)
    v_cvt_pk_bf16_f32 v102, v84, v85
    v_mul_f32 v119, v119, v255
    s_waitcnt vmcnt(10)
    v_cvt_pk_bf16_f32 v103, v86, v87
    s_waitcnt vmcnt(8)
    v_cvt_pk_bf16_f32 v104, v88, v89
    v_mfma_f32_32x32x16_bf16 v[144:159], v[184:187], a[72:75], v[144:159]
    s_waitcnt vmcnt(6)
    v_cvt_pk_bf16_f32 v105, v90, v91
    s_waitcnt vmcnt(4)
    v_cvt_pk_bf16_f32 v106, v92, v93
    s_waitcnt vmcnt(2)
    v_cvt_pk_bf16_f32 v107, v94, v95
    s_waitcnt vmcnt(0)
    v_cvt_pk_bf16_f32 v108, v96, v97
    v_mov_b32 v109, 0
    v_mov_b32 v110, 0
    v_mov_b32 v111, 0
    v_bfe_u32 v12, v1, 4, 1
    v_mfma_f32_32x32x16_bf16 v[160:175], v[184:187], a[216:219], v[160:175]
    s_waitcnt lgkmcnt(4)
    ds_read_b64_tr_b16 v[184:185], v10 offset:20480
    ds_read_b64_tr_b16 v[186:187], v10 offset:20736
    v_lshlrev_b32 v12, 14, v12
    v_and_b32 v13, 15, v1
    v_lshl_add_u32 v12, v13, 4, v12
    v_lshrrev_b32 v13, 5, v1
    v_lshl_add_u32 v12, v13, 8, v12
    v_mul_u32_u24 v13, 0x7ff000, v13
    v_mfma_f32_32x32x16_bf16 v[144:159], v[188:191], a[76:79], v[144:159]
    v_lshlrev_b32 v13, 8, v13
    v_lshl_add_u32 v13, v1, 7, v13
    s_lshl_b32 s40, s37, 3
    s_lshl_b32 s41, s36, 1
    s_add_u32 s40, s40, s41
    s_lshl_b32 s42, s40, 12
    s_lshl_b32 s41, s38, 2
    s_add_u32 s42, s42, s41
    v_mfma_f32_32x32x16_bf16 v[160:175], v[188:191], a[220:223], v[160:175]
    s_waitcnt lgkmcnt(4)
    ds_read_b64_tr_b16 v[188:189], v11 offset:20480
    ds_read_b64_tr_b16 v[190:191], v11 offset:20736
    s_add_u32 s42, s42, 2097152
    s_lshl_b32 s40, s40, 15
    s_lshl_b32 s41, s38, 9
    s_add_u32 s40, s40, s41
    s_add_u32 s41, s40, 32768
    s_add_u32 s43, s42, 4096
    v_mfma_f32_16x16x32_bf16 v[236:239], v[232:235], v[176:179], v[236:239]
    v_mfma_f32_32x32x16_bf16 v[48:63], v[100:103], v[192:195], 0
    v_mfma_f32_32x32x16_bf16 v[144:159], v[176:179], a[80:83], v[144:159]
    v_mfma_f32_32x32x16_bf16 v[64:79], v[100:103], v[208:211], 0
    v_cvt_pk_bf16_f32 v120, v112, v113
    v_cvt_pk_bf16_f32 v121, v114, v115
    v_cvt_pk_bf16_f32 v122, v116, v117
    v_cvt_pk_bf16_f32 v123, v118, v119
    v_mfma_f32_32x32x16_bf16 v[160:175], v[176:179], a[224:227], v[160:175]
    s_waitcnt lgkmcnt(4)
    ds_read_b64_tr_b16 v[176:177], v8 offset:24576
    ds_read_b64_tr_b16 v[178:179], v8 offset:24832
    buffer_store_dwordx4 v[120:123], v3, s[20:23], s61 offen sc1
    v_mul_f32 v248, v231, v128
    v_mul_f32 v249, v231, v129
    v_mfma_f32_32x32x16_bf16 v[144:159], v[180:183], a[84:87], v[144:159]
    v_mfma_f32_32x32x16_bf16 v[48:63], v[104:107], v[196:199], v[48:63]
    v_mul_f32 v250, v231, v130
    v_mul_f32 v251, v231, v131
    v_mul_f32 v252, v231, v132
    v_mul_f32 v253, v231, v133
    v_mfma_f32_32x32x16_bf16 v[160:175], v[180:183], a[228:231], v[160:175]
    s_waitcnt lgkmcnt(4)
    ds_read_b64_tr_b16 v[180:181], v9 offset:24576
    ds_read_b64_tr_b16 v[182:183], v9 offset:24832
    v_mfma_f32_32x32x16_bf16 v[64:79], v[104:107], v[212:215], v[64:79]
    v_mul_f32 v254, v231, v134
    v_mul_f32 v255, v231, v135
    v_mfma_f32_32x32x16_bf16 v[144:159], v[184:187], a[88:91], v[144:159]
    v_exp_f32 v248, v248
    v_exp_f32 v249, v249
    v_exp_f32 v250, v250
    v_mfma_f32_32x32x16_bf16 v[160:175], v[184:187], a[232:235], v[160:175]
    s_waitcnt lgkmcnt(4)
    ds_read_b64_tr_b16 v[184:185], v10 offset:24576
    ds_read_b64_tr_b16 v[186:187], v10 offset:24832
    v_mfma_f32_32x32x16_bf16 v[48:63], v[108:111], v[200:203], v[48:63]
    v_exp_f32 v251, v251
    v_mfma_f32_32x32x16_bf16 v[144:159], v[188:191], a[92:95], v[144:159]
    v_mfma_f32_32x32x16_bf16 v[64:79], v[108:111], v[216:219], v[64:79]
    v_exp_f32 v252, v252
    v_exp_f32 v253, v253
    v_mfma_f32_32x32x16_bf16 v[160:175], v[188:191], a[236:239], v[160:175]
    s_waitcnt lgkmcnt(4)
    ds_read_b64_tr_b16 v[188:189], v11 offset:24576
    ds_read_b64_tr_b16 v[190:191], v11 offset:24832
    v_exp_f32 v254, v254
    v_exp_f32 v255, v255
    v_mfma_f32_16x16x32_bf16 v[236:239], v[232:235], v[176:179], v[236:239]
    v_mov_b32 v60, v56
    v_mov_b32 v61, v56
    v_mfma_f32_32x32x16_bf16 v[144:159], v[176:179], a[96:99], v[144:159]
    v_mov_b32 v76, v72
    v_mov_b32 v77, v72
    v_permlane32_swap_b32 v60, v61
    v_mul_f32 v128, v128, v136
    v_mul_f32 v129, v129, v137
    v_permlane32_swap_b32 v76, v77
    v_add_f32 v61, 0x358637bd, v61
    v_mfma_f32_32x32x16_bf16 v[160:175], v[176:179], a[240:243], v[160:175]
    s_waitcnt lgkmcnt(4)
    ds_read_b64_tr_b16 v[176:177], v8 offset:28672
    ds_read_b64_tr_b16 v[178:179], v8 offset:28928
    v_rcp_f32 v61, v61
    v_add_f32 v77, 0x358637bd, v77
    v_mul_f32 v130, v130, v138
    v_rcp_f32 v77, v77
    v_mul_f32 v48, v48, v61
    v_mfma_f32_32x32x16_bf16 v[144:159], v[180:183], a[100:103], v[144:159]
    v_mul_f32 v49, v49, v61
    v_mul_f32 v50, v50, v61
    v_mul_f32 v51, v51, v61
    v_mul_f32 v52, v52, v61
    v_mul_f32 v53, v53, v61
    v_mul_f32 v54, v54, v61
    v_mul_f32 v55, v55, v61
    v_mul_f32 v56, v56, v61
    v_mul_f32 v57, v57, v61
    v_mfma_f32_32x32x16_bf16 v[160:175], v[180:183], a[244:247], v[160:175]
    s_waitcnt lgkmcnt(4)
    ds_read_b64_tr_b16 v[180:181], v9 offset:28672
    ds_read_b64_tr_b16 v[182:183], v9 offset:28928
    v_cvt_pk_bf16_f32 v48, v48, v49
    v_cvt_pk_bf16_f32 v49, v50, v51
    v_cvt_pk_bf16_f32 v50, v52, v53
    v_mul_f32 v131, v131, v139
    v_cvt_pk_bf16_f32 v51, v54, v55
    v_cvt_pk_bf16_f32 v52, v56, v57
    v_mfma_f32_32x32x16_bf16 v[144:159], v[184:187], a[104:107], v[144:159]
    buffer_store_dwordx4 v[48:51], v12, s[28:31], s40 offen sc1
    buffer_store_dword v52, v13, s[28:31], s42 offen sc1
    v_mul_f32 v64, v64, v77
    v_mul_f32 v65, v65, v77
    v_mul_f32 v66, v66, v77
    v_mul_f32 v67, v67, v77
    v_mfma_f32_32x32x16_bf16 v[160:175], v[184:187], a[248:251], v[160:175]
    s_waitcnt lgkmcnt(4)
    ds_read_b64_tr_b16 v[184:185], v10 offset:28672
    ds_read_b64_tr_b16 v[186:187], v10 offset:28928
    v_mul_f32 v68, v68, v77
    v_mul_f32 v69, v69, v77
    v_mul_f32 v70, v70, v77
    v_mul_f32 v71, v71, v77
    v_mul_f32 v72, v72, v77
    v_mfma_f32_32x32x16_bf16 v[144:159], v[188:191], a[108:111], v[144:159]
    v_mul_f32 v73, v73, v77
    v_cvt_pk_bf16_f32 v64, v64, v65
    v_cvt_pk_bf16_f32 v65, v66, v67
    v_cvt_pk_bf16_f32 v66, v68, v69
    v_cvt_pk_bf16_f32 v67, v70, v71
    v_cvt_pk_bf16_f32 v68, v72, v73
    v_mfma_f32_32x32x16_bf16 v[160:175], v[188:191], a[252:255], v[160:175]
    s_waitcnt lgkmcnt(4)
    ds_read_b64_tr_b16 v[188:189], v11 offset:28672
    ds_read_b64_tr_b16 v[190:191], v11 offset:28928
    buffer_store_dwordx4 v[64:67], v12, s[28:31], s41 offen sc1
    v_mul_f32 v132, v132, v140
    v_mul_f32 v133, v133, v141
    buffer_store_dword v68, v13, s[28:31], s43 offen sc1
    v_mfma_f32_16x16x32_bf16 v[236:239], v[232:235], v[176:179], v[236:239]
    s_and_b32 s40, s2, 7
    s_lshr_b32 s41, s2, 3
    s_mul_i32 s42, s40, 29
    v_mfma_f32_32x32x16_bf16 v[144:159], v[176:179], a[112:115], v[144:159]
    s_min_u32 s43, s40, 2
    s_add_u32 s42, s42, s43
    s_add_u32 s63, s42, s41
    s_cmp_lt_u32 s40, 2
    s_cselect_b32 s43, 30, 29
    s_cmp_lt_u32 s41, s43
    s_cselect_b32 s63, s63, 255
    s_mul_i32 s40, s63, 21846
    v_mfma_f32_32x32x16_bf16 v[160:175], v[176:179], v[16:19], v[160:175]
    s_waitcnt lgkmcnt(4)
    ds_read_b64_tr_b16 v[176:177], v8 offset:32768
    ds_read_b64_tr_b16 v[178:179], v8 offset:33024
    s_lshr_b32 s40, s40, 16
    s_mul_i32 s41, s40, 2521
    s_lshr_b32 s101, s41, 16
    s_mul_i32 s41, s101, 26
    s_sub_u32 s40, s40, s41
    v_mfma_f32_32x32x16_bf16 v[144:159], v[180:183], a[116:119], v[144:159]
    s_mul_i32 s41, s40, 6554
    s_lshr_b32 s41, s41, 16
    s_sub_u32 s41, s101, s41
    s_mul_i32 s41, s41, 10
    v_mul_f32 v134, v134, v142
    s_add_u32 s41, s41, s40
    v_mul_f32 v135, v135, v143
    s_mul_i32 s41, s41, 3
    v_mfma_f32_32x32x16_bf16 v[160:175], v[180:183], v[20:23], v[160:175]
    s_waitcnt lgkmcnt(4)
    ds_read_b64_tr_b16 v[180:181], v9 offset:32768
    ds_read_b64_tr_b16 v[182:183], v9 offset:33024
    s_mul_i32 s42, s101, 26
    v_add_f32 v248, 1.0, v248
    v_add_f32 v249, 1.0, v249
    s_add_u32 s42, s42, s40
    v_add_f32 v250, 1.0, v250
    v_mfma_f32_32x32x16_bf16 v[144:159], v[184:187], a[120:123], v[144:159]
    s_mul_i32 s42, s42, 3
    s_sub_u32 s42, s63, s42
    v_add_f32 v251, 1.0, v251
    v_add_f32 v252, 1.0, v252
    s_add_u32 s41, s41, s42
    v_add_f32 v253, 1.0, v253
    s_min_u32 s100, s41, 89
    v_mfma_f32_32x32x16_bf16 v[160:175], v[184:187], v[24:27], v[160:175]
    s_waitcnt lgkmcnt(4)
    ds_read_b64_tr_b16 v[184:185], v10 offset:32768
    ds_read_b64_tr_b16 v[186:187], v10 offset:33024
    v_add_f32 v254, 1.0, v254
    s_mul_i32 s40, s40, 80
    v_add_f32 v255, 1.0, v255
    s_add_u32 s41, s40, 79
    v_rcp_f32 v248, v248
    v_mfma_f32_32x32x16_bf16 v[144:159], v[188:191], a[124:127], v[144:159]
    s_min_u32 s40, s40, 2047
    s_min_u32 s41, s41, 2047
    v_rcp_f32 v249, v249
    s_and_b32 s40, s40, 0xf00
    v_rcp_f32 v250, v250
    v_mfma_f32_32x32x16_bf16 v[160:175], v[188:191], v[28:31], v[160:175]
    s_waitcnt lgkmcnt(4)
    ds_read_b64_tr_b16 v[188:189], v11 offset:32768
    ds_read_b64_tr_b16 v[190:191], v11 offset:33024
    s_and_b32 s41, s41, 0xf00
    s_sub_u32 s41, s41, 256
    v_rcp_f32 v251, v251
    v_mfma_f32_16x16x32_bf16 v[236:239], v[232:235], v[176:179], v[236:239]
    v_mov_b32 v246, s40
    v_mov_b32 v247, s41
    v_mfma_f32_32x32x16_bf16 v[144:159], v[176:179], a[128:131], v[144:159]
    v_cmp_gt_u32 vcc, 32, v1
    v_rcp_f32 v252, v252
    v_rcp_f32 v253, v253
    v_cndmask_b32 v246, v247, v246, vcc
    v_lshl_add_u32 v246, v1, 3, v246
    v_mfma_f32_32x32x16_bf16 v[160:175], v[176:179], v[32:35], v[160:175]
    s_waitcnt lgkmcnt(4)
    v_add_u32 v246, 16384, v246
    buffer_load_dwordx2 v[12:13], v246, s[32:35], 0 offen sc1
    v_rcp_f32 v254, v254
    s_getpc_b64 s[42:43]
LB_pc:
    v_mfma_f32_32x32x16_bf16 v[144:159], v[180:183], a[132:135], v[144:159]
    s_mul_i32 s40, s100, 48
    v_rcp_f32 v255, v255
    s_add_u32 s61, s53, 295424
    s_add_u32 s40, s40, LK_tab-LB_pc
    v_mul_f32 v128, v128, v248
    v_mul_f32 v129, v129, v249
    v_mfma_f32_32x32x16_bf16 v[160:175], v[180:183], v[36:39], v[160:175]
    s_waitcnt lgkmcnt(2)
    v_min_u32 v247, 47, v1
    v_add_u32 v247, s40, v247
    v_mul_f32 v130, v130, v250
    v_mul_f32 v131, v131, v251
    v_mul_f32 v132, v132, v252
    v_mul_f32 v133, v133, v253
    global_load_ubyte v247, v247, s[42:43]
    v_mfma_f32_32x32x16_bf16 v[144:159], v[184:187], a[136:139], v[144:159]
    v_mul_f32 v134, v134, v254
    v_mul_f32 v135, v135, v255
    v_cvt_pk_bf16_f32 v136, v128, v129
    v_cvt_pk_bf16_f32 v137, v130, v131
    v_cvt_pk_bf16_f32 v138, v132, v133
    v_cvt_pk_bf16_f32 v139, v134, v135
    v_mfma_f32_32x32x16_bf16 v[160:175], v[184:187], v[40:43], v[160:175]
    s_waitcnt lgkmcnt(0)
    buffer_store_dwordx4 v[136:139], v3, s[20:23], s61 offen sc1
    v_mfma_f32_32x32x16_bf16 v[144:159], v[188:191], a[140:143], v[144:159]
    v_mfma_f32_32x32x16_bf16 v[160:175], v[188:191], v[44:47], v[160:175]
    s_mov_b64 exec, 0xffff
    ds_write_b64 v244, v[236:237] offset:15424
    s_mov_b64 exec, -1
    s_add_u32 s80, s39, s81
    s_add_u32 s80, s80, 20480
    s_mul_i32 s43, s63, 21846
    s_lshr_b32 s43, s43, 16
    s_mul_i32 s42, s43, 3
    s_sub_u32 s38, s63, s42
    s_mul_i32 s42, s101, 26
    s_sub_u32 s37, s43, s42
    s_mov_b32 s4, s76
    s_mov_b32 s5, s77
    s_mov_b32 s6, 5308416
    s_mov_b32 s7, 0x20000
    s_lshr_b32 s40, s36, 1
    s_and_b32 s41, s36, 1
    s_mul_i32 s42, s40, 147456
    v_lshl_add_u32 v16, v1, 4, s42
    v_add_u32 v17, 294912, v16
    s_cmp_eq_u32 s40, 0
    s_cselect_b32 s42, 0, 2146435072
    s_add_u32 s42, s42, 589824
    v_add_u32 v18, s42, v16
    s_lshl_b32 s42, s40, 11
    s_lshl_b32 s49, s41, 10
    s_add_u32 s49, s49, s42
    s_mov_b32 s51, s41
    s_mov_b32 s52, s40
    s_mul_i32 s53, s40, 12288
    s_lshl_b32 s42, s41, 11
    s_add_u32 s53, s53, s42
    s_add_u32 s53, s53, 12288
    v_lshrrev_b32 v34, 3, v1
    v_mul_u32_u24 v34, 1152, v34
    v_bfe_u32 v35, v1, 4, 2
    v_lshlrev_b32 v35, 1, v35
    v_and_b32 v19, 7, v1
    v_xor_b32 v35, v35, v19
    v_lshl_add_u32 v34, v35, 4, v34
    s_mul_i32 s41, s41, 18432
    s_mul_i32 s46, s38, 384
    s_add_u32 s41, s41, s46
    v_add_u32 v19, s41, v34
    v_add_u32 v20, 9216, v19
    v_add_u32 v21, 128, v19
    v_add_u32 v22, 9344, v19
    v_add_u32 v23, 256, v19
    v_add_u32 v24, 9472, v19
    s_mul_i32 s45, s37, 737280
    s_waitcnt vmcnt(2)
    v_cmp_eq_u64 vcc, s[58:59], v[12:13]
    s_nop 1
    s_cmp_eq_u64 vcc, -1
    s_cbranch_scc0 LF1_slow
LF1_ok:
    s_waitcnt vmcnt(1)
    v_mov_b32 v247, v247
    s_waitcnt lgkmcnt(0)
    s_barrier
    s_cmp_eq_u32 s63, 255
    s_cbranch_scc1 LB_spare
    ds_read_b32 v248, v245 offset:15424
    v_readlane_b32 s40, v247, s51
    ds_read_b32 v249, v245 offset:15552
    ds_read_b32 v250, v245 offset:15680
    ds_read_b32 v251, v245 offset:15808
    s_waitcnt lgkmcnt(2)
    v_add_f32 v248, v248, v249
    v_readlane_b32 s41, v247, s52
    s_waitcnt lgkmcnt(0)
    v_add_f32 v250, v250, v251
    v_add_f32 v248, v248, v250
    v_cvt_pk_bf16_f32 v249, v248, v248
    v_lshlrev_b32 v249, 16, v249
    v_sub_f32 v249, v248, v249
    s_add_u32 m0, s49, 0
    v_cvt_pk_bf16_f32 v224, v248, v249
    s_nop 1
    v_mfma_f32_32x32x8_bf16 v[144:159], v[224:225], v[226:227], v[144:159]
    v_mfma_f32_32x32x8_bf16 v[160:175], v[224:225], v[228:229], v[160:175]
    s_nop 10
    v_mul_f32 v248, v230, v144
    s_lshl_b32 s40, s40, 10
    v_mul_f32 v249, v230, v145
    v_mul_f32 v250, v230, v146
    v_mul_f32 v251, v230, v147
    v_mul_f32 v252, v230, v148
    v_mul_f32 v253, v230, v149
    s_add_u32 s47, s45, s40
    v_mul_f32 v254, v230, v150
    v_mul_f32 v255, v230, v151
    v_exp_f32 v248, v248
    v_exp_f32 v249, v249
    s_mul_i32 s48, s41, 36864
    v_exp_f32 v250, v250
    v_exp_f32 v251, v251
    v_exp_f32 v252, v252
    v_exp_f32 v253, v253
    v_exp_f32 v254, v254
    buffer_load_dwordx4 v16, s[20:23], s47 offen sc1 lds
    v_exp_f32 v255, v255
    v_mul_f32 v144, v144, v152
    v_mul_f32 v145, v145, v153
    v_mul_f32 v146, v146, v154
    v_mul_f32 v147, v147, v155
    s_addk_i32 m0, 4096
    v_mul_f32 v148, v148, v156
    v_mul_f32 v149, v149, v157
    v_mul_f32 v150, v150, v158
    v_mul_f32 v151, v151, v159
    buffer_load_dwordx4 v17, s[20:23], s47 offen sc1 lds
    v_add_f32 v248, 1.0, v248
    v_add_f32 v249, 1.0, v249
    v_add_f32 v250, 1.0, v250
    v_add_f32 v251, 1.0, v251
    v_add_f32 v252, 1.0, v252
    s_addk_i32 m0, 4096
    v_add_f32 v253, 1.0, v253
    v_add_f32 v254, 1.0, v254
    v_add_f32 v255, 1.0, v255
    v_rcp_f32 v248, v248
    buffer_load_dwordx4 v18, s[20:23], s47 offen sc1 lds
    v_rcp_f32 v249, v249
    v_rcp_f32 v250, v250
    v_rcp_f32 v251, v251
    v_rcp_f32 v252, v252
    v_rcp_f32 v253, v253
    s_add_u32 m0, s53, 0
    v_rcp_f32 v254, v254
    v_rcp_f32 v255, v255
    s_add_u32 s61, s54, 0
    v_mul_f32 v144, v144, v248
    s_add_u32 s51, s51, 2
    v_mul_f32 v145, v145, v249
    v_mul_f32 v146, v146, v250
    v_mul_f32 v147, v147, v251
    v_mul_f32 v148, v148, v252
    v_mul_f32 v149, v149, v253
    buffer_load_dwordx4 v19, s[4:7], s48 offen lds
    v_mul_f32 v150, v150, v254
    v_mul_f32 v151, v151, v255
    v_cvt_pk_bf16_f32 v152, v144, v145
    v_cvt_pk_bf16_f32 v153, v146, v147
    v_cvt_pk_bf16_f32 v154, v148, v149
    s_addk_i32 m0, 1024
    v_cvt_pk_bf16_f32 v155, v150, v151
    buffer_store_dwordx4 v[152:155], v3, s[20:23], s61 offen sc1
    v_mul_f32 v248, v231, v160
    v_mul_f32 v249, v231, v161
    buffer_load_dwordx4 v20, s[4:7], s48 offen lds
    v_mul_f32 v250, v231, v162
    v_mul_f32 v251, v231, v163
    v_mul_f32 v252, v231, v164
    v_mul_f32 v253, v231, v165
    v_mul_f32 v254, v231, v166
    s_addk_i32 m0, 3072
    v_mul_f32 v255, v231, v167
    v_exp_f32 v248, v248
    v_exp_f32 v249, v249
    v_exp_f32 v250, v250
    buffer_load_dwordx4 v21, s[4:7], s48 offen lds
    v_exp_f32 v251, v251
    v_exp_f32 v252, v252
    v_exp_f32 v253, v253
    v_exp_f32 v254, v254
    v_exp_f32 v255, v255
    s_addk_i32 m0, 1024
    v_mul_f32 v160, v160, v168
    v_mul_f32 v161, v161, v169
    v_mul_f32 v162, v162, v170
    v_mul_f32 v163, v163, v171
    buffer_load_dwordx4 v22, s[4:7], s48 offen lds
    v_mul_f32 v164, v164, v172
    v_mul_f32 v165, v165, v173
    v_mul_f32 v166, v166, v174
    v_mul_f32 v167, v167, v175
    v_add_f32 v248, 1.0, v248
    s_addk_i32 m0, 3072
    v_add_f32 v249, 1.0, v249
    v_add_f32 v250, 1.0, v250
    v_add_f32 v251, 1.0, v251
    v_add_f32 v252, 1.0, v252
    v_add_f32 v253, 1.0, v253
    buffer_load_dwordx4 v23, s[4:7], s48 offen lds
    v_add_f32 v254, 1.0, v254
    v_add_f32 v255, 1.0, v255
    v_rcp_f32 v248, v248
    v_rcp_f32 v249, v249
    s_addk_i32 m0, 1024
    v_rcp_f32 v250, v250
    v_rcp_f32 v251, v251
    v_rcp_f32 v252, v252
    v_rcp_f32 v253, v253
    v_rcp_f32 v254, v254
    buffer_load_dwordx4 v24, s[4:7], s48 offen lds
    v_rcp_f32 v255, v255
    s_add_u32 s61, s54, 294912
    v_mul_f32 v160, v160, v248
    v_mul_f32 v161, v161, v249
    s_add_u32 s52, s52, 2
    v_mul_f32 v162, v162, v250
    v_mul_f32 v163, v163, v251
    v_mul_f32 v164, v164, v252
    v_mul_f32 v165, v165, v253
    v_mul_f32 v166, v166, v254
    v_readlane_b32 s40, v247, s51
    v_mul_f32 v167, v167, v255
    v_cvt_pk_bf16_f32 v168, v160, v161
    v_cvt_pk_bf16_f32 v169, v162, v163
    v_cvt_pk_bf16_f32 v170, v164, v165
    v_readlane_b32 s41, v247, s52
    v_cvt_pk_bf16_f32 v171, v166, v167
    buffer_store_dwordx4 v[168:171], v3, s[20:23], s61 offen sc1
    s_mov_b32 s12, s64
    s_mov_b32 s13, s65
    s_mov_b32 s14, 2359296
    s_add_u32 m0, s49, 36864
    s_mov_b32 s15, 0x20000
    s_lshl_b32 s66, s36, 10
    s_mul_i32 s67, s37, 81920
    s_add_u32 s67, s67, s66
    s_lshl_b32 s68, s36, 12
    s_lshl_b32 s40, s40, 10
    s_add_u32 s68, s68, 20480
    s_lshl_b32 s42, s101, 7
    s_add_u32 s46, s46, s42
    s_mul_i32 s69, s36, 41472
    s_add_u32 s47, s45, s40
    s_add_u32 s69, s69, s46
    v_bfe_u32 v40, v1, 4, 2
    v_lshlrev_b32 v40, 1, v40
    v_and_b32 v41, 7, v1
    v_xor_b32 v40, v40, v41
    s_mul_i32 s48, s41, 36864
    v_lshlrev_b32 v40, 4, v40
    v_bfe_u32 v41, v1, 3, 2
    v_lshrrev_b32 v5, 5, v1
    v_lshl_add_u32 v41, v5, 3, v41
    buffer_load_dwordx4 v16, s[20:23], s47 offen sc1 lds
    v_mul_u32_u24 v41, 1152, v41
    v_add_u32 v4, v40, v41
    v_mul_u32_u24 v5, 72, v5
    v_bfe_u32 v41, v1, 4, 1
    v_mul_u32_u24 v41, 18, v41
    s_addk_i32 m0, 4096
    v_add_u32 v5, v5, v41
    v_bfe_u32 v41, v1, 3, 1
    v_add_u32 v5, v5, v41
    v_mul_u32_u24 v5, 1152, v5
    buffer_load_dwordx4 v17, s[20:23], s47 offen sc1 lds
    v_add_u32 v5, v5, v40
    s_and_b32 s42, s36, 1
    s_lshl_b32 s42, s42, 2
    v_lshrrev_b32 v40, 4, v1
    v_add_u32 v40, s42, v40
    s_addk_i32 m0, 4096
    v_and_b32 v41, 7, v1
    v_xor_b32 v40, v40, v41
    v_and_b32 v41, 56, v1
    v_lshlrev_b32 v41, 4, v41
    v_lshl_add_u32 v6, v40, 4, v41
    buffer_load_dwordx4 v18, s[20:23], s47 offen sc1 lds
    v_bfe_u32 v40, v1, 1, 3
    v_lshrrev_b32 v41, 4, v1
    v_xor_b32 v40, v40, v41
    v_and_b32 v41, 15, v1
    s_add_u32 m0, s53, 36864
    v_lshlrev_b32 v7, 7, v41
    v_lshl_add_u32 v7, v40, 4, v7
    v_xor_b32 v8, 64, v7
    s_mul_i32 s42, s37, 80
    v_add_u32 v40, s42, v41
    s_add_u32 s51, s51, 2
    v_lshlrev_b32 v40, 4, v40
    v_add_u32 v14, 32772, v40
    s_lshl_b32 s43, s36, 3
    s_add_u32 s42, s42, s43
    buffer_load_dwordx4 v19, s[4:7], s48 offen lds
    v_lshrrev_b32 v40, 3, v1
    v_add_u32 v40, s42, v40
    v_mul_u32_u24 v40, 1152, v40
    v_and_b32 v41, 7, v1
    v_lshl_add_u32 v40, v41, 4, v40
    s_addk_i32 m0, 1024
    v_add_u32 v9, s46, v40
    v_add_u32 v10, 36864, v9
    s_lshr_b32 s42, s36, 1
    s_mul_i32 s42, s42, 2146435072
    buffer_load_dwordx4 v20, s[4:7], s48 offen lds
    s_add_u32 s42, s42, 73728
    v_add_u32 v11, s42, v9
    s_mul_i32 s56, s37, 3
    s_add_u32 s56, s56, s38
    s_mul_i32 s56, s56, 122880
    s_addk_i32 m0, 3072
    s_mul_i32 s3, s37, 10240
    s_add_u32 s3, s3, s66
    s_add_u32 s3, s3, 2097152
    s_lshl_b32 s39, s36, 11
    s_add_u32 s39, s39, 20480
    buffer_load_dwordx4 v21, s[4:7], s48 offen lds
    s_mul_i32 s44, s36, 165888
    s_add_u32 s44, s44, s46
    s_add_u32 s44, s44, 18432
    s_mul_i32 s42, s36, 3
    s_addk_i32 m0, 1024
    s_add_u32 s42, s42, 0
    s_and_b32 s43, s42, 3
    s_lshr_b32 s42, s42, 2
    s_lshl_b32 s43, s43, 10
    s_sub_u32 s57, s101, s42
    buffer_load_dwordx4 v22, s[4:7], s48 offen lds
    s_add_u32 s57, s57, 2
    s_mul_i32 s63, s57, 43
    s_lshr_b32 s63, s63, 7
    s_mul_i32 s63, s63, 3
    s_addk_i32 m0, 3072
    s_sub_u32 s57, s57, s63
    s_lshr_b32 s63, s57, 1
    s_mul_i32 s63, s63, 2146435072
    s_mul_i32 s57, s57, 20480
    s_mul_i32 s42, s42, 40960
    buffer_load_dwordx4 v23, s[4:7], s48 offen lds
    s_add_u32 s57, s57, s42
    s_add_u32 s57, s57, s56
    s_add_u32 s57, s57, s43
    s_add_u32 s60, s57, s63
    s_addk_i32 m0, 1024
    s_mul_i32 s42, s36, 3
    s_add_u32 s42, s42, 1
    s_and_b32 s43, s42, 3
    s_lshr_b32 s42, s42, 2
    s_lshl_b32 s43, s43, 10
    buffer_load_dwordx4 v24, s[4:7], s48 offen lds
    s_sub_u32 s57, s101, s42
    s_add_u32 s57, s57, 2
    s_mul_i32 s63, s57, 43
    s_lshr_b32 s63, s63, 7
    s_mul_i32 s63, s63, 3
    s_add_u32 s52, s52, 2
    s_sub_u32 s57, s57, s63
    s_lshr_b32 s63, s57, 1
    s_mul_i32 s63, s63, 2146435072
    s_mul_i32 s57, s57, 20480
    v_readlane_b32 s40, v247, s51
    s_mul_i32 s42, s42, 40960
    s_add_u32 s57, s57, s42
    s_add_u32 s57, s57, s56
    s_add_u32 s57, s57, s43
    s_add_u32 s62, s57, s63
    v_readlane_b32 s41, v247, s52
    s_mul_i32 s42, s36, 3
    s_add_u32 s42, s42, 2
    s_and_b32 s43, s42, 3
    s_lshr_b32 s42, s42, 2
    s_add_u32 m0, s49, 73728
    s_lshl_b32 s43, s43, 10
    s_sub_u32 s57, s101, s42
    s_add_u32 s57, s57, 2
    s_mul_i32 s63, s57, 43
    s_lshr_b32 s63, s63, 7
    s_lshl_b32 s40, s40, 10
    s_mul_i32 s63, s63, 3
    s_sub_u32 s57, s57, s63
    s_lshr_b32 s63, s57, 1
    s_mul_i32 s63, s63, 2146435072
    s_add_u32 s47, s45, s40
    s_mul_i32 s57, s57, 20480
    s_mul_i32 s42, s42, 40960
    s_add_u32 s57, s57, s42
    s_add_u32 s57, s57, s56
    s_add_u32 s57, s57, s43
    s_mul_i32 s48, s41, 36864
    s_add_u32 s64, s57, s63
    v_mov_b32 v48, 0
    v_mov_b32 v49, 0
    v_mov_b32 v50, 0
    v_mov_b32 v51, 0
    buffer_load_dwordx4 v16, s[20:23], s47 offen sc1 lds
    v_mov_b32 v52, 0
    v_mov_b32 v53, 0
    v_mov_b32 v54, 0
    v_mov_b32 v55, 0
    s_addk_i32 m0, 4096
    v_mov_b32 v56, 0
    v_mov_b32 v57, 0
    v_mov_b32 v58, 0
    v_mov_b32 v59, 0
    v_mov_b32 v60, 0
    buffer_load_dwordx4 v17, s[20:23], s47 offen sc1 lds
    v_mov_b32 v61, 0
    v_mov_b32 v62, 0
    v_mov_b32 v63, 0
    v_mov_b32 v64, 0
    s_addk_i32 m0, 4096
    v_mov_b32 v65, 0
    v_mov_b32 v66, 0
    v_mov_b32 v67, 0
    v_mov_b32 v68, 0
    v_mov_b32 v69, 0
    buffer_load_dwordx4 v18, s[20:23], s47 offen sc1 lds
    v_mov_b32 v70, 0
    v_mov_b32 v71, 0
    v_mov_b32 v72, 0
    v_mov_b32 v73, 0
    s_add_u32 m0, s53, 73728
    v_mov_b32 v74, 0
    v_mov_b32 v75, 0
    v_mov_b32 v76, 0
    v_mov_b32 v77, 0
    v_mov_b32 v78, 0
    s_add_u32 s51, s51, 2
    v_mov_b32 v79, 0
    v_mov_b32 v80, 0
    v_mov_b32 v81, 0
    v_mov_b32 v82, 0
    v_mov_b32 v83, 0
    buffer_load_dwordx4 v19, s[4:7], s48 offen lds
    v_mov_b32 v84, 0
    v_mov_b32 v85, 0
    v_mov_b32 v86, 0
    v_mov_b32 v87, 0
    s_addk_i32 m0, 1024
    v_mov_b32 v88, 0
    v_mov_b32 v89, 0
    v_mov_b32 v90, 0
    v_mov_b32 v91, 0
    v_mov_b32 v92, 0
    buffer_load_dwordx4 v20, s[4:7], s48 offen lds
    v_mov_b32 v93, 0
    v_mov_b32 v94, 0
    v_mov_b32 v95, 0
    v_mov_b32 v96, 0
    s_addk_i32 m0, 3072
    v_mov_b32 v97, 0
    v_mov_b32 v98, 0
    v_mov_b32 v99, 0
    v_mov_b32 v100, 0
    v_mov_b32 v101, 0
    buffer_load_dwordx4 v21, s[4:7], s48 offen lds
    v_mov_b32 v102, 0
    v_mov_b32 v103, 0
    v_mov_b32 v104, 0
    v_mov_b32 v105, 0
    s_addk_i32 m0, 1024
    v_mov_b32 v106, 0
    v_mov_b32 v107, 0
    v_mov_b32 v182, s58
    v_mov_b32 v183, s59
    v_mov_b32 v186, s58
    buffer_load_dwordx4 v22, s[4:7], s48 offen lds
    v_mov_b32 v187, s59
    v_mov_b32 v190, s58
    v_mov_b32 v191, s59
    v_mov_b32 v194, s58
    v_mov_b32 v195, s59
    s_addk_i32 m0, 3072
    v_mov_b32 v198, s58
    v_mov_b32 v199, s59
    v_mov_b32 v202, s58
    v_mov_b32 v203, s59
    buffer_load_dwordx4 v23, s[4:7], s48 offen lds
    v_mov_b32 v206, s58
    v_mov_b32 v207, s59
    v_mov_b32 v210, s58
    v_mov_b32 v211, s59
    v_mov_b32 v214, s58
    s_addk_i32 m0, 1024
    v_mov_b32 v215, s59
    v_mov_b32 v218, s58
    v_mov_b32 v219, s59
    v_mov_b32 v222, s58
    buffer_load_dwordx4 v24, s[4:7], s48 offen lds
    v_mov_b32 v223, s59
    v_mov_b32 v226, s58
    v_mov_b32 v227, s59
    v_mov_b32 v230, s58
    v_mov_b32 v231, s59
    s_add_u32 s52, s52, 2
    v_mov_b32 v234, s58
    v_mov_b32 v235, s59
    v_mov_b32 v238, s58
    v_mov_b32 v239, s59
    s_mov_b32 s8, s70
    s_mov_b32 s9, s71
    s_mov_b32 s10, 663552
    s_mov_b32 s11, 0x20000
    s_mov_b32 s16, s78
    s_mov_b32 s17, s79
    s_mov_b32 s18, 2359296
    s_mov_b32 s19, 0x20000
    s_add_u32 s24, s82, 26476544
    s_addc_u32 s25, s83, 0
    s_mov_b32 s26, 9584640
    s_mov_b32 s27, 0x20000
    v_add_u32 v246, 2048, v246
    v_lshlrev_b32 v28, 4, v1
    v_lshrrev_b32 v34, 5, v1
    v_lshlrev_b32 v34, 11, v34
    v_bfe_u32 v35, v1, 2, 3
    v_lshl_add_u32 v34, v35, 7, v34
    v_and_b32 v29, 3, v1
    v_lshl_add_u32 v30, v29, 3, v34
    v_lshrrev_b32 v35, 1, v35
    s_mul_i32 s40, s36, 3
    s_add_u32 s40, s40, 0
    s_and_b32 s41, s40, 3
    s_lshr_b32 s40, s40, 2
    s_lshl_b32 s40, s40, 12
    s_add_u32 s40, s40, 12288
    v_xor_b32 v34, s41, v35
    v_lshl_add_u32 v34, v34, 5, v30
    v_add_u32 v25, s40, v34
    s_mul_i32 s40, s36, 3
    s_add_u32 s40, s40, 1
    s_and_b32 s41, s40, 3
    s_lshr_b32 s40, s40, 2
    s_lshl_b32 s40, s40, 12
    s_add_u32 s40, s40, 12288
    v_xor_b32 v34, s41, v35
    v_lshl_add_u32 v34, v34, 5, v30
    v_add_u32 v26, s40, v34
    s_mul_i32 s40, s36, 3
    s_add_u32 s40, s40, 2
    s_and_b32 s41, s40, 3
    s_lshr_b32 s40, s40, 2
    s_lshl_b32 s40, s40, 12
    s_add_u32 s40, s40, 12288
    v_xor_b32 v34, s41, v35
    v_lshl_add_u32 v34, v34, 5, v30
    v_add_u32 v27, s40, v34
    v_xor_b32 v34, s36, v35
    v_lshl_add_u32 v29, v34, 5, v30
    v_mov_b32 v30, v28
    s_waitcnt vmcnt(19)
    s_barrier
    v_readlane_b32 s40, v247, s51
    v_readlane_b32 s41, v247, s52
    s_add_u32 m0, s49, 110592
    s_lshl_b32 s40, s40, 10
    s_add_u32 s47, s45, s40
    s_mul_i32 s48, s41, 36864
    buffer_load_dwordx4 v16, s[20:23], s47 offen sc1 lds
    s_addk_i32 m0, 4096
    s_nop 0
    buffer_load_dwordx4 v17, s[20:23], s47 offen sc1 lds
    s_addk_i32 m0, 4096
    s_nop 0
    buffer_load_dwordx4 v18, s[20:23], s47 offen sc1 lds
    s_add_u32 m0, s53, 110592
    s_add_u32 s51, s51, 2
    buffer_load_dwordx4 v19, s[4:7], s48 offen lds
    s_addk_i32 m0, 1024
    s_nop 0
    buffer_load_dwordx4 v20, s[4:7], s48 offen lds
    s_addk_i32 m0, 3072
    s_nop 0
    buffer_load_dwordx4 v21, s[4:7], s48 offen lds
    s_addk_i32 m0, 1024
    s_nop 0
    buffer_load_dwordx4 v22, s[4:7], s48 offen lds
    s_addk_i32 m0, 3072
    s_nop 0
    buffer_load_dwordx4 v23, s[4:7], s48 offen lds
    s_addk_i32 m0, 1024
    s_nop 0
    buffer_load_dwordx4 v24, s[4:7], s48 offen lds
    s_add_u32 s52, s52, 2
    ds_read_b64_tr_b16 v[108:109], v25 offset:0
    ds_read_b64_tr_b16 v[110:111], v25 offset:1024
    ds_read_b64_tr_b16 v[112:113], v25 offset:12288
    ds_read_b64_tr_b16 v[114:115], v25 offset:13312
    ds_read_b128 a[0:3], v28 offset:0
    ds_read_b128 a[4:7], v28 offset:1024
    ds_read_b128 a[8:11], v28 offset:2048
    ds_read_b128 a[12:15], v28 offset:3072
    ds_read_b64_tr_b16 v[116:117], v26 offset:0
    ds_read_b64_tr_b16 v[118:119], v26 offset:1024
    ds_read_b64_tr_b16 v[120:121], v26 offset:12288
    ds_read_b64_tr_b16 v[122:123], v26 offset:13312
    ds_read_b128 a[16:19], v28 offset:4096
    ds_read_b128 a[20:23], v28 offset:5120
    ds_read_b128 a[24:27], v28 offset:6144
    s_waitcnt lgkmcnt(14)
    ds_read_b128 a[28:31], v28 offset:7168
    s_waitcnt lgkmcnt(14)
    ds_read_b64_tr_b16 v[124:125], v27 offset:0
    s_waitcnt lgkmcnt(14)
    ds_read_b64_tr_b16 v[126:127], v27 offset:1024
    s_waitcnt lgkmcnt(14)
    ds_read_b64_tr_b16 v[128:129], v27 offset:12288
    s_waitcnt lgkmcnt(14)
    ds_read_b64_tr_b16 v[130:131], v27 offset:13312
    s_waitcnt lgkmcnt(14)
    ds_read_b128 a[32:35], v28 offset:8192
    s_waitcnt lgkmcnt(14)
    ds_read_b128 a[36:39], v28 offset:9216
    v_add_u32 v25, 36864, v25
    v_add_u32 v26, 36864, v26
    v_add_u32 v27, 36864, v27
    v_add_u32 v28, 36864, v28
    s_mov_b32 s50, 0
LB_loop:
    s_waitcnt vmcnt(18) lgkmcnt(0)
    s_barrier
    s_and_b32 s40, s50, 1
    s_cbranch_scc0 LF2_ok
    v_cmp_eq_u64 vcc, s[58:59], v[32:33]
    s_nop 1
    s_cmp_eq_u64 vcc, -1
    s_cbranch_scc0 LF2_slow
LF2_ok:
    s_cmp_eq_u32 s50, 1
    s_cselect_b32 s40, 2048, 0
    v_add_u32 v246, s40, v246
    v_mfma_f32_16x16x32_bf16 v[48:51], v[108:111], a[0:3], v[48:51]
    v_readlane_b32 s40, v247, s51
    ds_read_b64_tr_b16 v[132:133], v25 offset:0
    v_mfma_f32_16x16x32_bf16 v[48:51], v[112:115], a[4:7], v[48:51]
    v_readlane_b32 s41, v247, s52
    ds_read_b64_tr_b16 v[134:135], v25 offset:1024
    v_mfma_f32_16x16x32_bf16 v[52:55], v[108:111], a[8:11], v[52:55]
    s_add_u32 m0, s49, 0
    ds_read_b64_tr_b16 v[136:137], v25 offset:12288
    v_mfma_f32_16x16x32_bf16 v[52:55], v[112:115], a[12:15], v[52:55]
    s_lshl_b32 s40, s40, 10
    ds_read_b64_tr_b16 v[138:139], v25 offset:13312
    ds_read_b128 a[40:43], v28 offset:0
    v_mfma_f32_16x16x32_bf16 v[56:59], v[108:111], a[16:19], v[56:59]
    ds_read_b128 a[44:47], v28 offset:1024
    ds_read_b128 a[48:51], v28 offset:2048
    v_mfma_f32_16x16x32_bf16 v[56:59], v[112:115], a[20:23], v[56:59]
    s_add_u32 s47, s45, s40
    ds_read_b128 a[52:55], v28 offset:3072
    v_mfma_f32_16x16x32_bf16 v[60:63], v[108:111], a[24:27], v[60:63]
    s_mul_i32 s48, s41, 36864
    ds_read_b64_tr_b16 v[140:141], v26 offset:0
    v_mfma_f32_16x16x32_bf16 v[60:63], v[112:115], a[28:31], v[60:63]
    buffer_load_dwordx4 v16, s[20:23], s47 offen sc1 lds
    ds_read_b64_tr_b16 v[142:143], v26 offset:1024
    v_mfma_f32_16x16x32_bf16 v[64:67], v[108:111], a[32:35], v[64:67]
    s_addk_i32 m0, 4096
    ds_read_b64_tr_b16 v[144:145], v26 offset:12288
    ds_read_b64_tr_b16 v[146:147], v26 offset:13312
    v_mfma_f32_16x16x32_bf16 v[64:67], v[112:115], a[36:39], v[64:67]
    buffer_load_dwordx4 v17, s[20:23], s47 offen sc1 lds
    ds_read_b128 a[56:59], v28 offset:4096
    v_mfma_f32_16x16x32_bf16 v[68:71], v[116:119], a[0:3], v[68:71]
    s_addk_i32 m0, 4096
    ds_read_b128 a[60:63], v28 offset:5120
    v_mfma_f32_16x16x32_bf16 v[68:71], v[120:123], a[4:7], v[68:71]
    ds_read_b128 a[64:67], v28 offset:6144
    ds_read_b128 a[68:71], v28 offset:7168
    v_mfma_f32_16x16x32_bf16 v[72:75], v[116:119], a[8:11], v[72:75]
    buffer_load_dwordx4 v18, s[20:23], s47 offen sc1 lds
    ds_read_b64_tr_b16 v[148:149], v27 offset:0
    v_mfma_f32_16x16x32_bf16 v[72:75], v[120:123], a[12:15], v[72:75]
    s_add_u32 m0, s53, 0
    ds_read_b64_tr_b16 v[150:151], v27 offset:1024
    ds_read_b64_tr_b16 v[152:153], v27 offset:12288
    v_mfma_f32_16x16x32_bf16 v[76:79], v[116:119], a[16:19], v[76:79]
    s_add_u32 s51, s51, 2
    ds_read_b64_tr_b16 v[154:155], v27 offset:13312
    v_mfma_f32_16x16x32_bf16 v[76:79], v[120:123], a[20:23], v[76:79]
    buffer_load_dwordx4 v19, s[4:7], s48 offen lds
    ds_read_b128 a[72:75], v28 offset:8192
    v_mfma_f32_16x16x32_bf16 v[80:83], v[116:119], a[24:27], v[80:83]
    s_addk_i32 m0, 1024
    ds_read_b128 a[76:79], v28 offset:9216
    v_add_u32 v25, 36864, v25
    v_mfma_f32_16x16x32_bf16 v[80:83], v[120:123], a[28:31], v[80:83]
    buffer_load_dwordx4 v20, s[4:7], s48 offen lds
    v_add_u32 v26, 36864, v26
    v_mfma_f32_16x16x32_bf16 v[84:87], v[116:119], a[32:35], v[84:87]
    s_addk_i32 m0, 3072
    v_add_u32 v27, 36864, v27
    v_mfma_f32_16x16x32_bf16 v[84:87], v[120:123], a[36:39], v[84:87]
    v_add_u32 v28, 36864, v28
    v_mfma_f32_16x16x32_bf16 v[88:91], v[124:127], a[0:3], v[88:91]
    buffer_load_dwordx4 v21, s[4:7], s48 offen lds
    v_mfma_f32_16x16x32_bf16 v[88:91], v[128:131], a[4:7], v[88:91]
    s_addk_i32 m0, 1024
    v_mfma_f32_16x16x32_bf16 v[92:95], v[124:127], a[8:11], v[92:95]
    buffer_load_dwordx4 v22, s[4:7], s48 offen lds
    v_mfma_f32_16x16x32_bf16 v[92:95], v[128:131], a[12:15], v[92:95]
    s_addk_i32 m0, 3072
    v_mfma_f32_16x16x32_bf16 v[96:99], v[124:127], a[16:19], v[96:99]
    buffer_load_dwordx4 v23, s[4:7], s48 offen lds
    v_mfma_f32_16x16x32_bf16 v[96:99], v[128:131], a[20:23], v[96:99]
    s_addk_i32 m0, 1024
    v_mfma_f32_16x16x32_bf16 v[100:103], v[124:127], a[24:27], v[100:103]
    v_mfma_f32_16x16x32_bf16 v[100:103], v[128:131], a[28:31], v[100:103]
    buffer_load_dwordx4 v24, s[4:7], s48 offen lds
    v_mfma_f32_16x16x32_bf16 v[104:107], v[124:127], a[32:35], v[104:107]
    s_add_u32 s52, s52, 2
    v_mfma_f32_16x16x32_bf16 v[104:107], v[128:131], a[36:39], v[104:107]
    buffer_load_dwordx2 v[32:33], v246, s[32:35], 0 offen sc1
    s_waitcnt vmcnt(19) lgkmcnt(0)
    s_barrier
    v_mfma_f32_16x16x32_bf16 v[48:51], v[132:135], a[40:43], v[48:51]
    v_readlane_b32 s40, v247, s51
    ds_read_b64_tr_b16 v[108:109], v25 offset:0
    v_mfma_f32_16x16x32_bf16 v[48:51], v[136:139], a[44:47], v[48:51]
    v_readlane_b32 s41, v247, s52
    ds_read_b64_tr_b16 v[110:111], v25 offset:1024
    v_mfma_f32_16x16x32_bf16 v[52:55], v[132:135], a[48:51], v[52:55]
    s_add_u32 m0, s49, 36864
    ds_read_b64_tr_b16 v[112:113], v25 offset:12288
    v_mfma_f32_16x16x32_bf16 v[52:55], v[136:139], a[52:55], v[52:55]
    ds_read_b64_tr_b16 v[114:115], v25 offset:13312
    ds_read_b128 a[0:3], v28 offset:0
    v_mfma_f32_16x16x32_bf16 v[56:59], v[132:135], a[56:59], v[56:59]
    s_lshl_b32 s40, s40, 10
    ds_read_b128 a[4:7], v28 offset:1024
    v_mfma_f32_16x16x32_bf16 v[56:59], v[136:139], a[60:63], v[56:59]
    s_add_u32 s47, s45, s40
    ds_read_b128 a[8:11], v28 offset:2048
    ds_read_b128 a[12:15], v28 offset:3072
    v_mfma_f32_16x16x32_bf16 v[60:63], v[132:135], a[64:67], v[60:63]
    s_mul_i32 s48, s41, 36864
    ds_read_b64_tr_b16 v[116:117], v26 offset:0
    v_mfma_f32_16x16x32_bf16 v[60:63], v[136:139], a[68:71], v[60:63]
    buffer_load_dwordx4 v16, s[20:23], s47 offen sc1 lds
    ds_read_b64_tr_b16 v[118:119], v26 offset:1024
    v_mfma_f32_16x16x32_bf16 v[64:67], v[132:135], a[72:75], v[64:67]
    s_addk_i32 m0, 4096
    ds_read_b64_tr_b16 v[120:121], v26 offset:12288
    v_mfma_f32_16x16x32_bf16 v[64:67], v[136:139], a[76:79], v[64:67]
    ds_read_b64_tr_b16 v[122:123], v26 offset:13312
    ds_read_b128 a[16:19], v28 offset:4096
    v_mfma_f32_16x16x32_bf16 v[68:71], v[140:143], a[40:43], v[68:71]
    buffer_load_dwordx4 v17, s[20:23], s47 offen sc1 lds
    ds_read_b128 a[20:23], v28 offset:5120
    v_mfma_f32_16x16x32_bf16 v[68:71], v[144:147], a[44:47], v[68:71]
    s_addk_i32 m0, 4096
    ds_read_b128 a[24:27], v28 offset:6144
    ds_read_b128 a[28:31], v28 offset:7168
    v_mfma_f32_16x16x32_bf16 v[72:75], v[140:143], a[48:51], v[72:75]
    buffer_load_dwordx4 v18, s[20:23], s47 offen sc1 lds
    ds_read_b64_tr_b16 v[124:125], v27 offset:0
    v_mfma_f32_16x16x32_bf16 v[72:75], v[144:147], a[52:55], v[72:75]
    s_add_u32 m0, s53, 36864
    ds_read_b64_tr_b16 v[126:127], v27 offset:1024
    v_mfma_f32_16x16x32_bf16 v[76:79], v[140:143], a[56:59], v[76:79]
    s_add_u32 s51, s51, 2
    ds_read_b64_tr_b16 v[128:129], v27 offset:12288
    v_mfma_f32_16x16x32_bf16 v[76:79], v[144:147], a[60:63], v[76:79]
    ds_read_b64_tr_b16 v[130:131], v27 offset:13312
    ds_read_b128 a[32:35], v28 offset:8192
    v_mfma_f32_16x16x32_bf16 v[80:83], v[140:143], a[64:67], v[80:83]
    buffer_load_dwordx4 v19, s[4:7], s48 offen lds
    ds_read_b128 a[36:39], v28 offset:9216
    v_mfma_f32_16x16x32_bf16 v[80:83], v[144:147], a[68:71], v[80:83]
    s_addk_i32 m0, 1024
    v_add_u32 v25, 36864, v25
    v_add_u32 v26, 36864, v26
    v_mfma_f32_16x16x32_bf16 v[84:87], v[140:143], a[72:75], v[84:87]
    buffer_load_dwordx4 v20, s[4:7], s48 offen lds
    v_add_u32 v27, 36864, v27
    v_mfma_f32_16x16x32_bf16 v[84:87], v[144:147], a[76:79], v[84:87]
    s_addk_i32 m0, 3072
    v_add_u32 v28, 36864, v28
    v_mfma_f32_16x16x32_bf16 v[88:91], v[148:151], a[40:43], v[88:91]
    buffer_load_dwordx4 v21, s[4:7], s48 offen lds
    v_mfma_f32_16x16x32_bf16 v[88:91], v[152:155], a[44:47], v[88:91]
    v_mfma_f32_16x16x32_bf16 v[92:95], v[148:151], a[48:51], v[92:95]
    s_addk_i32 m0, 1024
    v_mfma_f32_16x16x32_bf16 v[92:95], v[152:155], a[52:55], v[92:95]
    buffer_load_dwordx4 v22, s[4:7], s48 offen lds
    v_mfma_f32_16x16x32_bf16 v[96:99], v[148:151], a[56:59], v[96:99]
    s_addk_i32 m0, 3072
    v_mfma_f32_16x16x32_bf16 v[96:99], v[152:155], a[60:63], v[96:99]
    buffer_load_dwordx4 v23, s[4:7], s48 offen lds
    v_mfma_f32_16x16x32_bf16 v[100:103], v[148:151], a[64:67], v[100:103]
    s_addk_i32 m0, 1024
    v_mfma_f32_16x16x32_bf16 v[100:103], v[152:155], a[68:71], v[100:103]
    v_mfma_f32_16x16x32_bf16 v[104:107], v[148:151], a[72:75], v[104:107]
    buffer_load_dwordx4 v24, s[4:7], s48 offen lds
    v_mfma_f32_16x16x32_bf16 v[104:107], v[152:155], a[76:79], v[104:107]
    s_add_u32 s52, s52, 2
    s_waitcnt vmcnt(19) lgkmcnt(0)
    s_barrier
    s_cmp_eq_u32 s50, 0
    s_cbranch_scc0 LB_pub
    v_mov_b32 v34, s58
    v_mov_b32 v35, s59
    buffer_store_dwordx2 v[34:35], v0, s[32:35], s80 offen sc1
LB_pub:
    v_mfma_f32_16x16x32_bf16 v[48:51], v[108:111], a[0:3], v[48:51]
    v_readlane_b32 s40, v247, s51
    ds_read_b64_tr_b16 v[132:133], v25 offset:0
    v_mfma_f32_16x16x32_bf16 v[48:51], v[112:115], a[4:7], v[48:51]
    v_readlane_b32 s41, v247, s52
    ds_read_b64_tr_b16 v[134:135], v25 offset:1024
    v_mfma_f32_16x16x32_bf16 v[52:55], v[108:111], a[8:11], v[52:55]
    s_add_u32 m0, s49, 73728
    ds_read_b64_tr_b16 v[136:137], v25 offset:12288
    v_mfma_f32_16x16x32_bf16 v[52:55], v[112:115], a[12:15], v[52:55]
    ds_read_b64_tr_b16 v[138:139], v25 offset:13312
    ds_read_b128 a[40:43], v28 offset:0
    v_mfma_f32_16x16x32_bf16 v[56:59], v[108:111], a[16:19], v[56:59]
    s_lshl_b32 s40, s40, 10
    ds_read_b128 a[44:47], v28 offset:1024
    v_mfma_f32_16x16x32_bf16 v[56:59], v[112:115], a[20:23], v[56:59]
    s_add_u32 s47, s45, s40
    ds_read_b128 a[48:51], v28 offset:2048
    ds_read_b128 a[52:55], v28 offset:3072
    v_mfma_f32_16x16x32_bf16 v[60:63], v[108:111], a[24:27], v[60:63]
    s_mul_i32 s48, s41, 36864
    ds_read_b64_tr_b16 v[140:141], v26 offset:0
    v_mfma_f32_16x16x32_bf16 v[60:63], v[112:115], a[28:31], v[60:63]
    buffer_load_dwordx4 v16, s[20:23], s47 offen sc1 lds
    ds_read_b64_tr_b16 v[142:143], v26 offset:1024
    v_mfma_f32_16x16x32_bf16 v[64:67], v[108:111], a[32:35], v[64:67]
    s_addk_i32 m0, 4096
    ds_read_b64_tr_b16 v[144:145], v26 offset:12288
    v_mfma_f32_16x16x32_bf16 v[64:67], v[112:115], a[36:39], v[64:67]
    ds_read_b64_tr_b16 v[146:147], v26 offset:13312
    ds_read_b128 a[56:59], v28 offset:4096
    v_mfma_f32_16x16x32_bf16 v[68:71], v[116:119], a[0:3], v[68:71]
    buffer_load_dwordx4 v17, s[20:23], s47 offen sc1 lds
    ds_read_b128 a[60:63], v28 offset:5120
    v_mfma_f32_16x16x32_bf16 v[68:71], v[120:123], a[4:7], v[68:71]
    s_addk_i32 m0, 4096
    ds_read_b128 a[64:67], v28 offset:6144
    ds_read_b128 a[68:71], v28 offset:7168
    v_mfma_f32_16x16x32_bf16 v[72:75], v[116:119], a[8:11], v[72:75]
    buffer_load_dwordx4 v18, s[20:23], s47 offen sc1 lds
    ds_read_b64_tr_b16 v[148:149], v27 offset:0
    v_mfma_f32_16x16x32_bf16 v[72:75], v[120:123], a[12:15], v[72:75]
    s_add_u32 m0, s53, 73728
    ds_read_b64_tr_b16 v[150:151], v27 offset:1024
    v_mfma_f32_16x16x32_bf16 v[76:79], v[116:119], a[16:19], v[76:79]
    s_add_u32 s51, s51, 2
    ds_read_b64_tr_b16 v[152:153], v27 offset:12288
    v_mfma_f32_16x16x32_bf16 v[76:79], v[120:123], a[20:23], v[76:79]
    ds_read_b64_tr_b16 v[154:155], v27 offset:13312
    ds_read_b128 a[72:75], v28 offset:8192
    v_mfma_f32_16x16x32_bf16 v[80:83], v[116:119], a[24:27], v[80:83]
    buffer_load_dwordx4 v19, s[4:7], s48 offen lds
    ds_read_b128 a[76:79], v28 offset:9216
    v_mfma_f32_16x16x32_bf16 v[80:83], v[120:123], a[28:31], v[80:83]
    s_addk_i32 m0, 1024
    v_add_u32 v25, 4294856704, v25
    v_add_u32 v26, 4294856704, v26
    v_mfma_f32_16x16x32_bf16 v[84:87], v[116:119], a[32:35], v[84:87]
    buffer_load_dwordx4 v20, s[4:7], s48 offen lds
    v_add_u32 v27, 4294856704, v27
    v_mfma_f32_16x16x32_bf16 v[84:87], v[120:123], a[36:39], v[84:87]
    s_addk_i32 m0, 3072
    v_add_u32 v28, 4294856704, v28
    v_mfma_f32_16x16x32_bf16 v[88:91], v[124:127], a[0:3], v[88:91]
    buffer_load_dwordx4 v21, s[4:7], s48 offen lds
    v_mfma_f32_16x16x32_bf16 v[88:91], v[128:131], a[4:7], v[88:91]
    v_mfma_f32_16x16x32_bf16 v[92:95], v[124:127], a[8:11], v[92:95]
    s_addk_i32 m0, 1024
    v_mfma_f32_16x16x32_bf16 v[92:95], v[128:131], a[12:15], v[92:95]
    buffer_load_dwordx4 v22, s[4:7], s48 offen lds
    v_mfma_f32_16x16x32_bf16 v[96:99], v[124:127], a[16:19], v[96:99]
    s_addk_i32 m0, 3072
    v_mfma_f32_16x16x32_bf16 v[96:99], v[128:131], a[20:23], v[96:99]
    buffer_load_dwordx4 v23, s[4:7], s48 offen lds
    v_mfma_f32_16x16x32_bf16 v[100:103], v[124:127], a[24:27], v[100:103]
    s_addk_i32 m0, 1024
    v_mfma_f32_16x16x32_bf16 v[100:103], v[128:131], a[28:31], v[100:103]
    v_mfma_f32_16x16x32_bf16 v[104:107], v[124:127], a[32:35], v[104:107]
    buffer_load_dwordx4 v24, s[4:7], s48 offen lds
    v_mfma_f32_16x16x32_bf16 v[104:107], v[128:131], a[36:39], v[104:107]
    s_add_u32 s52, s52, 2
    s_waitcnt vmcnt(19) lgkmcnt(0)
    s_barrier
    v_mfma_f32_16x16x32_bf16 v[48:51], v[132:135], a[40:43], v[48:51]
    v_readlane_b32 s40, v247, s51
    ds_read_b64_tr_b16 v[108:109], v25 offset:0
    v_mfma_f32_16x16x32_bf16 v[48:51], v[136:139], a[44:47], v[48:51]
    v_readlane_b32 s41, v247, s52
    ds_read_b64_tr_b16 v[110:111], v25 offset:1024
    v_mfma_f32_16x16x32_bf16 v[52:55], v[132:135], a[48:51], v[52:55]
    s_add_u32 m0, s49, 110592
    ds_read_b64_tr_b16 v[112:113], v25 offset:12288
    v_mfma_f32_16x16x32_bf16 v[52:55], v[136:139], a[52:55], v[52:55]
    ds_read_b64_tr_b16 v[114:115], v25 offset:13312
    ds_read_b128 a[0:3], v28 offset:0
    v_mfma_f32_16x16x32_bf16 v[56:59], v[132:135], a[56:59], v[56:59]
    s_lshl_b32 s40, s40, 10
    ds_read_b128 a[4:7], v28 offset:1024
    v_mfma_f32_16x16x32_bf16 v[56:59], v[136:139], a[60:63], v[56:59]
    s_add_u32 s47, s45, s40
    ds_read_b128 a[8:11], v28 offset:2048
    ds_read_b128 a[12:15], v28 offset:3072
    v_mfma_f32_16x16x32_bf16 v[60:63], v[132:135], a[64:67], v[60:63]
    s_mul_i32 s48, s41, 36864
    ds_read_b64_tr_b16 v[116:117], v26 offset:0
    v_mfma_f32_16x16x32_bf16 v[60:63], v[136:139], a[68:71], v[60:63]
    buffer_load_dwordx4 v16, s[20:23], s47 offen sc1 lds
    ds_read_b64_tr_b16 v[118:119], v26 offset:1024
    v_mfma_f32_16x16x32_bf16 v[64:67], v[132:135], a[72:75], v[64:67]
    s_addk_i32 m0, 4096
    ds_read_b64_tr_b16 v[120:121], v26 offset:12288
    v_mfma_f32_16x16x32_bf16 v[64:67], v[136:139], a[76:79], v[64:67]
    ds_read_b64_tr_b16 v[122:123], v26 offset:13312
    ds_read_b128 a[16:19], v28 offset:4096
    v_mfma_f32_16x16x32_bf16 v[68:71], v[140:143], a[40:43], v[68:71]
    buffer_load_dwordx4 v17, s[20:23], s47 offen sc1 lds
    ds_read_b128 a[20:23], v28 offset:5120
    v_mfma_f32_16x16x32_bf16 v[68:71], v[144:147], a[44:47], v[68:71]
    s_addk_i32 m0, 4096
    ds_read_b128 a[24:27], v28 offset:6144
    ds_read_b128 a[28:31], v28 offset:7168
    v_mfma_f32_16x16x32_bf16 v[72:75], v[140:143], a[48:51], v[72:75]
    buffer_load_dwordx4 v18, s[20:23], s47 offen sc1 lds
    ds_read_b64_tr_b16 v[124:125], v27 offset:0
    v_mfma_f32_16x16x32_bf16 v[72:75], v[144:147], a[52:55], v[72:75]
    s_add_u32 m0, s53, 110592
    ds_read_b64_tr_b16 v[126:127], v27 offset:1024
    v_mfma_f32_16x16x32_bf16 v[76:79], v[140:143], a[56:59], v[76:79]
    s_add_u32 s51, s51, 2
    ds_read_b64_tr_b16 v[128:129], v27 offset:12288
    v_mfma_f32_16x16x32_bf16 v[76:79], v[144:147], a[60:63], v[76:79]
    ds_read_b64_tr_b16 v[130:131], v27 offset:13312
    ds_read_b128 a[32:35], v28 offset:8192
    v_mfma_f32_16x16x32_bf16 v[80:83], v[140:143], a[64:67], v[80:83]
    buffer_load_dwordx4 v19, s[4:7], s48 offen lds
    ds_read_b128 a[36:39], v28 offset:9216
    v_mfma_f32_16x16x32_bf16 v[80:83], v[144:147], a[68:71], v[80:83]
    s_addk_i32 m0, 1024
    v_add_u32 v25, 36864, v25
    v_add_u32 v26, 36864, v26
    v_mfma_f32_16x16x32_bf16 v[84:87], v[140:143], a[72:75], v[84:87]
    buffer_load_dwordx4 v20, s[4:7], s48 offen lds
    v_add_u32 v27, 36864, v27
    v_mfma_f32_16x16x32_bf16 v[84:87], v[144:147], a[76:79], v[84:87]
    s_addk_i32 m0, 3072
    v_add_u32 v28, 36864, v28
    v_mfma_f32_16x16x32_bf16 v[88:91], v[148:151], a[40:43], v[88:91]
    buffer_load_dwordx4 v21, s[4:7], s48 offen lds
    v_mfma_f32_16x16x32_bf16 v[88:91], v[152:155], a[44:47], v[88:91]
    v_mfma_f32_16x16x32_bf16 v[92:95], v[148:151], a[48:51], v[92:95]
    s_addk_i32 m0, 1024
    v_mfma_f32_16x16x32_bf16 v[92:95], v[152:155], a[52:55], v[92:95]
    buffer_load_dwordx4 v22, s[4:7], s48 offen lds
    v_mfma_f32_16x16x32_bf16 v[96:99], v[148:151], a[56:59], v[96:99]
    s_addk_i32 m0, 3072
    v_mfma_f32_16x16x32_bf16 v[96:99], v[152:155], a[60:63], v[96:99]
    buffer_load_dwordx4 v23, s[4:7], s48 offen lds
    v_mfma_f32_16x16x32_bf16 v[100:103], v[148:151], a[64:67], v[100:103]
    s_addk_i32 m0, 1024
    v_mfma_f32_16x16x32_bf16 v[100:103], v[152:155], a[68:71], v[100:103]
    v_mfma_f32_16x16x32_bf16 v[104:107], v[148:151], a[72:75], v[104:107]
    buffer_load_dwordx4 v24, s[4:7], s48 offen lds
    v_mfma_f32_16x16x32_bf16 v[104:107], v[152:155], a[76:79], v[104:107]
    s_add_u32 s52, s52, 2
    s_add_u32 s50, s50, 1
    s_cmp_lt_u32 s50, 5
    s_cbranch_scc1 LB_loop
    s_waitcnt vmcnt(18)
    s_waitcnt lgkmcnt(0)
    s_barrier
    v_mfma_f32_16x16x32_bf16 v[48:51], v[108:111], a[0:3], v[48:51]
    s_add_u32 m0, s66, 0
    ds_read_b64_tr_b16 v[132:133], v25 offset:0
    v_mfma_f32_16x16x32_bf16 v[48:51], v[112:115], a[4:7], v[48:51]
    s_add_u32 s40, s67, 0
    ds_read_b64_tr_b16 v[134:135], v25 offset:1024
    ds_read_b64_tr_b16 v[136:137], v25 offset:12288
    v_mfma_f32_16x16x32_bf16 v[52:55], v[108:111], a[8:11], v[52:55]
    buffer_load_dwordx4 v30, s[28:31], s40 offen sc1 lds
    ds_read_b64_tr_b16 v[138:139], v25 offset:13312
    v_mfma_f32_16x16x32_bf16 v[52:55], v[112:115], a[12:15], v[52:55]
    s_addk_i32 m0, 4096
    ds_read_b128 a[40:43], v28 offset:0
    v_mfma_f32_16x16x32_bf16 v[56:59], v[108:111], a[16:19], v[56:59]
    s_addk_i32 s40, 16384
    ds_read_b128 a[44:47], v28 offset:1024
    ds_read_b128 a[48:51], v28 offset:2048
    v_mfma_f32_16x16x32_bf16 v[56:59], v[112:115], a[20:23], v[56:59]
    ds_read_b128 a[52:55], v28 offset:3072
    ds_read_b64_tr_b16 v[140:141], v26 offset:0
    v_mfma_f32_16x16x32_bf16 v[60:63], v[108:111], a[24:27], v[60:63]
    buffer_load_dwordx4 v30, s[28:31], s40 offen sc1 lds
    ds_read_b64_tr_b16 v[142:143], v26 offset:1024
    v_mfma_f32_16x16x32_bf16 v[60:63], v[112:115], a[28:31], v[60:63]
    s_addk_i32 m0, 4096
    ds_read_b64_tr_b16 v[144:145], v26 offset:12288
    v_mfma_f32_16x16x32_bf16 v[64:67], v[108:111], a[32:35], v[64:67]
    s_addk_i32 s40, 16384
    ds_read_b64_tr_b16 v[146:147], v26 offset:13312
    ds_read_b128 a[56:59], v28 offset:4096
    v_mfma_f32_16x16x32_bf16 v[64:67], v[112:115], a[36:39], v[64:67]
    buffer_load_dwordx4 v30, s[28:31], s40 offen sc1 lds
    ds_read_b128 a[60:63], v28 offset:5120
    v_mfma_f32_16x16x32_bf16 v[68:71], v[116:119], a[0:3], v[68:71]
    s_addk_i32 m0, 4096
    ds_read_b128 a[64:67], v28 offset:6144
    v_mfma_f32_16x16x32_bf16 v[68:71], v[120:123], a[4:7], v[68:71]
    s_addk_i32 s40, 16384
    s_waitcnt lgkmcnt(14)
    ds_read_b128 a[68:71], v28 offset:7168
    s_waitcnt lgkmcnt(14)
    ds_read_b64_tr_b16 v[148:149], v27 offset:0
    v_mfma_f32_16x16x32_bf16 v[72:75], v[116:119], a[8:11], v[72:75]
    buffer_load_dwordx4 v30, s[28:31], s40 offen sc1 lds
    s_waitcnt lgkmcnt(14)
    ds_read_b64_tr_b16 v[150:151], v27 offset:1024
    v_mfma_f32_16x16x32_bf16 v[72:75], v[120:123], a[12:15], v[72:75]
    s_addk_i32 m0, 4096
    s_waitcnt lgkmcnt(14)
    ds_read_b64_tr_b16 v[152:153], v27 offset:12288
    v_mfma_f32_16x16x32_bf16 v[76:79], v[116:119], a[16:19], v[76:79]
    s_addk_i32 s40, 16384
    s_waitcnt lgkmcnt(14)
    ds_read_b64_tr_b16 v[154:155], v27 offset:13312
    s_waitcnt lgkmcnt(14)
    ds_read_b128 a[72:75], v28 offset:8192
    v_mfma_f32_16x16x32_bf16 v[76:79], v[120:123], a[20:23], v[76:79]
    s_waitcnt lgkmcnt(14)
    ds_read_b128 a[76:79], v28 offset:9216
    v_add_u32 v25, 36864, v25
    v_mfma_f32_16x16x32_bf16 v[80:83], v[116:119], a[24:27], v[80:83]
    buffer_load_dwordx4 v30, s[28:31], s40 offen sc1 lds
    v_add_u32 v26, 36864, v26
    v_mfma_f32_16x16x32_bf16 v[80:83], v[120:123], a[28:31], v[80:83]
    s_add_u32 m0, s68, 0
    v_add_u32 v27, 36864, v27
    v_mfma_f32_16x16x32_bf16 v[84:87], v[116:119], a[32:35], v[84:87]
    s_add_u32 s40, s69, 0
    v_add_u32 v28, 36864, v28
    v_mfma_f32_16x16x32_bf16 v[84:87], v[120:123], a[36:39], v[84:87]
    buffer_load_dwordx4 v4, s[8:11], s40 offen lds
    v_mfma_f32_16x16x32_bf16 v[88:91], v[124:127], a[0:3], v[88:91]
    s_addk_i32 m0, 1024
    v_mfma_f32_16x16x32_bf16 v[88:91], v[128:131], a[4:7], v[88:91]
    s_addk_i32 s40, 4608
    v_mfma_f32_16x16x32_bf16 v[92:95], v[124:127], a[8:11], v[92:95]
    buffer_load_dwordx4 v4, s[8:11], s40 offen lds
    v_mfma_f32_16x16x32_bf16 v[92:95], v[128:131], a[12:15], v[92:95]
    s_addk_i32 m0, 1024
    v_mfma_f32_16x16x32_bf16 v[96:99], v[124:127], a[16:19], v[96:99]
    s_addk_i32 s40, 16128
    v_mfma_f32_16x16x32_bf16 v[96:99], v[128:131], a[20:23], v[96:99]
    v_mfma_f32_16x16x32_bf16 v[100:103], v[124:127], a[24:27], v[100:103]
    buffer_load_dwordx4 v4, s[8:11], s40 offen lds
    v_mfma_f32_16x16x32_bf16 v[100:103], v[128:131], a[28:31], v[100:103]
    s_addk_i32 m0, 1024
    v_mfma_f32_16x16x32_bf16 v[104:107], v[124:127], a[32:35], v[104:107]
    s_addk_i32 s40, 4608
    v_mfma_f32_16x16x32_bf16 v[104:107], v[128:131], a[36:39], v[104:107]
    buffer_load_dwordx4 v4, s[8:11], s40 offen lds
    s_waitcnt vmcnt(18)
    s_waitcnt lgkmcnt(0)
    s_barrier
    v_mfma_f32_16x16x32_bf16 v[48:51], v[132:135], a[40:43], v[48:51]
    buffer_load_dword v36, v14, s[32:35], 0 offen offset:0 sc1
    ds_read_b64_tr_b16 v[108:109], v25 offset:0
    v_mfma_f32_16x16x32_bf16 v[48:51], v[136:139], a[44:47], v[48:51]
    buffer_load_dword v37, v14, s[32:35], 0 offen offset:256 sc1
    ds_read_b64_tr_b16 v[110:111], v25 offset:1024
    v_mfma_f32_16x16x32_bf16 v[52:55], v[132:135], a[48:51], v[52:55]
    buffer_load_dword v38, v14, s[32:35], 0 offen offset:512 sc1
    ds_read_b64_tr_b16 v[112:113], v25 offset:12288
    v_mfma_f32_16x16x32_bf16 v[52:55], v[136:139], a[52:55], v[52:55]
    buffer_load_dword v39, v14, s[32:35], 0 offen offset:768 sc1
    buffer_load_dword v40, v14, s[32:35], 0 offen offset:1024 sc1
    v_mfma_f32_16x16x32_bf16 v[56:59], v[132:135], a[56:59], v[56:59]
    buffer_load_dwordx4 v[240:243], v9, s[12:15], 0 offen
    ds_read_b64_tr_b16 v[114:115], v25 offset:13312
    v_mfma_f32_16x16x32_bf16 v[56:59], v[136:139], a[60:63], v[56:59]
    buffer_load_dwordx4 v[244:247], v10, s[12:15], 0 offen
    ds_read_b128 a[0:3], v28 offset:0
    v_mfma_f32_16x16x32_bf16 v[60:63], v[132:135], a[64:67], v[60:63]
    buffer_load_dwordx4 v[248:251], v11, s[12:15], 0 offen
    ds_read_b128 a[4:7], v28 offset:1024
    v_mfma_f32_16x16x32_bf16 v[60:63], v[136:139], a[68:71], v[60:63]
    s_add_u32 m0, s66, 36864
    ds_read_b128 a[8:11], v28 offset:2048
    v_mfma_f32_16x16x32_bf16 v[64:67], v[132:135], a[72:75], v[64:67]
    s_add_u32 s40, s67, 4096
    ds_read_b128 a[12:15], v28 offset:3072
    v_mfma_f32_16x16x32_bf16 v[64:67], v[136:139], a[76:79], v[64:67]
    buffer_load_dwordx4 v30, s[28:31], s40 offen sc1 lds
    s_addk_i32 m0, 4096
    v_mfma_f32_16x16x32_bf16 v[68:71], v[140:143], a[40:43], v[68:71]
    s_addk_i32 s40, 16384
    ds_read_b64_tr_b16 v[116:117], v26 offset:0
    ds_read_b64_tr_b16 v[118:119], v26 offset:1024
    v_mfma_f32_16x16x32_bf16 v[68:71], v[144:147], a[44:47], v[68:71]
    buffer_load_dwordx4 v30, s[28:31], s40 offen sc1 lds
    ds_read_b64_tr_b16 v[120:121], v26 offset:12288
    v_mfma_f32_16x16x32_bf16 v[72:75], v[140:143], a[48:51], v[72:75]
    s_addk_i32 m0, 4096
    ds_read_b64_tr_b16 v[122:123], v26 offset:13312
    v_mfma_f32_16x16x32_bf16 v[72:75], v[144:147], a[52:55], v[72:75]
    s_addk_i32 s40, 16384
    ds_read_b128 a[16:19], v28 offset:4096
    ds_read_b128 a[20:23], v28 offset:5120
    v_mfma_f32_16x16x32_bf16 v[76:79], v[140:143], a[56:59], v[76:79]
    buffer_load_dwordx4 v30, s[28:31], s40 offen sc1 lds
    ds_read_b128 a[24:27], v28 offset:6144
    v_mfma_f32_16x16x32_bf16 v[76:79], v[144:147], a[60:63], v[76:79]
    s_addk_i32 m0, 4096
    s_addk_i32 s40, 16384
    s_waitcnt lgkmcnt(14)
    ds_read_b128 a[28:31], v28 offset:7168
    v_mfma_f32_16x16x32_bf16 v[80:83], v[140:143], a[64:67], v[80:83]
    buffer_load_dwordx4 v30, s[28:31], s40 offen sc1 lds
    s_waitcnt lgkmcnt(14)
    ds_read_b64_tr_b16 v[124:125], v27 offset:0
    v_mfma_f32_16x16x32_bf16 v[80:83], v[144:147], a[68:71], v[80:83]
    s_addk_i32 m0, 4096
    s_waitcnt lgkmcnt(14)
    ds_read_b64_tr_b16 v[126:127], v27 offset:1024
    v_mfma_f32_16x16x32_bf16 v[84:87], v[140:143], a[72:75], v[84:87]
    s_addk_i32 s40, 16384
    s_waitcnt lgkmcnt(14)
    ds_read_b64_tr_b16 v[128:129], v27 offset:12288
    s_waitcnt lgkmcnt(14)
    ds_read_b64_tr_b16 v[130:131], v27 offset:13312
    v_mfma_f32_16x16x32_bf16 v[84:87], v[144:147], a[76:79], v[84:87]
    buffer_load_dwordx4 v30, s[28:31], s40 offen sc1 lds
    s_waitcnt lgkmcnt(14)
    ds_read_b128 a[32:35], v28 offset:8192
    v_mfma_f32_16x16x32_bf16 v[88:91], v[148:151], a[40:43], v[88:91]
    s_add_u32 m0, s68, 36864
    s_waitcnt lgkmcnt(14)
    ds_read_b128 a[36:39], v28 offset:9216
    v_mfma_f32_16x16x32_bf16 v[88:91], v[152:155], a[44:47], v[88:91]
    s_add_u32 s40, s69, 165888
    buffer_load_dwordx4 v4, s[8:11], s40 offen lds
    v_add_u32 v25, 36864, v25
    v_add_u32 v26, 36864, v26
    v_add_u32 v27, 36864, v27
    v_add_u32 v28, 36864, v28
    v_mfma_f32_16x16x32_bf16 v[92:95], v[148:151], a[48:51], v[92:95]
    s_addk_i32 m0, 1024
    v_mfma_f32_16x16x32_bf16 v[92:95], v[152:155], a[52:55], v[92:95]
    s_addk_i32 s40, 4608
    v_mfma_f32_16x16x32_bf16 v[96:99], v[148:151], a[56:59], v[96:99]
    buffer_load_dwordx4 v4, s[8:11], s40 offen lds
    v_mfma_f32_16x16x32_bf16 v[96:99], v[152:155], a[60:63], v[96:99]
    s_addk_i32 m0, 1024
    v_mfma_f32_16x16x32_bf16 v[100:103], v[148:151], a[64:67], v[100:103]
    s_addk_i32 s40, 16128
    v_mfma_f32_16x16x32_bf16 v[100:103], v[152:155], a[68:71], v[100:103]
    buffer_load_dwordx4 v4, s[8:11], s40 offen lds
    s_addk_i32 m0, 1024
    v_mfma_f32_16x16x32_bf16 v[104:107], v[148:151], a[72:75], v[104:107]
    s_addk_i32 s40, 4608
    v_mfma_f32_16x16x32_bf16 v[104:107], v[152:155], a[76:79], v[104:107]
    buffer_load_dwordx4 v4, s[8:11], s40 offen lds
    s_waitcnt vmcnt(26)
    s_waitcnt lgkmcnt(0)
    s_barrier
    v_mfma_f32_16x16x32_bf16 v[48:51], v[108:111], a[0:3], v[48:51]
    s_add_u32 m0, s66, 73728
    ds_read_b64_tr_b16 v[132:133], v25 offset:0
    v_mfma_f32_16x16x32_bf16 v[48:51], v[112:115], a[4:7], v[48:51]
    s_add_u32 s40, s67, 8192
    ds_read_b64_tr_b16 v[134:135], v25 offset:1024
    v_mfma_f32_16x16x32_bf16 v[52:55], v[108:111], a[8:11], v[52:55]
    buffer_load_dwordx4 v30, s[28:31], s40 offen sc1 lds
    ds_read_b64_tr_b16 v[136:137], v25 offset:12288
    v_mfma_f32_16x16x32_bf16 v[52:55], v[112:115], a[12:15], v[52:55]
    s_addk_i32 m0, 4096
    ds_read_b64_tr_b16 v[138:139], v25 offset:13312
    v_mfma_f32_16x16x32_bf16 v[56:59], v[108:111], a[16:19], v[56:59]
    s_addk_i32 s40, 16384
    ds_read_b128 a[40:43], v28 offset:0
    ds_read_b128 a[44:47], v28 offset:1024
    v_mfma_f32_16x16x32_bf16 v[56:59], v[112:115], a[20:23], v[56:59]
    ds_read_b128 a[48:51], v28 offset:2048
    ds_read_b128 a[52:55], v28 offset:3072
    v_mfma_f32_16x16x32_bf16 v[60:63], v[108:111], a[24:27], v[60:63]
    buffer_load_dwordx4 v30, s[28:31], s40 offen sc1 lds
    ds_read_b64_tr_b16 v[140:141], v26 offset:0
    v_mfma_f32_16x16x32_bf16 v[60:63], v[112:115], a[28:31], v[60:63]
    s_addk_i32 m0, 4096
    ds_read_b64_tr_b16 v[142:143], v26 offset:1024
    v_mfma_f32_16x16x32_bf16 v[64:67], v[108:111], a[32:35], v[64:67]
    s_addk_i32 s40, 16384
    ds_read_b64_tr_b16 v[144:145], v26 offset:12288
    ds_read_b64_tr_b16 v[146:147], v26 offset:13312
    v_mfma_f32_16x16x32_bf16 v[64:67], v[112:115], a[36:39], v[64:67]
    buffer_load_dwordx4 v30, s[28:31], s40 offen sc1 lds
    ds_read_b128 a[56:59], v28 offset:4096
    v_mfma_f32_16x16x32_bf16 v[68:71], v[116:119], a[0:3], v[68:71]
    s_addk_i32 m0, 4096
    ds_read_b128 a[60:63], v28 offset:5120
    v_mfma_f32_16x16x32_bf16 v[68:71], v[120:123], a[4:7], v[68:71]
    s_addk_i32 s40, 16384
    ds_read_b128 a[64:67], v28 offset:6144
    s_waitcnt lgkmcnt(14)
    ds_read_b128 a[68:71], v28 offset:7168
    v_mfma_f32_16x16x32_bf16 v[72:75], v[116:119], a[8:11], v[72:75]
    buffer_load_dwordx4 v30, s[28:31], s40 offen sc1 lds
    s_waitcnt lgkmcnt(14)
    ds_read_b64_tr_b16 v[148:149], v27 offset:0
    v_mfma_f32_16x16x32_bf16 v[72:75], v[120:123], a[12:15], v[72:75]
    s_addk_i32 m0, 4096
    s_waitcnt lgkmcnt(14)
    ds_read_b64_tr_b16 v[150:151], v27 offset:1024
    v_mfma_f32_16x16x32_bf16 v[76:79], v[116:119], a[16:19], v[76:79]
    s_addk_i32 s40, 16384
    s_waitcnt lgkmcnt(14)
    ds_read_b64_tr_b16 v[152:153], v27 offset:12288
    s_waitcnt lgkmcnt(14)
    ds_read_b64_tr_b16 v[154:155], v27 offset:13312
    v_mfma_f32_16x16x32_bf16 v[76:79], v[120:123], a[20:23], v[76:79]
    s_waitcnt lgkmcnt(14)
    ds_read_b128 a[72:75], v28 offset:8192
    s_waitcnt lgkmcnt(14)
    ds_read_b128 a[76:79], v28 offset:9216
    v_mfma_f32_16x16x32_bf16 v[80:83], v[116:119], a[24:27], v[80:83]
    buffer_load_dwordx4 v30, s[28:31], s40 offen sc1 lds
    v_add_u32 v25, 4294856704, v25
    v_mfma_f32_16x16x32_bf16 v[80:83], v[120:123], a[28:31], v[80:83]
    s_add_u32 m0, s68, 73728
    v_add_u32 v26, 4294856704, v26
    v_mfma_f32_16x16x32_bf16 v[84:87], v[116:119], a[32:35], v[84:87]
    s_add_u32 s40, s69, 331776
    v_add_u32 v27, 4294856704, v27
    v_mfma_f32_16x16x32_bf16 v[84:87], v[120:123], a[36:39], v[84:87]
    buffer_load_dwordx4 v4, s[8:11], s40 offen lds
    v_add_u32 v28, 4294856704, v28
    v_mfma_f32_16x16x32_bf16 v[88:91], v[124:127], a[0:3], v[88:91]
    s_addk_i32 m0, 1024
    v_mfma_f32_16x16x32_bf16 v[88:91], v[128:131], a[4:7], v[88:91]
    s_addk_i32 s40, 4608
    v_mfma_f32_16x16x32_bf16 v[92:95], v[124:127], a[8:11], v[92:95]
    buffer_load_dwordx4 v4, s[8:11], s40 offen lds
    v_mfma_f32_16x16x32_bf16 v[92:95], v[128:131], a[12:15], v[92:95]
    s_addk_i32 m0, 1024
    v_mfma_f32_16x16x32_bf16 v[96:99], v[124:127], a[16:19], v[96:99]
    s_addk_i32 s40, 16128
    v_mfma_f32_16x16x32_bf16 v[96:99], v[128:131], a[20:23], v[96:99]
    v_mfma_f32_16x16x32_bf16 v[100:103], v[124:127], a[24:27], v[100:103]
    buffer_load_dwordx4 v4, s[8:11], s40 offen lds
    v_mfma_f32_16x16x32_bf16 v[100:103], v[128:131], a[28:31], v[100:103]
    s_addk_i32 m0, 1024
    v_mfma_f32_16x16x32_bf16 v[104:107], v[124:127], a[32:35], v[104:107]
    s_addk_i32 s40, 4608
    v_mfma_f32_16x16x32_bf16 v[104:107], v[128:131], a[36:39], v[104:107]
    buffer_load_dwordx4 v4, s[8:11], s40 offen lds
    s_waitcnt vmcnt(26)
    s_waitcnt lgkmcnt(0)
    s_barrier
    v_mfma_f32_16x16x32_bf16 v[48:51], v[132:135], a[40:43], v[48:51]
    s_add_u32 m0, s66, 110592
    ds_read_b64_tr_b16 v[108:109], v29 offset:20480
    v_mfma_f32_16x16x32_bf16 v[48:51], v[136:139], a[44:47], v[48:51]
    s_add_u32 s40, s67, 12288
    ds_read_b64_tr_b16 v[110:111], v29 offset:21504
    v_mfma_f32_16x16x32_bf16 v[52:55], v[132:135], a[48:51], v[52:55]
    buffer_load_dwordx4 v30, s[28:31], s40 offen sc1 lds
    ds_read_b128 a[80:83], v28 offset:0
    v_mfma_f32_16x16x32_bf16 v[52:55], v[136:139], a[52:55], v[52:55]
    s_addk_i32 m0, 4096
    ds_read_b128 a[96:99], v28 offset:4096
    v_mfma_f32_16x16x32_bf16 v[56:59], v[132:135], a[56:59], v[56:59]
    s_addk_i32 s40, 16384
    ds_read_b128 a[112:115], v28 offset:8192
    ds_read_b128 a[128:131], v28 offset:12288
    v_mfma_f32_16x16x32_bf16 v[56:59], v[136:139], a[60:63], v[56:59]
    ds_read_b128 a[144:147], v28 offset:16384
    ds_read_b64_tr_b16 v[112:113], v29 offset:24576
    v_mfma_f32_16x16x32_bf16 v[60:63], v[132:135], a[64:67], v[60:63]
    buffer_load_dwordx4 v30, s[28:31], s40 offen sc1 lds
    ds_read_b64_tr_b16 v[114:115], v29 offset:25600
    v_mfma_f32_16x16x32_bf16 v[60:63], v[136:139], a[68:71], v[60:63]
    s_addk_i32 m0, 4096
    ds_read_b128 a[84:87], v28 offset:1024
    v_mfma_f32_16x16x32_bf16 v[64:67], v[132:135], a[72:75], v[64:67]
    s_addk_i32 s40, 16384
    ds_read_b128 a[100:103], v28 offset:5120
    ds_read_b128 a[116:119], v28 offset:9216
    v_mfma_f32_16x16x32_bf16 v[64:67], v[136:139], a[76:79], v[64:67]
    buffer_load_dwordx4 v30, s[28:31], s40 offen sc1 lds
    ds_read_b128 a[132:135], v28 offset:13312
    v_mfma_f32_16x16x32_bf16 v[68:71], v[140:143], a[40:43], v[68:71]
    s_addk_i32 m0, 4096
    ds_read_b128 a[148:151], v28 offset:17408
    v_mfma_f32_16x16x32_bf16 v[68:71], v[144:147], a[44:47], v[68:71]
    s_addk_i32 s40, 16384
    ds_read_b64_tr_b16 v[116:117], v29 offset:28672
    s_waitcnt lgkmcnt(14)
    ds_read_b64_tr_b16 v[118:119], v29 offset:29696
    v_mfma_f32_16x16x32_bf16 v[72:75], v[140:143], a[48:51], v[72:75]
    buffer_load_dwordx4 v30, s[28:31], s40 offen sc1 lds
    s_waitcnt lgkmcnt(14)
    ds_read_b128 a[88:91], v28 offset:2048
    v_mfma_f32_16x16x32_bf16 v[72:75], v[144:147], a[52:55], v[72:75]
    s_addk_i32 m0, 4096
    s_waitcnt lgkmcnt(14)
    ds_read_b128 a[104:107], v28 offset:6144
    v_mfma_f32_16x16x32_bf16 v[76:79], v[140:143], a[56:59], v[76:79]
    s_addk_i32 s40, 16384
    s_waitcnt lgkmcnt(14)
    ds_read_b128 a[120:123], v28 offset:10240
    s_waitcnt lgkmcnt(14)
    ds_read_b128 a[136:139], v28 offset:14336
    v_mfma_f32_16x16x32_bf16 v[76:79], v[144:147], a[60:63], v[76:79]
    s_waitcnt lgkmcnt(14)
    ds_read_b128 a[152:155], v28 offset:18432
    s_waitcnt lgkmcnt(14)
    ds_read_b64_tr_b16 v[120:121], v29 offset:32768
    v_mfma_f32_16x16x32_bf16 v[80:83], v[140:143], a[64:67], v[80:83]
    buffer_load_dwordx4 v30, s[28:31], s40 offen sc1 lds
    v_cvt_pk_bf16_f32 v180, v48, v49
    v_mfma_f32_16x16x32_bf16 v[80:83], v[144:147], a[68:71], v[80:83]
    s_add_u32 m0, s68, 110592
    s_waitcnt lgkmcnt(14)
    ds_read_b64_tr_b16 v[122:123], v29 offset:33792
    v_mfma_f32_16x16x32_bf16 v[84:87], v[140:143], a[72:75], v[84:87]
    s_add_u32 s40, s69, 497664
    s_waitcnt lgkmcnt(14)
    ds_read_b128 a[92:95], v28 offset:3072
    v_mfma_f32_16x16x32_bf16 v[84:87], v[144:147], a[76:79], v[84:87]
    buffer_load_dwordx4 v4, s[8:11], s40 offen lds
    s_waitcnt lgkmcnt(14)
    ds_read_b128 a[108:111], v28 offset:7168
    v_mfma_f32_16x16x32_bf16 v[88:91], v[148:151], a[40:43], v[88:91]
    s_addk_i32 m0, 1024
    s_waitcnt lgkmcnt(14)
    ds_read_b128 a[124:127], v28 offset:11264
    v_mfma_f32_16x16x32_bf16 v[88:91], v[152:155], a[44:47], v[88:91]
    s_addk_i32 s40, 4608
    s_waitcnt lgkmcnt(14)
    ds_read_b128 a[140:143], v28 offset:15360
    s_waitcnt lgkmcnt(14)
    ds_read_b128 a[156:159], v28 offset:19456
    v_add_u32 v29, 36864, v29
    v_add_u32 v28, 36864, v28
    v_mfma_f32_16x16x32_bf16 v[92:95], v[148:151], a[48:51], v[92:95]
    buffer_load_dwordx4 v4, s[8:11], s40 offen lds
    v_cvt_pk_bf16_f32 v200, v68, v69
    v_mfma_f32_16x16x32_bf16 v[92:95], v[152:155], a[52:55], v[92:95]
    s_addk_i32 m0, 1024
    v_cvt_pk_bf16_f32 v181, v50, v51
    v_mfma_f32_16x16x32_bf16 v[96:99], v[148:151], a[56:59], v[96:99]
    s_addk_i32 s40, 16128
    v_cvt_pk_bf16_f32 v201, v70, v71
    buffer_store_dwordx4 v[180:183], v30, s[24:27], s60 offen sc1
    v_mfma_f32_16x16x32_bf16 v[96:99], v[152:155], a[60:63], v[96:99]
    s_addk_i32 s60, 4096
    buffer_store_dwordx4 v[200:203], v30, s[24:27], s62 offen sc1
    s_addk_i32 s62, 4096
    v_mfma_f32_16x16x32_bf16 v[100:103], v[148:151], a[64:67], v[100:103]
    buffer_load_dwordx4 v4, s[8:11], s40 offen lds
    v_cvt_pk_bf16_f32 v184, v52, v53
    v_mfma_f32_16x16x32_bf16 v[100:103], v[152:155], a[68:71], v[100:103]
    s_addk_i32 m0, 1024
    v_cvt_pk_bf16_f32 v204, v72, v73
    v_mfma_f32_16x16x32_bf16 v[104:107], v[148:151], a[72:75], v[104:107]
    s_addk_i32 s40, 4608
    v_cvt_pk_bf16_f32 v185, v54, v55
    v_cvt_pk_bf16_f32 v205, v74, v75
    v_mfma_f32_16x16x32_bf16 v[104:107], v[152:155], a[76:79], v[104:107]
    buffer_load_dwordx4 v4, s[8:11], s40 offen lds
    buffer_store_dwordx4 v[184:187], v30, s[24:27], s60 offen sc1
    buffer_store_dwordx4 v[204:207], v30, s[24:27], s62 offen sc1
    s_addk_i32 s60, 4096
    s_addk_i32 s62, 4096
    v_cvt_pk_bf16_f32 v188, v56, v57
    v_cvt_pk_bf16_f32 v208, v76, v77
    v_cvt_pk_bf16_f32 v189, v58, v59
    v_cvt_pk_bf16_f32 v209, v78, v79
    buffer_store_dwordx4 v[188:191], v30, s[24:27], s60 offen sc1
    buffer_store_dwordx4 v[208:211], v30, s[24:27], s62 offen sc1
    s_addk_i32 s60, 4096
    s_addk_i32 s62, 4096
    v_cvt_pk_bf16_f32 v192, v60, v61
    v_cvt_pk_bf16_f32 v212, v80, v81
    v_cvt_pk_bf16_f32 v193, v62, v63
    v_cvt_pk_bf16_f32 v213, v82, v83
    buffer_store_dwordx4 v[192:195], v30, s[24:27], s60 offen sc1
    buffer_store_dwordx4 v[212:215], v30, s[24:27], s62 offen sc1
    s_addk_i32 s60, 4096
    s_addk_i32 s62, 4096
    v_cvt_pk_bf16_f32 v196, v64, v65
    v_cvt_pk_bf16_f32 v216, v84, v85
    v_cvt_pk_bf16_f32 v197, v66, v67
    v_cvt_pk_bf16_f32 v217, v86, v87
    buffer_store_dwordx4 v[196:199], v30, s[24:27], s60 offen sc1
    buffer_store_dwordx4 v[216:219], v30, s[24:27], s62 offen sc1
    s_waitcnt vmcnt(28)
    s_waitcnt lgkmcnt(0)
    s_barrier
    v_mfma_f32_16x16x32_bf16 v[160:163], v[108:111], a[80:83], 0
    s_add_u32 m0, s66, 0
    v_cvt_pk_bf16_f32 v220, v88, v89
    v_mfma_f32_16x16x32_bf16 v[160:163], v[112:115], a[84:87], v[160:163]
    s_add_u32 s40, s3, 0
    v_cvt_pk_bf16_f32 v221, v90, v91
    ds_read_b64_tr_b16 v[132:133], v29 offset:20480
    v_mfma_f32_16x16x32_bf16 v[160:163], v[116:119], a[88:91], v[160:163]
    buffer_store_dwordx4 v[220:223], v30, s[24:27], s64 offen sc1
    ds_read_b64_tr_b16 v[134:135], v29 offset:21504
    v_mfma_f32_16x16x32_bf16 v[160:163], v[120:123], a[92:95], v[160:163]
    s_addk_i32 s64, 4096
    buffer_load_dwordx4 v6, s[28:31], s40 offen sc1 lds
    v_mfma_f32_16x16x32_bf16 v[164:167], v[108:111], a[96:99], 0
    s_addk_i32 m0, 4096
    v_cvt_pk_bf16_f32 v224, v92, v93
    ds_read_b128 a[160:163], v28 offset:0
    v_mfma_f32_16x16x32_bf16 v[164:167], v[112:115], a[100:103], v[164:167]
    s_add_u32 s40, s3, 4096
    v_cvt_pk_bf16_f32 v225, v94, v95
    v_mfma_f32_16x16x32_bf16 v[164:167], v[116:119], a[104:107], v[164:167]
    buffer_store_dwordx4 v[224:227], v30, s[24:27], s64 offen sc1
    ds_read_b128 a[176:179], v28 offset:4096
    v_mfma_f32_16x16x32_bf16 v[164:167], v[120:123], a[108:111], v[164:167]
    s_addk_i32 s64, 4096
    buffer_load_dwordx4 v6, s[28:31], s40 offen sc1 lds
    v_mfma_f32_16x16x32_bf16 v[168:171], v[108:111], a[112:115], 0
    s_addk_i32 m0, 4096
    v_cvt_pk_bf16_f32 v228, v96, v97
    ds_read_b128 a[192:195], v28 offset:8192
    v_mfma_f32_16x16x32_bf16 v[168:171], v[112:115], a[116:119], v[168:171]
    s_add_u32 s40, s3, 8192
    v_cvt_pk_bf16_f32 v229, v98, v99
    v_mfma_f32_16x16x32_bf16 v[168:171], v[116:119], a[120:123], v[168:171]
    ds_read_b128 a[208:211], v28 offset:12288
    ds_read_b128 a[224:227], v28 offset:16384
    v_mfma_f32_16x16x32_bf16 v[168:171], v[120:123], a[124:127], v[168:171]
    buffer_store_dwordx4 v[228:231], v30, s[24:27], s64 offen sc1
    buffer_load_dwordx4 v6, s[28:31], s40 offen sc1 lds
    v_mfma_f32_16x16x32_bf16 v[172:175], v[108:111], a[128:131], 0
    s_addk_i32 s64, 4096
    s_add_u32 m0, s39, 0
    ds_read_b64_tr_b16 v[136:137], v29 offset:24576
    v_mfma_f32_16x16x32_bf16 v[172:175], v[112:115], a[132:135], v[172:175]
    s_add_u32 s40, s44, 0
    v_cvt_pk_bf16_f32 v232, v100, v101
    v_mfma_f32_16x16x32_bf16 v[172:175], v[116:119], a[136:139], v[172:175]
    v_cvt_pk_bf16_f32 v233, v102, v103
    ds_read_b64_tr_b16 v[138:139], v29 offset:25600
    ds_read_b128 a[164:167], v28 offset:1024
    ds_read_b128 a[180:183], v28 offset:5120
    ds_read_b128 a[196:199], v28 offset:9216
    ds_read_b128 a[212:215], v28 offset:13312
    ds_read_b128 a[228:231], v28 offset:17408
    ds_read_b64_tr_b16 v[140:141], v29 offset:28672
    s_waitcnt lgkmcnt(14)
    ds_read_b64_tr_b16 v[142:143], v29 offset:29696
    s_waitcnt lgkmcnt(14)
    ds_read_b128 a[168:171], v28 offset:2048
    s_waitcnt lgkmcnt(14)
    ds_read_b128 a[184:187], v28 offset:6144
    s_waitcnt lgkmcnt(14)
    ds_read_b128 a[200:203], v28 offset:10240
    s_waitcnt lgkmcnt(14)
    ds_read_b128 a[216:219], v28 offset:14336
    s_waitcnt lgkmcnt(14)
    ds_read_b128 a[232:235], v28 offset:18432
    s_waitcnt lgkmcnt(14)
    ds_read_b64_tr_b16 v[144:145], v29 offset:32768
    s_waitcnt lgkmcnt(14)
    ds_read_b64_tr_b16 v[146:147], v29 offset:33792
    s_waitcnt lgkmcnt(14)
    ds_read_b128 a[172:175], v28 offset:3072
    s_waitcnt lgkmcnt(14)
    ds_read_b128 a[188:191], v28 offset:7168
    s_waitcnt lgkmcnt(14)
    ds_read_b128 a[204:207], v28 offset:11264
    s_waitcnt lgkmcnt(14)
    ds_read_b128 a[220:223], v28 offset:15360
    s_waitcnt lgkmcnt(14)
    ds_read_b128 a[236:239], v28 offset:19456
    v_add_u32 v29, 36864, v29
    v_add_u32 v28, 36864, v28
    v_mfma_f32_16x16x32_bf16 v[172:175], v[120:123], a[140:143], v[172:175]
    buffer_store_dwordx4 v[232:235], v30, s[24:27], s64 offen sc1
    buffer_load_dwordx4 v5, s[8:11], s40 offen lds
    v_mfma_f32_16x16x32_bf16 v[176:179], v[108:111], a[144:147], 0
    s_addk_i32 s64, 4096
    s_add_u32 m0, s39, 1024
    v_mfma_f32_16x16x32_bf16 v[176:179], v[112:115], a[148:151], v[176:179]
    s_add_u32 s40, s44, 41472
    v_cvt_pk_bf16_f32 v236, v104, v105
    v_mfma_f32_16x16x32_bf16 v[176:179], v[116:119], a[152:155], v[176:179]
    v_cvt_pk_bf16_f32 v237, v106, v107
    v_mfma_f32_16x16x32_bf16 v[176:179], v[120:123], a[156:159], v[176:179]
    buffer_store_dwordx4 v[236:239], v30, s[24:27], s64 offen sc1
    buffer_load_dwordx4 v5, s[8:11], s40 offen lds
    s_waitcnt vmcnt(29)
    s_waitcnt lgkmcnt(0)
    s_barrier
    s_cmp_lt_u32 s60, 2146435072
    s_cbranch_scc1 LB_x0
    s_mul_i32 s40, s36, 3
    s_add_u32 s40, s40, 0
    s_and_b32 s40, s40, 3
    s_lshl_b32 s40, s40, 10
    s_add_u32 s40, s40, 36864
    v_add_u32 v34, s40, v30
    ds_write_b128 v34, v[48:51] offset:0
    ds_write_b128 v34, v[52:55] offset:4096
    ds_write_b128 v34, v[56:59] offset:8192
    ds_write_b128 v34, v[60:63] offset:12288
    ds_write_b128 v34, v[64:67] offset:16384
LB_x0:
    s_cmp_lt_u32 s62, 2146435072
    s_cbranch_scc1 LB_x1
    s_mul_i32 s40, s36, 3
    s_add_u32 s40, s40, 1
    s_and_b32 s40, s40, 3
    s_lshl_b32 s40, s40, 10
    s_add_u32 s40, s40, 36864
    v_add_u32 v34, s40, v30
    ds_write_b128 v34, v[68:71] offset:0
    ds_write_b128 v34, v[72:75] offset:4096
    ds_write_b128 v34, v[76:79] offset:8192
    ds_write_b128 v34, v[80:83] offset:12288
    ds_write_b128 v34, v[84:87] offset:16384
LB_x1:
    s_cmp_lt_u32 s64, 2146435072
    s_cbranch_scc1 LB_x2
    s_mul_i32 s40, s36, 3
    s_add_u32 s40, s40, 2
    s_and_b32 s40, s40, 3
    s_lshl_b32 s40, s40, 10
    s_add_u32 s40, s40, 36864
    v_add_u32 v34, s40, v30
    ds_write_b128 v34, v[88:91] offset:0
    ds_write_b128 v34, v[92:95] offset:4096
    ds_write_b128 v34, v[96:99] offset:8192
    ds_write_b128 v34, v[100:103] offset:12288
    ds_write_b128 v34, v[104:107] offset:16384
LB_x2:
    v_mfma_f32_16x16x32_bf16 v[160:163], v[132:135], a[160:163], v[160:163]
    ds_read_b64_tr_b16 v[108:109], v29 offset:20480
    ds_read_b64_tr_b16 v[110:111], v29 offset:21504
    v_mfma_f32_16x16x32_bf16 v[160:163], v[136:139], a[164:167], v[160:163]
    ds_read_b128 a[80:83], v28 offset:0
    ds_read_b128 a[96:99], v28 offset:4096
    v_mfma_f32_16x16x32_bf16 v[160:163], v[140:143], a[168:171], v[160:163]
    ds_read_b128 a[112:115], v28 offset:8192
    ds_read_b128 a[128:131], v28 offset:12288
    v_mfma_f32_16x16x32_bf16 v[160:163], v[144:147], a[172:175], v[160:163]
    ds_read_b128 a[144:147], v28 offset:16384
    ds_read_b64_tr_b16 v[112:113], v29 offset:24576
    v_mfma_f32_16x16x32_bf16 v[164:167], v[132:135], a[176:179], v[164:167]
    ds_read_b64_tr_b16 v[114:115], v29 offset:25600
    ds_read_b128 a[84:87], v28 offset:1024
    v_mfma_f32_16x16x32_bf16 v[164:167], v[136:139], a[180:183], v[164:167]
    ds_read_b128 a[100:103], v28 offset:5120
    ds_read_b128 a[116:119], v28 offset:9216
    v_mfma_f32_16x16x32_bf16 v[164:167], v[140:143], a[184:187], v[164:167]
    ds_read_b128 a[132:135], v28 offset:13312
    ds_read_b128 a[148:151], v28 offset:17408
    v_mfma_f32_16x16x32_bf16 v[164:167], v[144:147], a[188:191], v[164:167]
    ds_read_b64_tr_b16 v[116:117], v29 offset:28672
    s_waitcnt lgkmcnt(14)
    ds_read_b64_tr_b16 v[118:119], v29 offset:29696
    v_mfma_f32_16x16x32_bf16 v[168:171], v[132:135], a[192:195], v[168:171]
    s_waitcnt lgkmcnt(14)
    ds_read_b128 a[88:91], v28 offset:2048
    s_waitcnt lgkmcnt(14)
    ds_read_b128 a[104:107], v28 offset:6144
    v_mfma_f32_16x16x32_bf16 v[168:171], v[136:139], a[196:199], v[168:171]
    s_waitcnt lgkmcnt(14)
    ds_read_b128 a[120:123], v28 offset:10240
    s_waitcnt lgkmcnt(14)
    ds_read_b128 a[136:139], v28 offset:14336
    v_mfma_f32_16x16x32_bf16 v[168:171], v[140:143], a[200:203], v[168:171]
    s_waitcnt lgkmcnt(14)
    ds_read_b128 a[152:155], v28 offset:18432
    s_waitcnt lgkmcnt(14)
    ds_read_b64_tr_b16 v[120:121], v29 offset:32768
    v_mfma_f32_16x16x32_bf16 v[168:171], v[144:147], a[204:207], v[168:171]
    s_waitcnt lgkmcnt(14)
    ds_read_b64_tr_b16 v[122:123], v29 offset:33792
    s_waitcnt lgkmcnt(14)
    ds_read_b128 a[92:95], v28 offset:3072
    v_mfma_f32_16x16x32_bf16 v[172:175], v[132:135], a[208:211], v[172:175]
    s_waitcnt lgkmcnt(14)
    ds_read_b128 a[108:111], v28 offset:7168
    s_waitcnt lgkmcnt(14)
    ds_read_b128 a[124:127], v28 offset:11264
    v_mfma_f32_16x16x32_bf16 v[172:175], v[136:139], a[212:215], v[172:175]
    s_waitcnt lgkmcnt(14)
    ds_read_b128 a[140:143], v28 offset:15360
    s_waitcnt lgkmcnt(14)
    ds_read_b128 a[156:159], v28 offset:19456
    v_mfma_f32_16x16x32_bf16 v[172:175], v[140:143], a[216:219], v[172:175]
    v_add_u32 v29, 36864, v29
    v_add_u32 v28, 36864, v28
    v_mfma_f32_16x16x32_bf16 v[172:175], v[144:147], a[220:223], v[172:175]
    v_mfma_f32_16x16x32_bf16 v[176:179], v[132:135], a[224:227], v[176:179]
    v_mfma_f32_16x16x32_bf16 v[176:179], v[136:139], a[228:231], v[176:179]
    v_mfma_f32_16x16x32_bf16 v[176:179], v[140:143], a[232:235], v[176:179]
    v_mfma_f32_16x16x32_bf16 v[176:179], v[144:147], a[236:239], v[176:179]
    s_waitcnt vmcnt(18)
    s_waitcnt lgkmcnt(0)
    s_barrier
    v_mfma_f32_16x16x32_bf16 v[160:163], v[108:111], a[80:83], v[160:163]
    s_mul_i32 s40, s101, 40960
    ds_read_b64_tr_b16 v[132:133], v29 offset:20480
    v_mfma_f32_16x16x32_bf16 v[160:163], v[112:115], a[84:87], v[160:163]
    s_add_u32 s40, s40, s56
    ds_read_b64_tr_b16 v[134:135], v29 offset:21504
    v_mfma_f32_16x16x32_bf16 v[160:163], v[116:119], a[88:91], v[160:163]
    s_add_u32 s40, s40, s66
    ds_read_b128 a[160:163], v28 offset:0
    ds_read_b128 a[176:179], v28 offset:4096
    v_mfma_f32_16x16x32_bf16 v[160:163], v[120:123], a[92:95], v[160:163]
    s_add_u32 s41, s40, 4096
    ds_read_b128 a[192:195], v28 offset:8192
    v_mfma_f32_16x16x32_bf16 v[164:167], v[108:111], a[96:99], v[164:167]
    s_add_u32 s42, s40, 8192
    ds_read_b128 a[208:211], v28 offset:12288
    v_mfma_f32_16x16x32_bf16 v[164:167], v[112:115], a[100:103], v[164:167]
    s_add_u32 s43, s40, 12288
    ds_read_b128 a[224:227], v28 offset:16384
    v_mfma_f32_16x16x32_bf16 v[164:167], v[116:119], a[104:107], v[164:167]
    s_add_u32 s54, s40, 16384
    ds_read_b64_tr_b16 v[136:137], v29 offset:24576
    v_mfma_f32_16x16x32_bf16 v[164:167], v[120:123], a[108:111], v[164:167]
    v_mov_b32 v16, v30
    ds_read_b64_tr_b16 v[138:139], v29 offset:25600
    v_mfma_f32_16x16x32_bf16 v[168:171], v[108:111], a[112:115], v[168:171]
    v_add_u32 v17, 20480, v30
    ds_read_b128 a[164:167], v28 offset:1024
    v_mfma_f32_16x16x32_bf16 v[168:171], v[112:115], a[116:119], v[168:171]
    buffer_load_dwordx4 v[180:183], v16, s[24:27], s40 offen sc1
    ds_read_b128 a[180:183], v28 offset:5120
    v_mfma_f32_16x16x32_bf16 v[168:171], v[116:119], a[120:123], v[168:171]
    ds_read_b128 a[196:199], v28 offset:9216
    ds_read_b128 a[212:215], v28 offset:13312
    v_mfma_f32_16x16x32_bf16 v[168:171], v[120:123], a[124:127], v[168:171]
    buffer_load_dwordx4 v[184:187], v16, s[24:27], s41 offen sc1
    ds_read_b128 a[228:231], v28 offset:17408
    v_mfma_f32_16x16x32_bf16 v[172:175], v[108:111], a[128:131], v[172:175]
    buffer_load_dwordx4 v[188:191], v16, s[24:27], s42 offen sc1
    ds_read_b64_tr_b16 v[140:141], v29 offset:28672
    v_mfma_f32_16x16x32_bf16 v[172:175], v[112:115], a[132:135], v[172:175]
    buffer_load_dwordx4 v[192:195], v16, s[24:27], s43 offen sc1
    s_waitcnt lgkmcnt(14)
    ds_read_b64_tr_b16 v[142:143], v29 offset:29696
    v_mfma_f32_16x16x32_bf16 v[172:175], v[116:119], a[136:139], v[172:175]
    buffer_load_dwordx4 v[196:199], v16, s[24:27], s54 offen sc1
    s_waitcnt lgkmcnt(14)
    ds_read_b128 a[168:171], v28 offset:2048
    s_waitcnt lgkmcnt(14)
    ds_read_b128 a[184:187], v28 offset:6144
    s_waitcnt lgkmcnt(14)
    ds_read_b128 a[200:203], v28 offset:10240
    s_waitcnt lgkmcnt(14)
    ds_read_b128 a[216:219], v28 offset:14336
    s_waitcnt lgkmcnt(14)
    ds_read_b128 a[232:235], v28 offset:18432
    s_waitcnt lgkmcnt(14)
    ds_read_b64_tr_b16 v[144:145], v29 offset:32768
    s_waitcnt lgkmcnt(14)
    ds_read_b64_tr_b16 v[146:147], v29 offset:33792
    s_waitcnt lgkmcnt(14)
    ds_read_b128 a[172:175], v28 offset:3072
    s_waitcnt lgkmcnt(14)
    ds_read_b128 a[188:191], v28 offset:7168
    s_waitcnt lgkmcnt(14)
    ds_read_b128 a[204:207], v28 offset:11264
    s_waitcnt lgkmcnt(14)
    ds_read_b128 a[220:223], v28 offset:15360
    s_waitcnt lgkmcnt(14)
    ds_read_b128 a[236:239], v28 offset:19456
    v_add_u32 v29, 4294856704, v29
    v_add_u32 v28, 4294856704, v28
    s_add_u32 s57, s66, 36864
    v_add_u32 v18, s57, v30
    s_waitcnt lgkmcnt(14)
    ds_read_b128 v[220:223], v18 offset:0
    s_waitcnt lgkmcnt(14)
    ds_read_b128 v[224:227], v18 offset:4096
    s_waitcnt lgkmcnt(14)
    ds_read_b128 v[228:231], v18 offset:8192
    s_waitcnt lgkmcnt(14)
    ds_read_b128 v[232:235], v18 offset:12288
    s_waitcnt lgkmcnt(14)
    ds_read_b128 v[236:239], v18 offset:16384
    v_mfma_f32_16x16x32_bf16 v[172:175], v[120:123], a[140:143], v[172:175]
    buffer_load_dwordx4 v[200:203], v17, s[24:27], s40 offen sc1
    v_mfma_f32_16x16x32_bf16 v[176:179], v[108:111], a[144:147], v[176:179]
    buffer_load_dwordx4 v[204:207], v17, s[24:27], s41 offen sc1
    v_mfma_f32_16x16x32_bf16 v[176:179], v[112:115], a[148:151], v[176:179]
    buffer_load_dwordx4 v[208:211], v17, s[24:27], s42 offen sc1
    v_mfma_f32_16x16x32_bf16 v[176:179], v[116:119], a[152:155], v[176:179]
    buffer_load_dwordx4 v[212:215], v17, s[24:27], s43 offen sc1
    v_mfma_f32_16x16x32_bf16 v[176:179], v[120:123], a[156:159], v[176:179]
    buffer_load_dwordx4 v[216:219], v17, s[24:27], s54 offen sc1
    s_waitcnt vmcnt(10)
    s_waitcnt lgkmcnt(0)
    s_barrier
    v_mfma_f32_16x16x32_bf16 v[160:163], v[132:135], a[160:163], v[160:163]
    ds_read_b64_tr_b16 v[108:109], v29 offset:20480
    ds_read_b64_tr_b16 v[110:111], v29 offset:21504
    v_mfma_f32_16x16x32_bf16 v[160:163], v[136:139], a[164:167], v[160:163]
    ds_read_b128 a[80:83], v7 offset:0
    ds_read_b128 a[96:99], v7 offset:2048
    v_mfma_f32_16x16x32_bf16 v[160:163], v[140:143], a[168:171], v[160:163]
    ds_read_b128 a[112:115], v7 offset:4096
    ds_read_b128 a[128:131], v7 offset:6144
    v_mfma_f32_16x16x32_bf16 v[160:163], v[144:147], a[172:175], v[160:163]
    ds_read_b128 a[144:147], v7 offset:8192
    ds_read_b64_tr_b16 v[112:113], v29 offset:24576
    v_mfma_f32_16x16x32_bf16 v[164:167], v[132:135], a[176:179], v[164:167]
    ds_read_b64_tr_b16 v[114:115], v29 offset:25600
    ds_read_b128 a[84:87], v8 offset:0
    v_mfma_f32_16x16x32_bf16 v[164:167], v[136:139], a[180:183], v[164:167]
    ds_read_b128 a[100:103], v8 offset:2048
    ds_read_b128 a[116:119], v8 offset:4096
    v_mfma_f32_16x16x32_bf16 v[164:167], v[140:143], a[184:187], v[164:167]
    ds_read_b128 a[132:135], v8 offset:6144
    ds_read_b128 a[148:151], v8 offset:8192
    v_mfma_f32_16x16x32_bf16 v[164:167], v[144:147], a[188:191], v[164:167]
    v_add_u32 v29, 36864, v29
    v_add_u32 v28, 36864, v28
    v_mfma_f32_16x16x32_bf16 v[168:171], v[132:135], a[192:195], v[168:171]
    v_mfma_f32_16x16x32_bf16 v[168:171], v[136:139], a[196:199], v[168:171]
    v_mfma_f32_16x16x32_bf16 v[168:171], v[140:143], a[200:203], v[168:171]
    v_mfma_f32_16x16x32_bf16 v[168:171], v[144:147], a[204:207], v[168:171]
    v_mfma_f32_16x16x32_bf16 v[172:175], v[132:135], a[208:211], v[172:175]
    v_mfma_f32_16x16x32_bf16 v[172:175], v[136:139], a[212:215], v[172:175]
    v_mfma_f32_16x16x32_bf16 v[172:175], v[140:143], a[216:219], v[172:175]
    v_mfma_f32_16x16x32_bf16 v[172:175], v[144:147], a[220:223], v[172:175]
    v_mfma_f32_16x16x32_bf16 v[176:179], v[132:135], a[224:227], v[176:179]
    v_mfma_f32_16x16x32_bf16 v[176:179], v[136:139], a[228:231], v[176:179]
    v_mfma_f32_16x16x32_bf16 v[176:179], v[140:143], a[232:235], v[176:179]
    v_mfma_f32_16x16x32_bf16 v[176:179], v[144:147], a[236:239], v[176:179]
    s_waitcnt lgkmcnt(0)
    s_waitcnt vmcnt(9)
    v_cmp_eq_u64 vcc, s[58:59], v[182:183]
    s_waitcnt vmcnt(8)
    v_cmp_eq_u64 s[60:61], s[58:59], v[186:187]
    s_nop 0
    s_and_b64 vcc, vcc, s[60:61]
    s_waitcnt vmcnt(7)
    v_cmp_eq_u64 s[60:61], s[58:59], v[190:191]
    s_nop 0
    s_and_b64 vcc, vcc, s[60:61]
    s_waitcnt vmcnt(6)
    v_cmp_eq_u64 s[60:61], s[58:59], v[194:195]
    s_nop 0
    s_and_b64 vcc, vcc, s[60:61]
    s_waitcnt vmcnt(5)
    v_cmp_eq_u64 s[60:61], s[58:59], v[198:199]
    s_nop 0
    s_and_b64 vcc, vcc, s[60:61]
    s_waitcnt vmcnt(4)
    v_cmp_eq_u64 s[60:61], s[58:59], v[202:203]
    s_nop 0
    s_and_b64 vcc, vcc, s[60:61]
    s_waitcnt vmcnt(3)
    v_cmp_eq_u64 s[60:61], s[58:59], v[206:207]
    s_nop 0
    s_and_b64 vcc, vcc, s[60:61]
    s_waitcnt vmcnt(2)
    v_cmp_eq_u64 s[60:61], s[58:59], v[210:211]
    s_nop 0
    s_and_b64 vcc, vcc, s[60:61]
    s_waitcnt vmcnt(1)
    v_cmp_eq_u64 s[60:61], s[58:59], v[214:215]
    s_nop 0
    s_and_b64 vcc, vcc, s[60:61]
    s_waitcnt vmcnt(0)
    v_cmp_eq_u64 s[60:61], s[58:59], v[218:219]
    s_nop 0
    s_and_b64 vcc, vcc, s[60:61]
    s_nop 1
    s_cmp_eq_u64 vcc, -1
    s_cbranch_scc0 LFX_slow
LFX_ok:
    v_mfma_f32_16x16x32_bf16 v[160:163], v[108:111], a[80:83], v[160:163]
    v_mul_f32 v36, v36, v36
    v_mul_f32 v37, v37, v37
    v_mfma_f32_16x16x32_bf16 v[160:163], v[112:115], a[84:87], v[160:163]
    v_mul_f32 v38, v38, v38
    v_mul_f32 v39, v39, v39
    v_mfma_f32_16x16x32_bf16 v[164:167], v[108:111], a[96:99], v[164:167]
    v_mul_f32 v40, v40, v40
    v_lshlrev_b32 v182, 16, v180
    v_mfma_f32_16x16x32_bf16 v[164:167], v[112:115], a[100:103], v[164:167]
    v_and_b32 v183, 0xffff0000, v180
    v_add_f32 v220, v220, v182
    v_mfma_f32_16x16x32_bf16 v[168:171], v[108:111], a[112:115], v[168:171]
    v_add_f32 v221, v221, v183
    v_lshlrev_b32 v182, 16, v181
    v_mfma_f32_16x16x32_bf16 v[168:171], v[112:115], a[116:119], v[168:171]
    v_and_b32 v183, 0xffff0000, v181
    v_add_f32 v222, v222, v182
    v_mfma_f32_16x16x32_bf16 v[172:175], v[108:111], a[128:131], v[172:175]
    v_add_f32 v223, v223, v183
    v_lshlrev_b32 v186, 16, v184
    v_mfma_f32_16x16x32_bf16 v[172:175], v[112:115], a[132:135], v[172:175]
    v_and_b32 v187, 0xffff0000, v184
    v_add_f32 v224, v224, v186
    v_mfma_f32_16x16x32_bf16 v[176:179], v[108:111], a[144:147], v[176:179]
    v_add_f32 v225, v225, v187
    v_lshlrev_b32 v186, 16, v185
    v_mfma_f32_16x16x32_bf16 v[176:179], v[112:115], a[148:151], v[176:179]
    v_and_b32 v187, 0xffff0000, v185
    v_add_f32 v226, v226, v186
    v_add_f32 v227, v227, v187
    v_lshlrev_b32 v190, 16, v188
    v_and_b32 v191, 0xffff0000, v188
    v_add_f32 v228, v228, v190
    v_add_f32 v229, v229, v191
    v_lshlrev_b32 v190, 16, v189
    v_and_b32 v191, 0xffff0000, v189
    v_add_f32 v230, v230, v190
    v_add_f32 v231, v231, v191
    v_lshlrev_b32 v194, 16, v192
    v_and_b32 v195, 0xffff0000, v192
    v_add_f32 v232, v232, v194
    v_add_f32 v233, v233, v195
    v_lshlrev_b32 v194, 16, v193
    v_and_b32 v195, 0xffff0000, v193
    v_add_f32 v234, v234, v194
    v_add_f32 v235, v235, v195
    v_lshlrev_b32 v198, 16, v196
    v_and_b32 v199, 0xffff0000, v196
    v_add_f32 v236, v236, v198
    v_add_f32 v237, v237, v199
    v_lshlrev_b32 v198, 16, v197
    v_and_b32 v199, 0xffff0000, v197
    v_add_f32 v238, v238, v198
    v_add_f32 v239, v239, v199
    v_lshlrev_b32 v202, 16, v200
    v_and_b32 v203, 0xffff0000, v200
    v_add_f32 v220, v220, v202
    v_add_f32 v221, v221, v203
    v_lshlrev_b32 v202, 16, v201
    v_and_b32 v203, 0xffff0000, v201
    v_add_f32 v222, v222, v202
    v_add_f32 v223, v223, v203
    v_lshlrev_b32 v206, 16, v204
    v_and_b32 v207, 0xffff0000, v204
    v_add_f32 v224, v224, v206
    v_add_f32 v225, v225, v207
    v_lshlrev_b32 v206, 16, v205
    v_and_b32 v207, 0xffff0000, v205
    v_add_f32 v226, v226, v206
    v_add_f32 v227, v227, v207
    v_lshlrev_b32 v210, 16, v208
    v_and_b32 v211, 0xffff0000, v208
    v_add_f32 v228, v228, v210
    v_add_f32 v229, v229, v211
    v_lshlrev_b32 v210, 16, v209
    v_and_b32 v211, 0xffff0000, v209
    v_add_f32 v230, v230, v210
    v_add_f32 v231, v231, v211
    v_lshlrev_b32 v214, 16, v212
    v_and_b32 v215, 0xffff0000, v212
    v_add_f32 v232, v232, v214
    v_add_f32 v233, v233, v215
    v_lshlrev_b32 v214, 16, v213
    v_and_b32 v215, 0xffff0000, v213
    v_add_f32 v234, v234, v214
    v_add_f32 v235, v235, v215
    v_lshlrev_b32 v218, 16, v216
    v_and_b32 v219, 0xffff0000, v216
    v_add_f32 v236, v236, v218
    v_add_f32 v237, v237, v219
    v_lshlrev_b32 v218, 16, v217
    v_and_b32 v219, 0xffff0000, v217
    v_add_f32 v238, v238, v218
    v_add_f32 v239, v239, v219
    v_mul_f32 v220, v36, v220
    v_mul_f32 v221, v36, v221
    v_mul_f32 v222, v36, v222
    v_mul_f32 v223, v36, v223
    v_mul_f32 v224, v37, v224
    v_mul_f32 v225, v37, v225
    v_mul_f32 v226, v37, v226
    v_mul_f32 v227, v37, v227
    v_mul_f32 v228, v38, v228
    v_mul_f32 v229, v38, v229
    v_mul_f32 v230, v38, v230
    v_mul_f32 v231, v38, v231
    v_mul_f32 v232, v39, v232
    v_mul_f32 v233, v39, v233
    v_mul_f32 v234, v39, v234
    v_mul_f32 v235, v39, v235
    v_mul_f32 v236, v40, v236
    v_mul_f32 v237, v40, v237
    v_mul_f32 v238, v40, v238
    v_mul_f32 v239, v40, v239
    v_mul_f32 v48, s55, v220
    v_mul_f32 v49, s55, v221
    v_mul_f32 v50, s55, v222
    v_mul_f32 v51, s55, v223
    v_mul_f32 v52, s55, v224
    v_mul_f32 v53, s55, v225
    v_mul_f32 v54, s55, v226
    v_mul_f32 v55, s55, v227
    v_mul_f32 v56, s55, v228
    v_mul_f32 v57, s55, v229
    v_mul_f32 v58, s55, v230
    v_mul_f32 v59, s55, v231
    v_mul_f32 v60, s55, v232
    v_mul_f32 v61, s55, v233
    v_mul_f32 v62, s55, v234
    v_mul_f32 v63, s55, v235
    v_mul_f32 v64, s55, v236
    v_mul_f32 v65, s55, v237
    v_mul_f32 v66, s55, v238
    v_mul_f32 v67, s55, v239
    v_exp_f32 v48, v48
    v_exp_f32 v49, v49
    v_exp_f32 v50, v50
    v_exp_f32 v51, v51
    v_exp_f32 v52, v52
    v_exp_f32 v53, v53
    v_exp_f32 v54, v54
    v_exp_f32 v55, v55
    v_exp_f32 v56, v56
    v_exp_f32 v57, v57
    v_exp_f32 v58, v58
    v_exp_f32 v59, v59
    v_exp_f32 v60, v60
    v_exp_f32 v61, v61
    v_exp_f32 v62, v62
    v_exp_f32 v63, v63
    v_exp_f32 v64, v64
    v_exp_f32 v65, v65
    v_exp_f32 v66, v66
    v_exp_f32 v67, v67
    v_add_f32 v48, 1.0, v48
    v_add_f32 v49, 1.0, v49
    v_add_f32 v50, 1.0, v50
    v_add_f32 v51, 1.0, v51
    v_add_f32 v52, 1.0, v52
    v_add_f32 v53, 1.0, v53
    v_add_f32 v54, 1.0, v54
    v_add_f32 v55, 1.0, v55
    v_add_f32 v56, 1.0, v56
    v_add_f32 v57, 1.0, v57
    v_add_f32 v58, 1.0, v58
    v_add_f32 v59, 1.0, v59
    v_add_f32 v60, 1.0, v60
    v_add_f32 v61, 1.0, v61
    v_add_f32 v62, 1.0, v62
    v_add_f32 v63, 1.0, v63
    v_add_f32 v64, 1.0, v64
    v_add_f32 v65, 1.0, v65
    v_add_f32 v66, 1.0, v66
    v_add_f32 v67, 1.0, v67
    v_rcp_f32 v48, v48
    v_rcp_f32 v49, v49
    v_rcp_f32 v50, v50
    v_rcp_f32 v51, v51
    v_rcp_f32 v52, v52
    v_rcp_f32 v53, v53
    v_rcp_f32 v54, v54
    v_rcp_f32 v55, v55
    v_rcp_f32 v56, v56
    v_rcp_f32 v57, v57
    v_rcp_f32 v58, v58
    v_rcp_f32 v59, v59
    v_rcp_f32 v60, v60
    v_rcp_f32 v61, v61
    v_rcp_f32 v62, v62
    v_rcp_f32 v63, v63
    v_rcp_f32 v64, v64
    v_rcp_f32 v65, v65
    v_rcp_f32 v66, v66
    v_rcp_f32 v67, v67
    v_mul_f32 v220, v220, v48
    v_mul_f32 v221, v221, v49
    v_mul_f32 v222, v222, v50
    v_mul_f32 v223, v223, v51
    v_mul_f32 v224, v224, v52
    v_mul_f32 v225, v225, v53
    v_mul_f32 v226, v226, v54
    v_mul_f32 v227, v227, v55
    v_mul_f32 v228, v228, v56
    v_mul_f32 v229, v229, v57
    v_mul_f32 v230, v230, v58
    v_mul_f32 v231, v231, v59
    v_mul_f32 v232, v232, v60
    v_mul_f32 v233, v233, v61
    v_mul_f32 v234, v234, v62
    v_mul_f32 v235, v235, v63
    v_mul_f32 v236, v236, v64
    v_mul_f32 v237, v237, v65
    v_mul_f32 v238, v238, v66
    v_mul_f32 v239, v239, v67
    v_and_b32 v34, 15, v1
    v_mul_u32_u24 v34, 272, v34
    v_and_b32 v35, 48, v1
    s_lshl_b32 s40, s36, 6
    s_add_u32 s40, s40, 73728
    v_add3_u32 v25, v34, v35, s40
    v_lshrrev_b32 v34, 3, v1
    v_mul_u32_u24 v34, 272, v34
    v_and_b32 v35, 7, v1
    v_lshl_add_u32 v34, v35, 5, v34
    s_mul_i32 s40, s36, 2176
    s_add_u32 s40, s40, 73728
    v_add_u32 v26, s40, v34
    v_mul_f32 v220, v220, v160
    v_mul_f32 v221, v221, v161
    v_mul_f32 v222, v222, v162
    v_mul_f32 v223, v223, v163
    ds_write_b128 v25, v[220:223] offset:0
    v_mul_f32 v224, v224, v164
    v_mul_f32 v225, v225, v165
    v_mul_f32 v226, v226, v166
    v_mul_f32 v227, v227, v167
    ds_write_b128 v25, v[224:227] offset:4352
    v_mul_f32 v228, v228, v168
    v_mul_f32 v229, v229, v169
    v_mul_f32 v230, v230, v170
    v_mul_f32 v231, v231, v171
    ds_write_b128 v25, v[228:231] offset:8704
    v_mul_f32 v232, v232, v172
    v_mul_f32 v233, v233, v173
    v_mul_f32 v234, v234, v174
    v_mul_f32 v235, v235, v175
    ds_write_b128 v25, v[232:235] offset:13056
    v_mul_f32 v236, v236, v176
    v_mul_f32 v237, v237, v177
    v_mul_f32 v238, v238, v178
    v_mul_f32 v239, v239, v179
    ds_write_b128 v25, v[236:239] offset:17408
    v_lshlrev_b32 v48, 16, v240
    v_and_b32 v49, 0xffff0000, v240
    v_lshlrev_b32 v50, 16, v241
    v_and_b32 v51, 0xffff0000, v241
    v_lshlrev_b32 v52, 16, v242
    v_and_b32 v53, 0xffff0000, v242
    v_lshlrev_b32 v54, 16, v243
    v_and_b32 v55, 0xffff0000, v243
    v_lshlrev_b32 v56, 16, v244
    v_and_b32 v57, 0xffff0000, v244
    v_lshlrev_b32 v58, 16, v245
    v_and_b32 v59, 0xffff0000, v245
    v_lshlrev_b32 v60, 16, v246
    v_and_b32 v61, 0xffff0000, v246
    v_lshlrev_b32 v62, 16, v247
    v_and_b32 v63, 0xffff0000, v247
    v_lshlrev_b32 v64, 16, v248
    v_and_b32 v65, 0xffff0000, v248
    v_lshlrev_b32 v66, 16, v249
    v_and_b32 v67, 0xffff0000, v249
    v_lshlrev_b32 v68, 16, v250
    v_and_b32 v69, 0xffff0000, v250
    v_lshlrev_b32 v70, 16, v251
    v_and_b32 v71, 0xffff0000, v251
    s_waitcnt lgkmcnt(0)
    s_barrier
    ds_read_b128 v[180:183], v26 offset:0
    ds_read_b128 v[184:187], v26 offset:16
    ds_read_b128 v[188:191], v26 offset:8704
    ds_read_b128 v[192:195], v26 offset:8720
    ds_read_b128 v[196:199], v26 offset:17408
    ds_read_b128 v[200:203], v26 offset:17424
    s_waitcnt lgkmcnt(5)
    v_add_f32 v48, v48, v180
    v_add_f32 v49, v49, v181
    v_add_f32 v50, v50, v182
    v_add_f32 v51, v51, v183
    s_waitcnt lgkmcnt(4)
    v_add_f32 v52, v52, v184
    v_add_f32 v53, v53, v185
    v_add_f32 v54, v54, v186
    v_add_f32 v55, v55, v187
    v_cvt_pk_bf16_f32 v240, v48, v49
    v_cvt_pk_bf16_f32 v241, v50, v51
    v_cvt_pk_bf16_f32 v242, v52, v53
    v_cvt_pk_bf16_f32 v243, v54, v55
    buffer_store_dwordx4 v[240:243], v9, s[16:19], 0 offen
    s_waitcnt lgkmcnt(3)
    v_add_f32 v56, v56, v188
    v_add_f32 v57, v57, v189
    v_add_f32 v58, v58, v190
    v_add_f32 v59, v59, v191
    s_waitcnt lgkmcnt(2)
    v_add_f32 v60, v60, v192
    v_add_f32 v61, v61, v193
    v_add_f32 v62, v62, v194
    v_add_f32 v63, v63, v195
    v_cvt_pk_bf16_f32 v244, v56, v57
    v_cvt_pk_bf16_f32 v245, v58, v59
    v_cvt_pk_bf16_f32 v246, v60, v61
    v_cvt_pk_bf16_f32 v247, v62, v63
    buffer_store_dwordx4 v[244:247], v10, s[16:19], 0 offen
    s_waitcnt lgkmcnt(1)
    v_add_f32 v64, v64, v196
    v_add_f32 v65, v65, v197
    v_add_f32 v66, v66, v198
    v_add_f32 v67, v67, v199
    s_waitcnt lgkmcnt(0)
    v_add_f32 v68, v68, v200
    v_add_f32 v69, v69, v201
    v_add_f32 v70, v70, v202
    v_add_f32 v71, v71, v203
    v_cvt_pk_bf16_f32 v248, v64, v65
    v_cvt_pk_bf16_f32 v249, v66, v67
    v_cvt_pk_bf16_f32 v250, v68, v69
    v_cvt_pk_bf16_f32 v251, v70, v71
    buffer_store_dwordx4 v[248:251], v11, s[16:19], 0 offen
    s_endpgm
LB_spare:
    ds_read_b32 v248, v245 offset:15424
    ds_read_b32 v249, v245 offset:15552
    ds_read_b32 v250, v245 offset:15680
    ds_read_b32 v251, v245 offset:15808
    s_waitcnt lgkmcnt(2)
    v_add_f32 v248, v248, v249
    s_waitcnt lgkmcnt(0)
    v_add_f32 v250, v250, v251
    v_add_f32 v248, v248, v250
    v_cvt_pk_bf16_f32 v249, v248, v248
    v_lshlrev_b32 v249, 16, v249
    v_sub_f32 v249, v248, v249
    v_cvt_pk_bf16_f32 v224, v248, v249
    s_nop 1
    v_mfma_f32_32x32x8_bf16 v[144:159], v[224:225], v[226:227], v[144:159]
    v_mfma_f32_32x32x8_bf16 v[160:175], v[224:225], v[228:229], v[160:175]
    s_nop 10
    v_mul_f32 v248, v230, v144
    v_mul_f32 v249, v230, v145
    v_mul_f32 v250, v230, v146
    v_mul_f32 v251, v230, v147
    v_mul_f32 v252, v230, v148
    v_mul_f32 v253, v230, v149
    v_mul_f32 v254, v230, v150
    v_mul_f32 v255, v230, v151
    v_exp_f32 v248, v248
    v_exp_f32 v249, v249
    v_exp_f32 v250, v250
    v_exp_f32 v251, v251
    v_exp_f32 v252, v252
    v_exp_f32 v253, v253
    v_exp_f32 v254, v254
    v_exp_f32 v255, v255
    v_mul_f32 v144, v144, v152
    v_mul_f32 v145, v145, v153
    v_mul_f32 v146, v146, v154
    v_mul_f32 v147, v147, v155
    v_mul_f32 v148, v148, v156
    v_mul_f32 v149, v149, v157
    v_mul_f32 v150, v150, v158
    v_mul_f32 v151, v151, v159
    v_add_f32 v248, 1.0, v248
    v_add_f32 v249, 1.0, v249
    v_add_f32 v250, 1.0, v250
    v_add_f32 v251, 1.0, v251
    v_add_f32 v252, 1.0, v252
    v_add_f32 v253, 1.0, v253
    v_add_f32 v254, 1.0, v254
    v_add_f32 v255, 1.0, v255
    v_rcp_f32 v248, v248
    v_rcp_f32 v249, v249
    v_rcp_f32 v250, v250
    v_rcp_f32 v251, v251
    v_rcp_f32 v252, v252
    v_rcp_f32 v253, v253
    v_rcp_f32 v254, v254
    v_rcp_f32 v255, v255
    s_add_u32 s61, s54, 0
    v_mul_f32 v144, v144, v248
    v_mul_f32 v145, v145, v249
    v_mul_f32 v146, v146, v250
    v_mul_f32 v147, v147, v251
    v_mul_f32 v148, v148, v252
    v_mul_f32 v149, v149, v253
    v_mul_f32 v150, v150, v254
    v_mul_f32 v151, v151, v255
    v_cvt_pk_bf16_f32 v152, v144, v145
    v_cvt_pk_bf16_f32 v153, v146, v147
    v_cvt_pk_bf16_f32 v154, v148, v149
    v_cvt_pk_bf16_f32 v155, v150, v151
    buffer_store_dwordx4 v[152:155], v3, s[20:23], s61 offen sc1
    v_mul_f32 v248, v231, v160
    v_mul_f32 v249, v231, v161
    v_mul_f32 v250, v231, v162
    v_mul_f32 v251, v231, v163
    v_mul_f32 v252, v231, v164
    v_mul_f32 v253, v231, v165
    v_mul_f32 v254, v231, v166
    v_mul_f32 v255, v231, v167
    v_exp_f32 v248, v248
    v_exp_f32 v249, v249
    v_exp_f32 v250, v250
    v_exp_f32 v251, v251
    v_exp_f32 v252, v252
    v_exp_f32 v253, v253
    v_exp_f32 v254, v254
    v_exp_f32 v255, v255
    v_mul_f32 v160, v160, v168
    v_mul_f32 v161, v161, v169
    v_mul_f32 v162, v162, v170
    v_mul_f32 v163, v163, v171
    v_mul_f32 v164, v164, v172
    v_mul_f32 v165, v165, v173
    v_mul_f32 v166, v166, v174
    v_mul_f32 v167, v167, v175
    v_add_f32 v248, 1.0, v248
    v_add_f32 v249, 1.0, v249
    v_add_f32 v250, 1.0, v250
    v_add_f32 v251, 1.0, v251
    v_add_f32 v252, 1.0, v252
    v_add_f32 v253, 1.0, v253
    v_add_f32 v254, 1.0, v254
    v_add_f32 v255, 1.0, v255
    v_rcp_f32 v248, v248
    v_rcp_f32 v249, v249
    v_rcp_f32 v250, v250
    v_rcp_f32 v251, v251
    v_rcp_f32 v252, v252
    v_rcp_f32 v253, v253
    v_rcp_f32 v254, v254
    v_rcp_f32 v255, v255
    s_add_u32 s61, s54, 294912
    v_mul_f32 v160, v160, v248
    v_mul_f32 v161, v161, v249
    v_mul_f32 v162, v162, v250
    v_mul_f32 v163, v163, v251
    v_mul_f32 v164, v164, v252
    v_mul_f32 v165, v165, v253
    v_mul_f32 v166, v166, v254
    v_mul_f32 v167, v167, v255
    v_cvt_pk_bf16_f32 v168, v160, v161
    v_cvt_pk_bf16_f32 v169, v162, v163
    v_cvt_pk_bf16_f32 v170, v164, v165
    v_cvt_pk_bf16_f32 v171, v166, v167
    buffer_store_dwordx4 v[168:171], v3, s[20:23], s61 offen sc1
    s_waitcnt vmcnt(0)
    s_barrier
    v_mov_b32 v34, s58
    v_mov_b32 v35, s59
    buffer_store_dwordx2 v[34:35], v0, s[32:35], s80 offen sc1
    s_endpgm
LT_slow:
    s_mov_b32 s57, 0
LT_spin:
    s_sleep 2
    buffer_load_dwordx2 v[222:223], v221, s[20:23], 0 offen sc1
    s_waitcnt vmcnt(0)
    v_readfirstlane_b32 s40, v222
    s_add_u32 s57, s57, 1
    s_cmp_lg_u32 s40, 0
    s_cbranch_scc1 LT_ok
    s_cmp_lt_u32 s57, 100000
    s_cbranch_scc1 LT_spin
    s_branch LT_ok
LW_slow:
    s_mov_b32 s57, 0
LW_spin:
    s_sleep 2
    buffer_load_dwordx2 v[12:13], v15, s[32:35], 0 offen sc1
    s_waitcnt vmcnt(0)
    s_add_u32 s57, s57, 1
    v_cmp_eq_u64 vcc, s[58:59], v[12:13]
    s_nop 1
    s_cmp_eq_u64 vcc, -1
    s_cbranch_scc1 LW_ok
    s_cmp_lt_u32 s57, 100000
    s_cbranch_scc1 LW_spin
    s_branch LW_ok
LS_slow:
    s_mov_b32 s57, 0
LS_spin:
    s_sleep 2
    buffer_load_dwordx4 v[216:219], v14, s[32:35], 0 offen offset:0 sc1
    buffer_load_dwordx4 v[220:223], v14, s[32:35], 0 offen offset:512 sc1
    s_waitcnt vmcnt(0)
    s_add_u32 s57, s57, 1
    v_cmp_eq_u64 vcc, s[58:59], v[218:219]
    v_cmp_eq_u64 s[42:43], s[58:59], v[222:223]
    s_nop 0
    s_and_b64 vcc, vcc, s[42:43]
    s_nop 1
    s_cmp_eq_u64 vcc, -1
    s_cbranch_scc1 LS_ok
    s_cmp_lt_u32 s57, 100000
    s_cbranch_scc1 LS_spin
    s_branch LS_ok
LK_slow:
    s_mov_b32 s57, 0
LK_spin:
    s_sleep 2
    buffer_load_dwordx2 v[12:13], v14, s[32:35], 0 offen sc1
    s_waitcnt vmcnt(0)
    s_add_u32 s57, s57, 1
    v_cmp_eq_u64 vcc, s[58:59], v[12:13]
    s_nop 1
    s_cmp_eq_u64 vcc, -1
    s_cbranch_scc1 LK_ok
    s_cmp_lt_u32 s57, 100000
    s_cbranch_scc1 LK_spin
    s_branch LK_ok
LF1_slow:
    s_mov_b32 s57, 0
LF1_spin:
    s_sleep 2
    buffer_load_dwordx2 v[12:13], v246, s[32:35], 0 offen sc1
    s_waitcnt vmcnt(0)
    s_add_u32 s57, s57, 1
    v_cmp_eq_u64 vcc, s[58:59], v[12:13]
    s_nop 1
    s_cmp_eq_u64 vcc, -1
    s_cbranch_scc1 LF1_ok
    s_cmp_lt_u32 s57, 100000
    s_cbranch_scc1 LF1_spin
    s_branch LF1_ok
LF2_slow:
    s_mov_b32 s57, 0
LF2_spin:
    s_sleep 2
    buffer_load_dwordx2 v[32:33], v246, s[32:35], 0 offen sc1
    s_waitcnt vmcnt(0)
    s_add_u32 s57, s57, 1
    v_cmp_eq_u64 vcc, s[58:59], v[32:33]
    s_nop 1
    s_cmp_eq_u64 vcc, -1
    s_cbranch_scc1 LF2_ok
    s_cmp_lt_u32 s57, 100000
    s_cbranch_scc1 LF2_spin
    s_branch LF2_ok
LFX_slow:
    s_mov_b32 s57, 0
LFX_spin:
    s_sleep 2
    buffer_load_dwordx4 v[180:183], v16, s[24:27], s40 offen sc1
    buffer_load_dwordx4 v[184:187], v16, s[24:27], s41 offen sc1
    buffer_load_dwordx4 v[188:191], v16, s[24:27], s42 offen sc1
    buffer_load_dwordx4 v[192:195], v16, s[24:27], s43 offen sc1
    buffer_load_dwordx4 v[196:199], v16, s[24:27], s54 offen sc1
    buffer_load_dwordx4 v[200:203], v17, s[24:27], s40 offen sc1
    buffer_load_dwordx4 v[204:207], v17, s[24:27], s41 offen sc1
    buffer_load_dwordx4 v[208:211], v17, s[24:27], s42 offen sc1
    buffer_load_dwordx4 v[212:215], v17, s[24:27], s43 offen sc1
    buffer_load_dwordx4 v[216:219], v17, s[24:27], s54 offen sc1
    s_waitcnt vmcnt(0)
    s_add_u32 s57, s57, 1
    v_cmp_eq_u64 vcc, s[58:59], v[182:183]
    v_cmp_eq_u64 s[60:61], s[58:59], v[186:187]
    s_nop 0
    s_and_b64 vcc, vcc, s[60:61]
    v_cmp_eq_u64 s[60:61], s[58:59], v[190:191]
    s_nop 0
    s_and_b64 vcc, vcc, s[60:61]
    v_cmp_eq_u64 s[60:61], s[58:59], v[194:195]
    s_nop 0
    s_and_b64 vcc, vcc, s[60:61]
    v_cmp_eq_u64 s[60:61], s[58:59], v[198:199]
    s_nop 0
    s_and_b64 vcc, vcc, s[60:61]
    v_cmp_eq_u64 s[60:61], s[58:59], v[202:203]
    s_nop 0
    s_and_b64 vcc, vcc, s[60:61]
    v_cmp_eq_u64 s[60:61], s[58:59], v[206:207]
    s_nop 0
    s_and_b64 vcc, vcc, s[60:61]
    v_cmp_eq_u64 s[60:61], s[58:59], v[210:211]
    s_nop 0
    s_and_b64 vcc, vcc, s[60:61]
    v_cmp_eq_u64 s[60:61], s[58:59], v[214:215]
    s_nop 0
    s_and_b64 vcc, vcc, s[60:61]
    v_cmp_eq_u64 s[60:61], s[58:59], v[218:219]
    s_nop 0
    s_and_b64 vcc, vcc, s[60:61]
    s_nop 1
    s_cmp_eq_u64 vcc, -1
    s_cbranch_scc1 LFX_ok
    s_cmp_lt_u32 s57, 100000
    s_cbranch_scc1 LFX_spin
    s_branch LFX_ok
LK_end:
    s_endpgm
LK_tab:
.byte 0, 7, 14, 19, 28, 33, 42, 47, 54, 61, 68, 73, 82, 87, 96, 101, 108, 115, 122, 127, 136, 141, 9, 23, 38, 52, 63, 77, 92, 106, 117, 131, 3, 12, 21, 30, 39, 48, 57, 66, 75, 84, 93, 102, 111, 120, 129, 138
.byte 0, 7, 14, 19, 28, 33, 42, 47, 54, 61, 68, 73, 82, 87, 96, 101, 108, 115, 122, 127, 136, 141, 9, 23, 38, 52, 63, 77, 92, 106, 117, 131, 3, 12, 21, 30, 39, 48, 57, 66, 75, 84, 93, 102, 111, 120, 129, 138
.byte 0, 7, 14, 19, 28, 33, 42, 47, 54, 61, 68, 73, 82, 87, 96, 101, 108, 115, 122, 127, 136, 141, 9, 23, 38, 52, 63, 77, 92, 106, 117, 131, 3, 12, 21, 30, 39, 48, 57, 66, 75, 84, 93, 102, 111, 120, 129, 138
.byte 0, 7, 14, 19, 28, 33, 42, 47, 54, 61, 68, 73, 82, 87, 96, 101, 108, 115, 122, 127, 136, 141, 9, 23, 38, 52, 63, 77, 92, 106, 117, 131, 3, 12, 21, 30, 39, 48, 57, 66, 75, 84, 93, 102, 111, 120, 129, 138
.byte 0, 7, 14, 19, 28, 33, 42, 47, 54, 61, 68, 73, 82, 87, 96, 101, 108, 115, 122, 127, 136, 141, 9, 23, 38, 52, 63, 77, 92, 106, 117, 131, 3, 12, 21, 30, 39, 48, 57, 66, 75, 84, 93, 102, 111, 120, 129, 138
.byte 0, 7, 14, 19, 28, 33, 42, 47, 54, 61, 68, 73, 82, 87, 96, 101, 108, 115, 122, 127, 136, 141, 9, 23, 38, 52, 63, 77, 92, 106, 117, 131, 3, 12, 21, 30, 39, 48, 57, 66, 75, 84, 93, 102, 111, 120, 129, 138
.byte 0, 7, 14, 19, 28, 33, 42, 47, 54, 61, 68, 73, 82, 87, 96, 101, 108, 115, 122, 127, 136, 141, 9, 23, 38, 52, 63, 77, 92, 106, 117, 131, 3, 12, 21, 30, 39, 48, 57, 66, 75, 84, 93, 102, 111, 120, 129, 138
.byte 0, 7, 14, 19, 28, 33, 42, 47, 54, 61, 68, 73, 82, 87, 96, 101, 108, 115, 122, 127, 136, 141, 9, 23, 38, 52, 63, 77, 92, 106, 117, 131, 3, 12, 21, 30, 39, 48, 57, 66, 75, 84, 93, 102, 111, 120, 129, 138
.byte 0, 7, 14, 19, 28, 33, 42, 47, 54, 61, 68, 73, 82, 87, 96, 101, 108, 115, 122, 127, 136, 141, 9, 23, 38, 52, 63, 77, 92, 106, 117, 131, 3, 12, 21, 30, 39, 48, 57, 66, 75, 84, 93, 102, 111, 120, 129, 138
.byte 0, 7, 14, 19, 28, 33, 42, 47, 54, 61, 68, 73, 82, 87, 96, 101, 108, 115, 122, 127, 136, 141, 9, 23, 38, 52, 63, 77, 92, 106, 117, 131, 3, 12, 21, 30, 39, 48, 57, 66, 75, 84, 93, 102, 111, 120, 129, 138
.byte 0, 7, 14, 19, 28, 33, 42, 47, 54, 61, 68, 73, 82, 87, 96, 101, 108, 115, 122, 127, 136, 141, 9, 23, 38, 52, 63, 77, 92, 106, 117, 131, 3, 12, 21, 30, 39, 48, 57, 66, 75, 84, 93, 102, 111, 120, 129, 138
.byte 0, 7, 14, 19, 28, 33, 42, 47, 54, 61, 68, 73, 82, 87, 96, 101, 108, 115, 122, 127, 136, 141, 9, 23, 38, 52, 63, 77, 92, 106, 117, 131, 3, 12, 21, 30, 39, 48, 57, 66, 75, 84, 93, 102, 111, 120, 129, 138
.byte 0, 7, 14, 19, 28, 33, 42, 47, 54, 61, 68, 73, 82, 87, 96, 101, 108, 115, 122, 127, 136, 141, 9, 23, 38, 52, 63, 77, 92, 106, 117, 131, 3, 12, 21, 30, 39, 48, 57, 66, 75, 84, 93, 102, 111, 120, 129, 138
.byte 0, 7, 14, 19, 28, 33, 42, 47, 54, 61, 68, 73, 82, 87, 96, 101, 108, 115, 122, 127, 136, 141, 9, 23, 38, 52, 63, 77, 92, 106, 117, 131, 3, 12, 21, 30, 39, 48, 57, 66, 75, 84, 93, 102, 111, 120, 129, 138
.byte 0, 7, 14, 19, 28, 33, 42, 47, 54, 61, 68, 73, 82, 87, 96, 101, 108, 115, 122, 127, 136, 141, 9, 23, 38, 52, 63, 77, 92, 106, 117, 131, 3, 12, 21, 30, 39, 48, 57, 66, 75, 84, 93, 102, 111, 120, 129, 138
.byte 0, 7, 14, 19, 28, 33, 42, 47, 54, 61, 68, 73, 82, 87, 96, 101, 108, 115, 122, 127, 136, 141, 9, 23, 38, 52, 63, 77, 92, 106, 117, 131, 3, 12, 21, 30, 39, 48, 57, 66, 75, 84, 93, 102, 111, 120, 129, 138
.byte 0, 7, 14, 19, 28, 33, 42, 47, 54, 61, 68, 73, 82, 87, 96, 101, 108, 115, 122, 127, 136, 141, 9, 23, 38, 52, 63, 77, 92, 106, 117, 131, 3, 12, 21, 30, 39, 48, 57, 66, 75, 84, 93, 102, 111, 120, 129, 138
.byte 0, 7, 14, 19, 28, 33, 42, 47, 54, 61, 68, 73, 82, 87, 96, 101, 108, 115, 122, 127, 136, 141, 9, 23, 38, 52, 63, 77, 92, 106, 117, 131, 3, 12, 21, 30, 39, 48, 57, 66, 75, 84, 93, 102, 111, 120, 129, 138
.byte 0, 7, 14, 19, 28, 33, 42, 47, 54, 61, 68, 73, 82, 87, 96, 101, 108, 115, 122, 127, 136, 141, 9, 23, 38, 52, 63, 77, 92, 106, 117, 131, 3, 12, 21, 30, 39, 48, 57, 66, 75, 84, 93, 102, 111, 120, 129, 138
.byte 0, 7, 14, 19, 28, 33, 42, 47, 54, 61, 68, 73, 82, 87, 96, 101, 108, 115, 122, 127, 136, 141, 9, 23, 38, 52, 63, 77, 92, 106, 117, 131, 3, 12, 21, 30, 39, 48, 57, 66, 75, 84, 93, 102, 111, 120, 129, 138
.byte 0, 7, 14, 19, 28, 33, 42, 47, 54, 61, 68, 73, 82, 87, 96, 101, 108, 115, 122, 127, 136, 141, 9, 23, 38, 52, 63, 77, 92, 106, 117, 131, 3, 12, 21, 30, 39, 48, 57, 66, 75, 84, 93, 102, 111, 120, 129, 138
.byte 0, 7, 14, 19, 28, 33, 42, 47, 54, 61, 68, 73, 82, 87, 96, 101, 108, 115, 122, 127, 136, 141, 9, 23, 38, 52, 63, 77, 92, 106, 117, 131, 3, 12, 21, 30, 39, 48, 57, 66, 75, 84, 93, 102, 111, 120, 129, 138
.byte 0, 7, 14, 19, 28, 33, 42, 47, 54, 61, 68, 73, 82, 87, 96, 101, 108, 115, 122, 127, 136, 141, 9, 23, 38, 52, 63, 77, 92, 106, 117, 131, 3, 12, 21, 30, 39, 48, 57, 66, 75, 84, 93, 102, 111, 120, 129, 138
.byte 0, 7, 14, 19, 28, 33, 42, 47, 54, 61, 68, 73, 82, 87, 96, 101, 108, 115, 122, 127, 136, 141, 9, 23, 38, 52, 63, 77, 92, 106, 117, 131, 3, 12, 21, 30, 39, 48, 57, 66, 75, 84, 93, 102, 111, 120, 129, 138
.byte 0, 7, 14, 19, 28, 33, 42, 47, 54, 61, 68, 73, 82, 87, 96, 101, 108, 115, 122, 127, 136, 141, 9, 23, 38, 52, 63, 77, 92, 106, 117, 131, 3, 12, 21, 30, 39, 48, 57, 66, 75, 84, 93, 102, 111, 120, 129, 138
.byte 0, 7, 14, 19, 28, 33, 42, 47, 54, 61, 68, 73, 82, 87, 96, 101, 108, 115, 122, 127, 136, 141, 9, 23, 38, 52, 63, 77, 92, 106, 117, 131, 3, 12, 21, 30, 39, 48, 57, 66, 75, 84, 93, 102, 111, 120, 129, 138
.byte 0, 7, 14, 19, 28, 33, 42, 47, 54, 61, 68, 73, 82, 87, 96, 101, 108, 115, 122, 127, 136, 141, 9, 23, 38, 52, 63, 77, 92, 106, 117, 131, 3, 12, 21, 30, 39, 48, 57, 66, 75, 84, 93, 102, 111, 120, 129, 138
.byte 0, 7, 14, 19, 28, 33, 42, 47, 54, 61, 68, 73, 82, 87, 96, 101, 108, 115, 122, 127, 136, 141, 9, 23, 38, 52, 63, 77, 92, 106, 117, 131, 3, 12, 21, 30, 39, 48, 57, 66, 75, 84, 93, 102, 111, 120, 129, 138
.byte 0, 7, 14, 19, 28, 33, 42, 47, 54, 61, 68, 73, 82, 87, 96, 101, 108, 115, 122, 127, 136, 141, 9, 23, 38, 52, 63, 77, 92, 106, 117, 131, 3, 12, 21, 30, 39, 48, 57, 66, 75, 84, 93, 102, 111, 120, 129, 138
.byte 0, 7, 14, 19, 28, 33, 42, 47, 54, 61, 68, 73, 82, 87, 96, 101, 108, 115, 122, 127, 136, 141, 9, 23, 38, 52, 63, 77, 92, 106, 117, 131, 3, 12, 21, 30, 39, 48, 57, 66, 75, 84, 93, 102, 111, 120, 129, 138
.byte 1, 10, 15, 24, 29, 36, 43, 50, 55, 64, 69, 78, 83, 90, 97, 104, 109, 118, 123, 132, 137, 2, 16, 27, 41, 56, 70, 81, 95, 110, 124, 135, 4, 13, 22, 31, 40, 49, 58, 67, 76, 85, 94, 103, 112, 121, 130, 139
.byte 1, 10, 15, 24, 29, 36, 43, 50, 55, 64, 69, 78, 83, 90, 97, 104, 109, 118, 123, 132, 137, 2, 16, 27, 41, 56, 70, 81, 95, 110, 124, 135, 4, 13, 22, 31, 40, 49, 58, 67, 76, 85, 94, 103, 112, 121, 130, 139
.byte 1, 10, 15, 24, 29, 36, 43, 50, 55, 64, 69, 78, 83, 90, 97, 104, 109, 118, 123, 132, 137, 2, 16, 27, 41, 56, 70, 81, 95, 110, 124, 135, 4, 13, 22, 31, 40, 49, 58, 67, 76, 85, 94, 103, 112, 121, 130, 139
.byte 1, 10, 15, 24, 29, 36, 43, 50, 55, 64, 69, 78, 83, 90, 97, 104, 109, 118, 123, 132, 137, 2, 16, 27, 41, 56, 70, 81, 95, 110, 124, 135, 4, 13, 22, 31, 40, 49, 58, 67, 76, 85, 94, 103, 112, 121, 130, 139
.byte 1, 10, 15, 24, 29, 36, 43, 50, 55, 64, 69, 78, 83, 90, 97, 104, 109, 118, 123, 132, 137, 2, 16, 27, 41, 56, 70, 81, 95, 110, 124, 135, 4, 13, 22, 31, 40, 49, 58, 67, 76, 85, 94, 103, 112, 121, 130, 139
.byte 1, 10, 15, 24, 29, 36, 43, 50, 55, 64, 69, 78, 83, 90, 97, 104, 109, 118, 123, 132, 137, 2, 16, 27, 41, 56, 70, 81, 95, 110, 124, 135, 4, 13, 22, 31, 40, 49, 58, 67, 76, 85, 94, 103, 112, 121, 130, 139
.byte 1, 10, 15, 24, 29, 36, 43, 50, 55, 64, 69, 78, 83, 90, 97, 104, 109, 118, 123, 132, 137, 2, 16, 27, 41, 56, 70, 81, 95, 110, 124, 135, 4, 13, 22, 31, 40, 49, 58, 67, 76, 85, 94, 103, 112, 121, 130, 139
.byte 1, 10, 15, 24, 29, 36, 43, 50, 55, 64, 69, 78, 83, 90, 97, 104, 109, 118, 123, 132, 137, 2, 16, 27, 41, 56, 70, 81, 95, 110, 124, 135, 4, 13, 22, 31, 40, 49, 58, 67, 76, 85, 94, 103, 112, 121, 130, 139
.byte 1, 10, 15, 24, 29, 36, 43, 50, 55, 64, 69, 78, 83, 90, 97, 104, 109, 118, 123, 132, 137, 2, 16, 27, 41, 56, 70, 81, 95, 110, 124, 135, 4, 13, 22, 31, 40, 49, 58, 67, 76, 85, 94, 103, 112, 121, 130, 139
.byte 1, 10, 15, 24, 29, 36, 43, 50, 55, 64, 69, 78, 83, 90, 97, 104, 109, 118, 123, 132, 137, 2, 16, 27, 41, 56, 70, 81, 95, 110, 124, 135, 4, 13, 22, 31, 40, 49, 58, 67, 76, 85, 94, 103, 112, 121, 130, 139
.byte 1, 10, 15, 24, 29, 36, 43, 50, 55, 64, 69, 78, 83, 90, 97, 104, 109, 118, 123, 132, 137, 2, 16, 27, 41, 56, 70, 81, 95, 110, 124, 135, 4, 13, 22, 31, 40, 49, 58, 67, 76, 85, 94, 103, 112, 121, 130, 139
.byte 1, 10, 15, 24, 29, 36, 43, 50, 55, 64, 69, 78, 83, 90, 97, 104, 109, 118, 123, 132, 137, 2, 16, 27, 41, 56, 70, 81, 95, 110, 124, 135, 4, 13, 22, 31, 40, 49, 58, 67, 76, 85, 94, 103, 112, 121, 130, 139
.byte 1, 10, 15, 24, 29, 36, 43, 50, 55, 64, 69, 78, 83, 90, 97, 104, 109, 118, 123, 132, 137, 2, 16, 27, 41, 56, 70, 81, 95, 110, 124, 135, 4, 13, 22, 31, 40, 49, 58, 67, 76, 85, 94, 103, 112, 121, 130, 139
.byte 1, 10, 15, 24, 29, 36, 43, 50, 55, 64, 69, 78, 83, 90, 97, 104, 109, 118, 123, 132, 137, 2, 16, 27, 41, 56, 70, 81, 95, 110, 124, 135, 4, 13, 22, 31, 40, 49, 58, 67, 76, 85, 94, 103, 112, 121, 130, 139
.byte 1, 10, 15, 24, 29, 36, 43, 50, 55, 64, 69, 78, 83, 90, 97, 104, 109, 118, 123, 132, 137, 2, 16, 27, 41, 56, 70, 81, 95, 110, 124, 135, 4, 13, 22, 31, 40, 49, 58, 67, 76, 85, 94, 103, 112, 121, 130, 139
.byte 1, 10, 15, 24, 29, 36, 43, 50, 55, 64, 69, 78, 83, 90, 97, 104, 109, 118, 123, 132, 137, 2, 16, 27, 41, 56, 70, 81, 95, 110, 124, 135, 4, 13, 22, 31, 40, 49, 58, 67, 76, 85, 94, 103, 112, 121, 130, 139
.byte 1, 10, 15, 24, 29, 36, 43, 50, 55, 64, 69, 78, 83, 90, 97, 104, 109, 118, 123, 132, 137, 2, 16, 27, 41, 56, 70, 81, 95, 110, 124, 135, 4, 13, 22, 31, 40, 49, 58, 67, 76, 85, 94, 103, 112, 121, 130, 139
.byte 1, 10, 15, 24, 29, 36, 43, 50, 55, 64, 69, 78, 83, 90, 97, 104, 109, 118, 123, 132, 137, 2, 16, 27, 41, 56, 70, 81, 95, 110, 124, 135, 4, 13, 22, 31, 40, 49, 58, 67, 76, 85, 94, 103, 112, 121, 130, 139
.byte 1, 10, 15, 24, 29, 36, 43, 50, 55, 64, 69, 78, 83, 90, 97, 104, 109, 118, 123, 132, 137, 2, 16, 27, 41, 56, 70, 81, 95, 110, 124, 135, 4, 13, 22, 31, 40, 49, 58, 67, 76, 85, 94, 103, 112, 121, 130, 139
.byte 1, 10, 15, 24, 29, 36, 43, 50, 55, 64, 69, 78, 83, 90, 97, 104, 109, 118, 123, 132, 137, 2, 16, 27, 41, 56, 70, 81, 95, 110, 124, 135, 4, 13, 22, 31, 40, 49, 58, 67, 76, 85, 94, 103, 112, 121, 130, 139
.byte 1, 10, 15, 24, 29, 36, 43, 50, 55, 64, 69, 78, 83, 90, 97, 104, 109, 118, 123, 132, 137, 2, 16, 27, 41, 56, 70, 81, 95, 110, 124, 135, 4, 13, 22, 31, 40, 49, 58, 67, 76, 85, 94, 103, 112, 121, 130, 139
.byte 1, 10, 15, 24, 29, 36, 43, 50, 55, 64, 69, 78, 83, 90, 97, 104, 109, 118, 123, 132, 137, 2, 16, 27, 41, 56, 70, 81, 95, 110, 124, 135, 4, 13, 22, 31, 40, 49, 58, 67, 76, 85, 94, 103, 112, 121, 130, 139
.byte 1, 10, 15, 24, 29, 36, 43, 50, 55, 64, 69, 78, 83, 90, 97, 104, 109, 118, 123, 132, 137, 2, 16, 27, 41, 56, 70, 81, 95, 110, 124, 135, 4, 13, 22, 31, 40, 49, 58, 67, 76, 85, 94, 103, 112, 121, 130, 139
.byte 1, 10, 15, 24, 29, 36, 43, 50, 55, 64, 69, 78, 83, 90, 97, 104, 109, 118, 123, 132, 137, 2, 16, 27, 41, 56, 70, 81, 95, 110, 124, 135, 4, 13, 22, 31, 40, 49, 58, 67, 76, 85, 94, 103, 112, 121, 130, 139
.byte 1, 10, 15, 24, 29, 36, 43, 50, 55, 64, 69, 78, 83, 90, 97, 104, 109, 118, 123, 132, 137, 2, 16, 27, 41, 56, 70, 81, 95, 110, 124, 135, 4, 13, 22, 31, 40, 49, 58, 67, 76, 85, 94, 103, 112, 121, 130, 139
.byte 1, 10, 15, 24, 29, 36, 43, 50, 55, 64, 69, 78, 83, 90, 97, 104, 109, 118, 123, 132, 137, 2, 16, 27, 41, 56, 70, 81, 95, 110, 124, 135, 4, 13, 22, 31, 40, 49, 58, 67, 76, 85, 94, 103, 112, 121, 130, 139
.byte 1, 10, 15, 24, 29, 36, 43, 50, 55, 64, 69, 78, 83, 90, 97, 104, 109, 118, 123, 132, 137, 2, 16, 27, 41, 56, 70, 81, 95, 110, 124, 135, 4, 13, 22, 31, 40, 49, 58, 67, 76, 85, 94, 103, 112, 121, 130, 139
.byte 1, 10, 15, 24, 29, 36, 43, 50, 55, 64, 69, 78, 83, 90, 97, 104, 109, 118, 123, 132, 137, 2, 16, 27, 41, 56, 70, 81, 95, 110, 124, 135, 4, 13, 22, 31, 40, 49, 58, 67, 76, 85, 94, 103, 112, 121, 130, 139
.byte 1, 10, 15, 24, 29, 36, 43, 50, 55, 64, 69, 78, 83, 90, 97, 104, 109, 118, 123, 132, 137, 2, 16, 27, 41, 56, 70, 81, 95, 110, 124, 135, 4, 13, 22, 31, 40, 49, 58, 67, 76, 85, 94, 103, 112, 121, 130, 139
.byte 1, 10, 15, 24, 29, 36, 43, 50, 55, 64, 69, 78, 83, 90, 97, 104, 109, 118, 123, 132, 137, 2, 16, 27, 41, 56, 70, 81, 95, 110, 124, 135, 4, 13, 22, 31, 40, 49, 58, 67, 76, 85, 94, 103, 112, 121, 130, 139
.byte 6, 11, 18, 25, 32, 37, 46, 51, 60, 65, 72, 79, 86, 91, 100, 105, 114, 119, 126, 133, 140, 5, 20, 34, 45, 59, 74, 88, 99, 113, 128, 142, 8, 17, 26, 35, 44, 53, 62, 71, 80, 89, 98, 107, 116, 125, 134, 143
.byte 6, 11, 18, 25, 32, 37, 46, 51, 60, 65, 72, 79, 86, 91, 100, 105, 114, 119, 126, 133, 140, 5, 20, 34, 45, 59, 74, 88, 99, 113, 128, 142, 8, 17, 26, 35, 44, 53, 62, 71, 80, 89, 98, 107, 116, 125, 134, 143
.byte 6, 11, 18, 25, 32, 37, 46, 51, 60, 65, 72, 79, 86, 91, 100, 105, 114, 119, 126, 133, 140, 5, 20, 34, 45, 59, 74, 88, 99, 113, 128, 142, 8, 17, 26, 35, 44, 53, 62, 71, 80, 89, 98, 107, 116, 125, 134, 143
.byte 6, 11, 18, 25, 32, 37, 46, 51, 60, 65, 72, 79, 86, 91, 100, 105, 114, 119, 126, 133, 140, 5, 20, 34, 45, 59, 74, 88, 99, 113, 128, 142, 8, 17, 26, 35, 44, 53, 62, 71, 80, 89, 98, 107, 116, 125, 134, 143
.byte 6, 11, 18, 25, 32, 37, 46, 51, 60, 65, 72, 79, 86, 91, 100, 105, 114, 119, 126, 133, 140, 5, 20, 34, 45, 59, 74, 88, 99, 113, 128, 142, 8, 17, 26, 35, 44, 53, 62, 71, 80, 89, 98, 107, 116, 125, 134, 143
.byte 6, 11, 18, 25, 32, 37, 46, 51, 60, 65, 72, 79, 86, 91, 100, 105, 114, 119, 126, 133, 140, 5, 20, 34, 45, 59, 74, 88, 99, 113, 128, 142, 8, 17, 26, 35, 44, 53, 62, 71, 80, 89, 98, 107, 116, 125, 134, 143
.byte 6, 11, 18, 25, 32, 37, 46, 51, 60, 65, 72, 79, 86, 91, 100, 105, 114, 119, 126, 133, 140, 5, 20, 34, 45, 59, 74, 88, 99, 113, 128, 142, 8, 17, 26, 35, 44, 53, 62, 71, 80, 89, 98, 107, 116, 125, 134, 143
.byte 6, 11, 18, 25, 32, 37, 46, 51, 60, 65, 72, 79, 86, 91, 100, 105, 114, 119, 126, 133, 140, 5, 20, 34, 45, 59, 74, 88, 99, 113, 128, 142, 8, 17, 26, 35, 44, 53, 62, 71, 80, 89, 98, 107, 116, 125, 134, 143
.byte 6, 11, 18, 25, 32, 37, 46, 51, 60, 65, 72, 79, 86, 91, 100, 105, 114, 119, 126, 133, 140, 5, 20, 34, 45, 59, 74, 88, 99, 113, 128, 142, 8, 17, 26, 35, 44, 53, 62, 71, 80, 89, 98, 107, 116, 125, 134, 143
.byte 6, 11, 18, 25, 32, 37, 46, 51, 60, 65, 72, 79, 86, 91, 100, 105, 114, 119, 126, 133, 140, 5, 20, 34, 45, 59, 74, 88, 99, 113, 128, 142, 8, 17, 26, 35, 44, 53, 62, 71, 80, 89, 98, 107, 116, 125, 134, 143
.byte 6, 11, 18, 25, 32, 37, 46, 51, 60, 65, 72, 79, 86, 91, 100, 105, 114, 119, 126, 133, 140, 5, 20, 34, 45, 59, 74, 88, 99, 113, 128, 142, 8, 17, 26, 35, 44, 53, 62, 71, 80, 89, 98, 107, 116, 125, 134, 143
.byte 6, 11, 18, 25, 32, 37, 46, 51, 60, 65, 72, 79, 86, 91, 100, 105, 114, 119, 126, 133, 140, 5, 20, 34, 45, 59, 74, 88, 99, 113, 128, 142, 8, 17, 26, 35, 44, 53, 62, 71, 80, 89, 98, 107, 116, 125, 134, 143
.byte 6, 11, 18, 25, 32, 37, 46, 51, 60, 65, 72, 79, 86, 91, 100, 105, 114, 119, 126, 133, 140, 5, 20, 34, 45, 59, 74, 88, 99, 113, 128, 142, 8, 17, 26, 35, 44, 53, 62, 71, 80, 89, 98, 107, 116, 125, 134, 143
.byte 6, 11, 18, 25, 32, 37, 46, 51, 60, 65, 72, 79, 86, 91, 100, 105, 114, 119, 126, 133, 140, 5, 20, 34, 45, 59, 74, 88, 99, 113, 128, 142, 8, 17, 26, 35, 44, 53, 62, 71, 80, 89, 98, 107, 116, 125, 134, 143
.byte 6, 11, 18, 25, 32, 37, 46, 51, 60, 65, 72, 79, 86, 91, 100, 105, 114, 119, 126, 133, 140, 5, 20, 34, 45, 59, 74, 88, 99, 113, 128, 142, 8, 17, 26, 35, 44, 53, 62, 71, 80, 89, 98, 107, 116, 125, 134, 143
.byte 6, 11, 18, 25, 32, 37, 46, 51, 60, 65, 72, 79, 86, 91, 100, 105, 114, 119, 126, 133, 140, 5, 20, 34, 45, 59, 74, 88, 99, 113, 128, 142, 8, 17, 26, 35, 44, 53, 62, 71, 80, 89, 98, 107, 116, 125, 134, 143
.byte 6, 11, 18, 25, 32, 37, 46, 51, 60, 65, 72, 79, 86, 91, 100, 105, 114, 119, 126, 133, 140, 5, 20, 34, 45, 59, 74, 88, 99, 113, 128, 142, 8, 17, 26, 35, 44, 53, 62, 71, 80, 89, 98, 107, 116, 125, 134, 143
.byte 6, 11, 18, 25, 32, 37, 46, 51, 60, 65, 72, 79, 86, 91, 100, 105, 114, 119, 126, 133, 140, 5, 20, 34, 45, 59, 74, 88, 99, 113, 128, 142, 8, 17, 26, 35, 44, 53, 62, 71, 80, 89, 98, 107, 116, 125, 134, 143
.byte 6, 11, 18, 25, 32, 37, 46, 51, 60, 65, 72, 79, 86, 91, 100, 105, 114, 119, 126, 133, 140, 5, 20, 34, 45, 59, 74, 88, 99, 113, 128, 142, 8, 17, 26, 35, 44, 53, 62, 71, 80, 89, 98, 107, 116, 125, 134, 143
.byte 6, 11, 18, 25, 32, 37, 46, 51, 60, 65, 72, 79, 86, 91, 100, 105, 114, 119, 126, 133, 140, 5, 20, 34, 45, 59, 74, 88, 99, 113, 128, 142, 8, 17, 26, 35, 44, 53, 62, 71, 80, 89, 98, 107, 116, 125, 134, 143
.byte 6, 11, 18, 25, 32, 37, 46, 51, 60, 65, 72, 79, 86, 91, 100, 105, 114, 119, 126, 133, 140, 5, 20, 34, 45, 59, 74, 88, 99, 113, 128, 142, 8, 17, 26, 35, 44, 53, 62, 71, 80, 89, 98, 107, 116, 125, 134, 143
.byte 6, 11, 18, 25, 32, 37, 46, 51, 60, 65, 72, 79, 86, 91, 100, 105, 114, 119, 126, 133, 140, 5, 20, 34, 45, 59, 74, 88, 99, 113, 128, 142, 8, 17, 26, 35, 44, 53, 62, 71, 80, 89, 98, 107, 116, 125, 134, 143
.byte 6, 11, 18, 25, 32, 37, 46, 51, 60, 65, 72, 79, 86, 91, 100, 105, 114, 119, 126, 133, 140, 5, 20, 34, 45, 59, 74, 88, 99, 113, 128, 142, 8, 17, 26, 35, 44, 53, 62, 71, 80, 89, 98, 107, 116, 125, 134, 143
.byte 6, 11, 18, 25, 32, 37, 46, 51, 60, 65, 72, 79, 86, 91, 100, 105, 114, 119, 126, 133, 140, 5, 20, 34, 45, 59, 74, 88, 99, 113, 128, 142, 8, 17, 26, 35, 44, 53, 62, 71, 80, 89, 98, 107, 116, 125, 134, 143
.byte 6, 11, 18, 25, 32, 37, 46, 51, 60, 65, 72, 79, 86, 91, 100, 105, 114, 119, 126, 133, 140, 5, 20, 34, 45, 59, 74, 88, 99, 113, 128, 142, 8, 17, 26, 35, 44, 53, 62, 71, 80, 89, 98, 107, 116, 125, 134, 143
.byte 6, 11, 18, 25, 32, 37, 46, 51, 60, 65, 72, 79, 86, 91, 100, 105, 114, 119, 126, 133, 140, 5, 20, 34, 45, 59, 74, 88, 99, 113, 128, 142, 8, 17, 26, 35, 44, 53, 62, 71, 80, 89, 98, 107, 116, 125, 134, 143
.byte 6, 11, 18, 25, 32, 37, 46, 51, 60, 65, 72, 79, 86, 91, 100, 105, 114, 119, 126, 133, 140, 5, 20, 34, 45, 59, 74, 88, 99, 113, 128, 142, 8, 17, 26, 35, 44, 53, 62, 71, 80, 89, 98, 107, 116, 125, 134, 143
.byte 6, 11, 18, 25, 32, 37, 46, 51, 60, 65, 72, 79, 86, 91, 100, 105, 114, 119, 126, 133, 140, 5, 20, 34, 45, 59, 74, 88, 99, 113, 128, 142, 8, 17, 26, 35, 44, 53, 62, 71, 80, 89, 98, 107, 116, 125, 134, 143
.byte 6, 11, 18, 25, 32, 37, 46, 51, 60, 65, 72, 79, 86, 91, 100, 105, 114, 119, 126, 133, 140, 5, 20, 34, 45, 59, 74, 88, 99, 113, 128, 142, 8, 17, 26, 35, 44, 53, 62, 71, 80, 89, 98, 107, 116, 125, 134, 143
.byte 6, 11, 18, 25, 32, 37, 46, 51, 60, 65, 72, 79, 86, 91, 100, 105, 114, 119, 126, 133, 140, 5, 20, 34, 45, 59, 74, 88, 99, 113, 128, 142, 8, 17, 26, 35, 44, 53, 62, 71, 80, 89, 98, 107, 116, 125, 134, 143
.p2align 2
.section .rodata,"a"
.p2align 6
.amdhsa_kernel recurrent_scan__linear_kernel_hedgehog__swiglu_ffn__prompt_kernel
  .amdhsa_next_free_vgpr 512
  .amdhsa_next_free_sgpr 102
  .amdhsa_accum_offset 256
  .amdhsa_group_segment_fixed_size 0
  .amdhsa_kernarg_size 88
  .amdhsa_user_sgpr_count 2
  .amdhsa_user_sgpr_kernarg_segment_ptr 1
  .amdhsa_system_sgpr_workgroup_id_x 1
.end_amdhsa_kernel
.text
```
